```python
import torch

def _softmax(x, axis=-1):
    return torch.softmax(x, dim=axis)
def _gelu(x):
    return torch.nn.functional.gelu(x, approximate="tanh")
def _silu(x):
    return torch.nn.functional.silu(x)
def _sigmoid(x):
    return torch.sigmoid(x)
def _layernorm(x, axis=-1, eps=1e-5):
    m = x.mean(dim=axis, keepdim=True)
    v = x.var(dim=axis, keepdim=True, unbiased=False)
    return (x - m) / torch.sqrt(v + eps)
def _scatter_add(tgt, idx, src, axis=0):
    return tgt.clone().index_add_(axis, idx, src)
def _segment_sum(src, seg, n):
    out = torch.zeros((n,) + src.shape[1:], dtype=src.dtype)
    return out.index_add_(0, seg, src)
def _pad(x, pw):
    flat = tuple(v for pair in reversed(pw) for v in pair)
    return torch.nn.functional.pad(x, flat)

kernel_name = 'sequential_preLN__sliding_block__mixer_s_mlp__prompt'

def setup_inputs():

    _w = (lambda a: (lambda t: t.to(torch.bfloat16) if t.is_floating_point() else t)(torch.as_tensor(a)))
    def _A_setup():
        B, S, D = 1, 2048, 640
        return {
            "x": _w((lambda *s: torch.randn(*s, dtype=torch.bfloat16) * 0.05)(B, S, D)),
            "wqkv": _w((lambda *s: torch.randn(*s, dtype=torch.bfloat16) * 0.05)(D, 3 * D)),
            "wo": _w((lambda *s: torch.randn(*s, dtype=torch.bfloat16) * 0.05)(D, D)),
        }
    _A_in = _A_setup()

    def _B_setup():
        B, S, D, F = 1, 2048, 640, 1728
        return {
            "x":  _w((lambda *s: torch.randn(*s, dtype=torch.bfloat16) * 0.05)(B, S, D)),
            "w1": _w((lambda *s: torch.randn(*s, dtype=torch.bfloat16) * 3.2)(D, D) * (D ** -0.5)),
            "w2": _w((lambda *s: torch.randn(*s, dtype=torch.bfloat16) * 3.2)(D, D) * (D ** -0.5)),
            "w3": _w((lambda *s: torch.randn(*s, dtype=torch.bfloat16) * 3.2)(D, F) * (D ** -0.5)),
            "w4": _w((lambda *s: torch.randn(*s, dtype=torch.bfloat16) * 3.2)(F, D) * (F ** -0.5)),
        }
    _B_in = _B_setup()

    return {
        "A_x": _A_in["x"],
        "A_wqkv": _A_in["wqkv"],
        "A_wo": _A_in["wo"],
        "B_x": _B_in["x"],
        "B_w1": _B_in["w1"],
        "B_w2": _B_in["w2"],
        "B_w3": _B_in["w3"],
        "B_w4": _B_in["w4"],
    }

def reference(A_x, A_wqkv, A_wo, B_x, B_w1, B_w2, B_w3, B_w4):
    def _A_ref(x, wqkv, wo):
        B, S, D = x.shape
        H = 32; Dh = D // H; W = 256
        qkv = (lambda x, *d: x.permute(*d))((x @ wqkv).reshape(B, S, 3, H, Dh), 2, 0, 3, 1, 4)
        q, k, v = qkv[0], qkv[1], qkv[2]
        scores = torch.einsum("bhqd,bhkd->bhqk", q, k) * (Dh ** -0.5)
        idx = torch.arange(S)
        mask = (idx[:, None] - idx[None, :] >= 0) & (idx[:, None] - idx[None, :] < W)
        scores = torch.where(mask[None, None], scores, -1e9)
        p = _softmax(scores, axis=-1)
        o = torch.einsum("bhqk,bhkd->bhqd", p, v)
        return (lambda x, *d: x.permute(*d))(o, 0, 2, 1, 3).reshape(B, S, D) @ wo

    def _B_ref(x, w1, w2, w3, w4):
        B, S, D = x.shape
        h = _gelu(_layernorm(x, axis=-1) @ w1)
        c = D // 4
        g0 = _pad(h[:, :, 0*c:1*c], ((0, 0), (1, 0), (0, 0)))[:, :S, :]
        g1 = _pad(h[:, :, 1*c:2*c], ((0, 0), (0, 1), (0, 0)))[:, 1:, :]
        g2 = _pad(h[:, :, 2*c:3*c], ((0, 0), (2, 0), (0, 0)))[:, :S, :]
        g3 = _pad(h[:, :, 3*c:   ], ((0, 0), (0, 2), (0, 0)))[:, 2:, :]
        hs = torch.concatenate([g0, g1, g2, g3], axis=-1) @ w2
        x1 = x + hs
        h2 = _gelu(_layernorm(x1, axis=-1) @ w3) @ w4
        return x1 + h2

    x = A_x
    h = x + _A_ref(_layernorm(x, axis=-1), A_wqkv, A_wo)
    h2 = h + _B_ref(_layernorm(h, axis=-1), B_w1, B_w2, B_w3, B_w4)
    return h2
```

```asm
; @launch grid=(256,1,1) block=(512,1,1) lds=161920
.amdgcn_target "amdgcn-amd-amdhsa--gfx950"
.text
.globl sequential_preLN__sliding_block__mixer_s_mlp__prompt_kernel
.p2align 8
.type sequential_preLN__sliding_block__mixer_s_mlp__prompt_kernel,@function
sequential_preLN__sliding_block__mixer_s_mlp__prompt_kernel:
    s_load_dwordx4 s[4:7], s[0:1], 0
    s_load_dwordx4 s[72:75], s[0:1], 72
    s_cmp_ge_u32 s2, 256
    s_cbranch_scc1 L_end
    v_lshrrev_b32 v2, 6, v0
    v_and_b32 v1, 63, v0
    v_readfirstlane_b32 s30, v2
    s_nop 0
    s_cmp_ge_u32 s30, 4
    s_cbranch_scc1 L_nocpf
    s_getpc_b64 s[48:49]
L_pc0:
    s_sub_u32 s48, s48, L_pc0-sequential_preLN__sliding_block__mixer_s_mlp__prompt_kernel
    s_subb_u32 s49, s49, 0
    s_lshr_b32 s50, s2, 3
    s_lshl_b32 s50, s50, 2
    s_add_u32 s50, s50, s30
    s_cmp_ge_u32 s50, 8
    s_cbranch_scc1 L_nocpf
    s_lshl_b32 s50, s50, 13
    v_lshl_add_u32 v60, v1, 7, s50
    v_min_u32 v60, L_code_end-sequential_preLN__sliding_block__mixer_s_mlp__prompt_kernel-4, v60
    v_mov_b32 v61, s49
    v_add_co_u32 v60, vcc, s48, v60
    s_nop 1
    v_addc_co_u32 v61, vcc, 0, v61, vcc
    global_load_dword v62, v[60:61], off
L_nocpf:
    s_and_b32 s25, s2, 7
    s_lshr_b32 s26, s2, 3
    s_and_b32 s27, s26, 3
    s_lshr_b32 s28, s26, 2
    s_lshr_b32 s31, s25, 1
    s_lshl_b32 s31, s31, 2
    s_add_u32 s31, s31, s27
    s_lshr_b32 s35, s27, 1
    s_cmp_eq_u32 s28, 99
    s_cselect_b32 s35, s35, 0
    s_xor_b32 s32, s25, s35
    s_and_b32 s32, s32, 1
    s_lshl_b32 s35, s28, 1
    s_add_u32 s32, s32, s35
    s_mul_i32 s29, s27, 3
    s_and_b32 s35, s25, 6
    s_add_u32 s29, s29, s35
    s_cmp_ge_u32 s32, 10
    s_addc_u32 s29, s29, s32
    s_mul_i32 s35, s29, 6554
    s_lshr_b32 s35, s35, 16
    s_mul_i32 s35, s35, 10
    s_sub_u32 s29, s29, s35
    s_cmp_ge_u32 s30, 4
    s_cbranch_scc1 L_k1_help
    s_cmp_lg_u32 s32, 15
    s_cbranch_scc1 L_k1_comp
    v_lshlrev_b32 v3, 4, v1
    v_mov_b32 v4, 0
    v_mov_b32 v5, 0
    v_mov_b32 v6, 0
    v_mov_b32 v7, 0
    s_lshl_b32 s43, s31, 2
    s_add_u32 s43, s43, s30
    s_lshl_b32 s44, s43, 12
    s_lshl_b32 s43, s43, 11
    s_add_u32 s43, s43, 18087936
    s_add_u32 s44, s44, 10485760
    s_waitcnt lgkmcnt(0)
    s_mov_b32 s20, s74
    s_and_b32 s21, s75, 0xffff
    s_mov_b32 s22, 18219008
    s_mov_b32 s23, 0x20000
    buffer_store_dwordx4 v[4:7], v3, s[20:23], s43 offen sc1
    buffer_store_dwordx4 v[4:7], v3, s[20:23], s43 offen offset:1024 sc1
    buffer_store_dwordx4 v[4:7], v3, s[20:23], s44 offen offset:0 sc1
    buffer_store_dwordx4 v[4:7], v3, s[20:23], s44 offen offset:1024 sc1
    buffer_store_dwordx4 v[4:7], v3, s[20:23], s44 offen offset:2048 sc1
    buffer_store_dwordx4 v[4:7], v3, s[20:23], s44 offen offset:3072 sc1
    s_mov_b32 s76, s72
    s_and_b32 s77, s73, 0xffff
    s_mov_b32 s78, 256
    s_mov_b32 s79, 0x20000
    v_mov_b32 v8, 1
    v_mov_b32 v224, 0
    v_mov_b32 v225, 0
    s_waitcnt vmcnt(0)
    s_mov_b64 exec, 1
    buffer_atomic_add v8, v4, s[76:79], 0 offen sc1
    s_mov_b64 exec, -1
    s_branch L_k1_spare_c2
L_k1_help:
    s_setprio 2
    s_sub_u32 s33, s30, 4
    v_lshrrev_b32 v8, 3, v1
    v_and_b32 v9, 7, v1
    v_lshrrev_b32 v10, 4, v1
    s_cmp_eq_u32 s32, 15
    s_cbranch_scc1 L_k1_spare_h
    v_mul_u32_u24 v11, 1280, v8
    v_xor_b32 v12, v10, v9
    v_lshl_add_u32 v4, v12, 4, v11
    v_xor_b32 v5, 64, v4
    v_mul_u32_u24 v11, 3840, v10
    v_bfe_u32 v12, v1, 2, 2
    v_xor_b32 v12, v12, v10
    v_lshl_add_u32 v11, v12, 6, v11
    v_and_b32 v12, 3, v1
    v_lshl_add_u32 v3, v12, 4, v11
    s_lshl_b32 s36, s31, 2
    s_add_u32 s36, s36, s33
    s_mul_i32 s36, s36, 40960
    s_mul_i32 s37, s33, 61440
    s_lshl_b32 s38, s32, 8
    s_add_u32 s37, s37, s38
    s_lshl_b32 s39, s33, 12
    s_mov_b32 s34, s29
    s_mov_b32 s14, 2621440
    s_mov_b32 s15, 0x20000
    s_mov_b32 s18, 2457600
    s_mov_b32 s19, 0x20000
    s_waitcnt lgkmcnt(0)
    s_mov_b32 s12, s4
    s_and_b32 s13, s5, 0xffff
    s_mov_b32 s16, s6
    s_and_b32 s17, s7, 0xffff
    s_lshl_b32 s40, s34, 7
    s_add_u32 s40, s40, s36
    s_mul_i32 s41, s34, 245760
    s_add_u32 s41, s41, s37
    s_add_u32 m0, s39, 0
    s_nop 0
    buffer_load_dwordx4 v4, s[12:15], s40 offen lds
    s_add_u32 m0, s39, 16384
    s_add_u32 s40, s40, 10240
    buffer_load_dwordx4 v3, s[16:19], s41 offen lds
    s_add_u32 s41, s41, 15360
    s_add_u32 m0, s39, 1024
    s_nop 0
    buffer_load_dwordx4 v5, s[12:15], s40 offen lds
    s_add_u32 m0, s39, 17408
    s_add_u32 s40, s40, 10240
    buffer_load_dwordx4 v3, s[16:19], s41 offen lds
    s_add_u32 s41, s41, 15360
    s_add_u32 m0, s39, 2048
    s_nop 0
    buffer_load_dwordx4 v4, s[12:15], s40 offen lds
    s_add_u32 m0, s39, 18432
    s_add_u32 s40, s40, 10240
    buffer_load_dwordx4 v3, s[16:19], s41 offen lds
    s_add_u32 s41, s41, 15360
    s_add_u32 m0, s39, 3072
    s_nop 0
    buffer_load_dwordx4 v5, s[12:15], s40 offen lds
    s_add_u32 m0, s39, 19456
    s_add_u32 s40, s40, 10240
    buffer_load_dwordx4 v3, s[16:19], s41 offen lds
    s_add_u32 s34, s34, 1
    s_cmp_eq_u32 s34, 10
    s_cselect_b32 s34, 0, s34
    s_mov_b32 s20, s74
    s_and_b32 s21, s75, 0xffff
    s_mov_b32 s22, 18219008
    s_mov_b32 s23, 0x20000
    v_lshlrev_b32 v14, 4, v1
    v_add_u32 v15, s39, v14
    v_and_b32 v48, 31, v1
    v_lshrrev_b32 v49, 5, v1
    v_mul_u32_u24 v50, 2560, v49
    v_lshl_add_u32 v52, v48, 2, v50
    v_lshlrev_b32 v51, 1, v52
    s_setprio 0
    s_load_dwordx2 s[10:11], s[0:1], 16
    s_load_dwordx8 s[56:63], s[0:1], 32
    v_lshlrev_b32 v14, 4, v1
    v_mov_b32 v2, 0
    s_waitcnt lgkmcnt(0)
    s_mov_b32 s20, s74
    s_and_b32 s21, s75, 0xffff
    s_mov_b32 s22, 18219008
    s_mov_b32 s23, 0x20000
    s_mov_b32 s76, s72
    s_and_b32 s77, s73, 0xffff
    s_mov_b32 s78, 256
    s_mov_b32 s79, 0x20000
    v_mov_b32 v13, 161856
    ds_write_b32 v13, v2
    ds_write_b32 v13, v2 offset:4
    ds_write_b32 v13, v2 offset:8
    ds_write_b32 v13, v2 offset:12
    ds_write_b32 v13, v2 offset:32
    ds_write_b32 v13, v2 offset:36
    ds_write_b32 v13, v2 offset:40
    ds_write_b32 v13, v2 offset:44
    ds_write_b32 v13, v2 offset:48
    ds_write_b32 v13, v2 offset:52
    ds_write_b32 v13, v2 offset:56
    ds_write_b32 v13, v2 offset:60
    s_waitcnt lgkmcnt(0)
    s_mul_i32 s48, s31, 15
    s_add_u32 s48, s48, s32
    s_add_u32 s48, s48, 41
    s_mov_b32 s64, s10
    s_mov_b32 s65, s11
    s_mov_b32 s50, 1280
    s_mov_b32 s51, 5
    s_mov_b32 s52, 0
    s_mov_b32 s53, 0
    s_mov_b32 s55, 0
    s_mov_b32 s66, 819200
    s_mov_b32 s70, 20
    s_mov_b32 s67, s48
    s_cmp_lt_u32 s48, 40
    s_cbranch_scc1 L_dec4m
    s_mov_b32 s64, s56
    s_mov_b32 s65, s57
    s_mov_b32 s52, 5
    s_mov_b32 s55, 17797120
    s_sub_u32 s67, s48, 40
    s_cmp_lt_u32 s48, 80
    s_cbranch_scc1 L_dec4m
    s_mov_b32 s64, s58
    s_mov_b32 s65, s59
    s_mov_b32 s52, 10
    s_mov_b32 s55, 0
    s_sub_u32 s67, s48, 80
    s_cmp_lt_u32 s48, 120
    s_cbranch_scc1 L_dec4m
    s_mov_b32 s64, s60
    s_mov_b32 s65, s61
    s_mov_b32 s50, 3456
    s_mov_b32 s52, 15
    s_mov_b32 s53, 1
    s_mov_b32 s55, 17809408
    s_mov_b32 s66, 2211840
    s_mov_b32 s51, 7
    s_sub_u32 s67, s48, 120
    s_mul_i32 s68, s67, 21846
    s_lshr_b32 s68, s68, 16
    s_mul_i32 s69, s68, 3
    s_sub_u32 s69, s67, s69
    s_cmp_lt_u32 s48, 201
    s_cbranch_scc1 L_decjm
    s_mov_b32 s64, s62
    s_mov_b32 s65, s63
    s_mov_b32 s50, 1280
    s_mov_b32 s52, 29
    s_mov_b32 s53, 2
    s_mov_b32 s55, 0
    s_mov_b32 s70, 54
    s_sub_u32 s67, s48, 201
    s_lshr_b32 s68, s67, 3
    s_and_b32 s69, s67, 7
    s_branch L_decjm
L_dec4m:
    s_lshr_b32 s68, s67, 2
    s_and_b32 s69, s67, 3
L_decjm:
    s_mov_b32 s24, s64
    s_and_b32 s25, s65, 0xffff
    s_mov_b32 s26, s66
    s_mov_b32 s27, 0x20000
    s_mul_i32 s54, s69, s51
    s_sub_u32 s70, s70, s54
    s_min_u32 s51, s51, s70
    s_lshl_b32 s49, s54, 2
    s_add_u32 s49, s49, s33
    s_lshl_b32 s49, s49, 3
    s_mul_i32 s49, s49, s50
    s_lshl_b32 s42, s68, 7
    s_add_u32 s49, s49, s42
    v_mul_lo_u32 v13, v8, s50
    v_lshl_add_u32 v13, v9, 4, v13
    s_lshl_b32 s42, s68, 2
    s_add_u32 s42, s42, s33
    s_mul_i32 s52, s52, 20480
    s_add_u32 s52, s52, 10752000
    s_cmp_eq_u32 s53, 1
    s_cbranch_scc1 L_dw3m
    s_mul_i32 s43, s42, 52429
    s_lshr_b32 s43, s43, 18
    s_mul_i32 s44, s43, 5
    s_sub_u32 s44, s42, s44
    s_cmp_eq_u32 s44, 0
    s_cselect_b32 s45, 4, -1
    s_bitcmp1_b32 s43, 0
    s_cselect_b32 s45, s45, 0
    s_add_u32 s44, s44, s45
    s_add_u32 s42, s42, s45
    s_lshl_b32 s44, s44, 10
    s_mul_i32 s46, s69, 2560
    s_branch L_dj2m
L_dw3m:
    s_lshr_b32 s45, s42, 1
    s_mul_i32 s43, s45, 9363
    s_lshr_b32 s43, s43, 16
    s_cmp_eq_u32 s45, 48
    s_cselect_b32 s43, 7, s43
    s_mul_i32 s44, s43, 7
    s_sub_u32 s44, s45, s44
    s_cmp_eq_u32 s43, 7
    s_addc_u32 s44, s44, 0
    s_lshl_b32 s44, s44, 1
    s_and_b32 s45, s42, 1
    s_add_u32 s44, s44, s45
    s_add_u32 s45, s44, 132
    s_cmp_eq_u32 s44, 7
    s_cselect_b32 s45, 146, s45
    s_cmp_lt_u32 s44, 7
    s_cselect_b32 s44, s44, s45
    s_lshl_b32 s44, s44, 10
    s_mul_i32 s46, s69, 8192
L_dj2m:
    s_mul_i32 s43, s43, 880640
    s_add_u32 s52, s52, s43
    s_add_u32 s52, s52, s44
    s_lshl_b32 s42, s42, 6
    s_add_u32 s42, s42, s46
    s_cmp_eq_u32 s55, 0
    s_cselect_b32 s42, 0, s42
    s_add_u32 s55, s55, s42
    v_bfe_u32 v11, v1, 2, 2
    v_lshl_add_u32 v11, v10, 3, v11
    v_lshlrev_b32 v11, 7, v11
    v_and_b32 v12, 3, v1
    v_lshl_add_u32 v11, v12, 4, v11
    s_lshr_b32 s42, s33, 1
    s_lshl_b32 s42, s42, 6
    s_and_b32 s43, s33, 1
    s_lshl_b32 s43, s43, 3
    s_add_u32 s42, s42, s43
    s_add_u32 s42, s42, 131072
    v_add_u32 v11, s42, v11
    v_lshrrev_b32 v6, 1, v10
    v_lshlrev_b32 v6, 9, v6
    v_and_b32 v7, 1, v10
    v_lshlrev_b32 v7, 9, v7
    v_sub_u32 v6, v6, v7
    v_add_u32 v6, v6, v11
    v_lshlrev_b32 v7, 12, v10
    v_add_u32 v7, v7, v11
    v_add_u32 v7, 2048, v7
    s_cmp_eq_u32 s53, 1
    s_mov_b32 s46, 5120
    s_cmov_b32 s46, 7168
    s_add_u32 s42, s54, 0
    s_mul_i32 s43, s42, 9363
    s_lshr_b32 s43, s43, 16
    s_cmp_eq_u32 s42, 48
    s_cselect_b32 s43, 7, s43
    s_mul_i32 s44, s43, 7
    s_sub_u32 s44, s42, s44
    s_cmp_eq_u32 s43, 7
    s_addc_u32 s44, s44, 0
    s_lshl_b32 s44, s44, 2
    s_lshr_b32 s44, 0x6315420, s44
    s_and_b32 s44, s44, 7
    s_lshl_b32 s44, s44, 3
    s_add_u32 s44, s44, s43
    s_cmp_eq_u32 s53, 2
    s_cselect_b32 s42, s44, s42
    s_mul_i32 s42, s42, s46
    s_add_u32 s92, s42, s52
    s_add_u32 s42, s54, 1
    s_mul_i32 s43, s42, 9363
    s_lshr_b32 s43, s43, 16
    s_cmp_eq_u32 s42, 48
    s_cselect_b32 s43, 7, s43
    s_mul_i32 s44, s43, 7
    s_sub_u32 s44, s42, s44
    s_cmp_eq_u32 s43, 7
    s_addc_u32 s44, s44, 0
    s_lshl_b32 s44, s44, 2
    s_lshr_b32 s44, 0x6315420, s44
    s_and_b32 s44, s44, 7
    s_lshl_b32 s44, s44, 3
    s_add_u32 s44, s44, s43
    s_cmp_eq_u32 s53, 2
    s_cselect_b32 s42, s44, s42
    s_mul_i32 s42, s42, s46
    s_add_u32 s93, s42, s52
    s_add_u32 s42, s54, 2
    s_mul_i32 s43, s42, 9363
    s_lshr_b32 s43, s43, 16
    s_cmp_eq_u32 s42, 48
    s_cselect_b32 s43, 7, s43
    s_mul_i32 s44, s43, 7
    s_sub_u32 s44, s42, s44
    s_cmp_eq_u32 s43, 7
    s_addc_u32 s44, s44, 0
    s_lshl_b32 s44, s44, 2
    s_lshr_b32 s44, 0x6315420, s44
    s_and_b32 s44, s44, 7
    s_lshl_b32 s44, s44, 3
    s_add_u32 s44, s44, s43
    s_cmp_eq_u32 s53, 2
    s_cselect_b32 s42, s44, s42
    s_mul_i32 s42, s42, s46
    s_add_u32 s94, s42, s52
    s_add_u32 s42, s54, 3
    s_mul_i32 s43, s42, 9363
    s_lshr_b32 s43, s43, 16
    s_cmp_eq_u32 s42, 48
    s_cselect_b32 s43, 7, s43
    s_mul_i32 s44, s43, 7
    s_sub_u32 s44, s42, s44
    s_cmp_eq_u32 s43, 7
    s_addc_u32 s44, s44, 0
    s_lshl_b32 s44, s44, 2
    s_lshr_b32 s44, 0x6315420, s44
    s_and_b32 s44, s44, 7
    s_lshl_b32 s44, s44, 3
    s_add_u32 s44, s44, s43
    s_cmp_eq_u32 s53, 2
    s_cselect_b32 s42, s44, s42
    s_mul_i32 s42, s42, s46
    s_add_u32 s95, s42, s52
    s_add_u32 s42, s54, 4
    s_mul_i32 s43, s42, 9363
    s_lshr_b32 s43, s43, 16
    s_cmp_eq_u32 s42, 48
    s_cselect_b32 s43, 7, s43
    s_mul_i32 s44, s43, 7
    s_sub_u32 s44, s42, s44
    s_cmp_eq_u32 s43, 7
    s_addc_u32 s44, s44, 0
    s_lshl_b32 s44, s44, 2
    s_lshr_b32 s44, 0x6315420, s44
    s_and_b32 s44, s44, 7
    s_lshl_b32 s44, s44, 3
    s_add_u32 s44, s44, s43
    s_cmp_eq_u32 s53, 2
    s_cselect_b32 s42, s44, s42
    s_mul_i32 s42, s42, s46
    s_add_u32 s96, s42, s52
    s_add_u32 s42, s54, 5
    s_mul_i32 s43, s42, 9363
    s_lshr_b32 s43, s43, 16
    s_cmp_eq_u32 s42, 48
    s_cselect_b32 s43, 7, s43
    s_mul_i32 s44, s43, 7
    s_sub_u32 s44, s42, s44
    s_cmp_eq_u32 s43, 7
    s_addc_u32 s44, s44, 0
    s_lshl_b32 s44, s44, 2
    s_lshr_b32 s44, 0x6315420, s44
    s_and_b32 s44, s44, 7
    s_lshl_b32 s44, s44, 3
    s_add_u32 s44, s44, s43
    s_cmp_eq_u32 s53, 2
    s_cselect_b32 s42, s44, s42
    s_mul_i32 s42, s42, s46
    s_add_u32 s97, s42, s52
    s_add_u32 s42, s54, 6
    s_mul_i32 s43, s42, 9363
    s_lshr_b32 s43, s43, 16
    s_cmp_eq_u32 s42, 48
    s_cselect_b32 s43, 7, s43
    s_mul_i32 s44, s43, 7
    s_sub_u32 s44, s42, s44
    s_cmp_eq_u32 s43, 7
    s_addc_u32 s44, s44, 0
    s_lshl_b32 s44, s44, 2
    s_lshr_b32 s44, 0x6315420, s44
    s_and_b32 s44, s44, 7
    s_lshl_b32 s44, s44, 3
    s_add_u32 s44, s44, s43
    s_cmp_eq_u32 s53, 2
    s_cselect_b32 s42, s44, s42
    s_mul_i32 s42, s42, s46
    s_add_u32 s98, s42, s52
    v_mov_b32 v64, s92
    v_mov_b32 v65, s93
    v_mov_b32 v66, s94
    v_mov_b32 v67, s95
    v_mov_b32 v68, s96
    v_mov_b32 v69, s97
    v_mov_b32 v70, s98
    v_mov_b32 v71, s51
    v_mov_b32 v72, s55
    s_lshl_b32 s42, s33, 6
    s_add_u32 s42, s42, 161280
    v_mov_b32 v73, s42
    s_mov_b64 exec, 1
    ds_write_b128 v73, v[64:67]
    ds_write_b128 v73, v[68:71] offset:16
    ds_write_b32 v73, v72 offset:32
    s_mov_b64 exec, -1
    s_waitcnt lgkmcnt(0)
    v_lshl_add_u32 v25, v9, 3, v8
    v_lshlrev_b32 v25, 3, v25
    s_mul_i32 s62, s31, 10
    s_add_u32 s62, s62, s29
    s_lshl_b32 s62, s62, 2
    s_add_u32 s62, s62, s33
    s_lshl_b32 s62, s62, 8
    s_add_u32 s62, s62, 17842176
    s_cmp_lt_u32 s32, 10
    s_cselect_b32 s43, 0, 0x40000000
    v_add_u32 v25, s43, v25
    v_mov_b32 v16, 0
    v_mov_b32 v17, 0
    v_mov_b32 v18, 0
    v_mov_b32 v19, 0
    v_mov_b32 v20, 0
    v_mov_b32 v21, 0
    v_mov_b32 v22, 0
    v_mov_b32 v23, 0
    v_mov_b32 v24, 0x3f803f80
    s_lshl_b32 s40, s34, 7
    s_add_u32 s40, s40, s36
    s_mul_i32 s41, s34, 245760
    s_add_u32 s41, s41, s37
    s_add_u32 m0, s39, 32768
    s_nop 0
    buffer_load_dwordx4 v4, s[12:15], s40 offen lds
    s_add_u32 m0, s39, 49152
    s_add_u32 s40, s40, 10240
    buffer_load_dwordx4 v3, s[16:19], s41 offen lds
    s_add_u32 s41, s41, 15360
    s_add_u32 m0, s39, 33792
    s_nop 0
    buffer_load_dwordx4 v5, s[12:15], s40 offen lds
    s_add_u32 m0, s39, 50176
    s_add_u32 s40, s40, 10240
    buffer_load_dwordx4 v3, s[16:19], s41 offen lds
    s_add_u32 s41, s41, 15360
    s_add_u32 m0, s39, 34816
    s_nop 0
    buffer_load_dwordx4 v4, s[12:15], s40 offen lds
    s_add_u32 m0, s39, 51200
    s_add_u32 s40, s40, 10240
    buffer_load_dwordx4 v3, s[16:19], s41 offen lds
    s_add_u32 s41, s41, 15360
    s_add_u32 m0, s39, 35840
    s_nop 0
    buffer_load_dwordx4 v5, s[12:15], s40 offen lds
    s_add_u32 m0, s39, 52224
    s_add_u32 s40, s40, 10240
    buffer_load_dwordx4 v3, s[16:19], s41 offen lds
    s_add_u32 s34, s34, 1
    s_cmp_eq_u32 s34, 10
    s_cselect_b32 s34, 0, s34
    s_waitcnt vmcnt(8)
    s_barrier
    ds_read_b128 v[96:99], v15 offset:0
    ds_read_b128 v[100:103], v15 offset:1024
    ds_read_b128 v[104:107], v15 offset:2048
    ds_read_b128 v[108:111], v15 offset:3072
    s_waitcnt lgkmcnt(0)
    v_lshlrev_b32 v112, 16, v96
    v_and_b32 v113, 0xffff0000, v96
    v_lshlrev_b32 v114, 16, v100
    v_and_b32 v115, 0xffff0000, v100
    v_lshlrev_b32 v116, 16, v104
    v_and_b32 v117, 0xffff0000, v104
    v_lshlrev_b32 v118, 16, v108
    v_and_b32 v119, 0xffff0000, v108
    v_add_f32 v16, v16, v112
    v_fmac_f32 v17, v112, v112
    v_add_f32 v18, v18, v114
    v_fmac_f32 v19, v114, v114
    v_add_f32 v20, v20, v116
    v_fmac_f32 v21, v116, v116
    v_add_f32 v22, v22, v118
    v_fmac_f32 v23, v118, v118
    v_add_f32 v16, v16, v113
    v_fmac_f32 v17, v113, v113
    v_add_f32 v18, v18, v115
    v_fmac_f32 v19, v115, v115
    v_add_f32 v20, v20, v117
    v_fmac_f32 v21, v117, v117
    v_add_f32 v22, v22, v119
    v_fmac_f32 v23, v119, v119
    v_lshlrev_b32 v112, 16, v97
    v_and_b32 v113, 0xffff0000, v97
    v_lshlrev_b32 v114, 16, v101
    v_and_b32 v115, 0xffff0000, v101
    v_lshlrev_b32 v116, 16, v105
    v_and_b32 v117, 0xffff0000, v105
    v_lshlrev_b32 v118, 16, v109
    v_and_b32 v119, 0xffff0000, v109
    v_add_f32 v16, v16, v112
    v_fmac_f32 v17, v112, v112
    v_add_f32 v18, v18, v114
    v_fmac_f32 v19, v114, v114
    v_add_f32 v20, v20, v116
    v_fmac_f32 v21, v116, v116
    v_add_f32 v22, v22, v118
    v_fmac_f32 v23, v118, v118
    v_add_f32 v16, v16, v113
    v_fmac_f32 v17, v113, v113
    v_add_f32 v18, v18, v115
    v_fmac_f32 v19, v115, v115
    v_add_f32 v20, v20, v117
    v_fmac_f32 v21, v117, v117
    v_add_f32 v22, v22, v119
    v_fmac_f32 v23, v119, v119
    v_lshlrev_b32 v112, 16, v98
    v_and_b32 v113, 0xffff0000, v98
    v_lshlrev_b32 v114, 16, v102
    v_and_b32 v115, 0xffff0000, v102
    v_lshlrev_b32 v116, 16, v106
    v_and_b32 v117, 0xffff0000, v106
    v_lshlrev_b32 v118, 16, v110
    v_and_b32 v119, 0xffff0000, v110
    v_add_f32 v16, v16, v112
    v_fmac_f32 v17, v112, v112
    v_add_f32 v18, v18, v114
    v_fmac_f32 v19, v114, v114
    v_add_f32 v20, v20, v116
    v_fmac_f32 v21, v116, v116
    v_add_f32 v22, v22, v118
    v_fmac_f32 v23, v118, v118
    v_add_f32 v16, v16, v113
    v_fmac_f32 v17, v113, v113
    v_add_f32 v18, v18, v115
    v_fmac_f32 v19, v115, v115
    v_add_f32 v20, v20, v117
    v_fmac_f32 v21, v117, v117
    v_add_f32 v22, v22, v119
    v_fmac_f32 v23, v119, v119
    v_lshlrev_b32 v112, 16, v99
    v_and_b32 v113, 0xffff0000, v99
    v_lshlrev_b32 v114, 16, v103
    v_and_b32 v115, 0xffff0000, v103
    v_lshlrev_b32 v116, 16, v107
    v_and_b32 v117, 0xffff0000, v107
    v_lshlrev_b32 v118, 16, v111
    v_and_b32 v119, 0xffff0000, v111
    v_add_f32 v16, v16, v112
    v_fmac_f32 v17, v112, v112
    v_add_f32 v18, v18, v114
    v_fmac_f32 v19, v114, v114
    v_add_f32 v20, v20, v116
    v_fmac_f32 v21, v116, v116
    v_add_f32 v22, v22, v118
    v_fmac_f32 v23, v118, v118
    v_add_f32 v16, v16, v113
    v_fmac_f32 v17, v113, v113
    v_add_f32 v18, v18, v115
    v_fmac_f32 v19, v115, v115
    v_add_f32 v20, v20, v117
    v_fmac_f32 v21, v117, v117
    v_add_f32 v22, v22, v119
    v_fmac_f32 v23, v119, v119
    v_add_f32_dpp v16, v16, v16 quad_perm:[1,0,3,2] row_mask:0xf bank_mask:0xf
    v_add_f32_dpp v17, v17, v17 quad_perm:[1,0,3,2] row_mask:0xf bank_mask:0xf
    v_add_f32_dpp v18, v18, v18 quad_perm:[1,0,3,2] row_mask:0xf bank_mask:0xf
    v_add_f32_dpp v19, v19, v19 quad_perm:[1,0,3,2] row_mask:0xf bank_mask:0xf
    v_add_f32_dpp v20, v20, v20 quad_perm:[1,0,3,2] row_mask:0xf bank_mask:0xf
    v_add_f32_dpp v21, v21, v21 quad_perm:[1,0,3,2] row_mask:0xf bank_mask:0xf
    v_add_f32_dpp v22, v22, v22 quad_perm:[1,0,3,2] row_mask:0xf bank_mask:0xf
    v_add_f32_dpp v23, v23, v23 quad_perm:[1,0,3,2] row_mask:0xf bank_mask:0xf
    v_add_f32_dpp v16, v16, v16 quad_perm:[2,3,0,1] row_mask:0xf bank_mask:0xf
    v_add_f32_dpp v17, v17, v17 quad_perm:[2,3,0,1] row_mask:0xf bank_mask:0xf
    v_add_f32_dpp v18, v18, v18 quad_perm:[2,3,0,1] row_mask:0xf bank_mask:0xf
    v_add_f32_dpp v19, v19, v19 quad_perm:[2,3,0,1] row_mask:0xf bank_mask:0xf
    v_add_f32_dpp v20, v20, v20 quad_perm:[2,3,0,1] row_mask:0xf bank_mask:0xf
    v_add_f32_dpp v21, v21, v21 quad_perm:[2,3,0,1] row_mask:0xf bank_mask:0xf
    v_add_f32_dpp v22, v22, v22 quad_perm:[2,3,0,1] row_mask:0xf bank_mask:0xf
    v_add_f32_dpp v23, v23, v23 quad_perm:[2,3,0,1] row_mask:0xf bank_mask:0xf
    v_add_f32_dpp v16, v16, v16 row_half_mirror row_mask:0xf bank_mask:0xf
    v_add_f32_dpp v17, v17, v17 row_half_mirror row_mask:0xf bank_mask:0xf
    v_add_f32_dpp v18, v18, v18 row_half_mirror row_mask:0xf bank_mask:0xf
    v_add_f32_dpp v19, v19, v19 row_half_mirror row_mask:0xf bank_mask:0xf
    v_add_f32_dpp v20, v20, v20 row_half_mirror row_mask:0xf bank_mask:0xf
    v_add_f32_dpp v21, v21, v21 row_half_mirror row_mask:0xf bank_mask:0xf
    v_add_f32_dpp v22, v22, v22 row_half_mirror row_mask:0xf bank_mask:0xf
    v_add_f32_dpp v23, v23, v23 row_half_mirror row_mask:0xf bank_mask:0xf
    v_cmp_eq_u32 vcc, 1, v9
    s_nop 1
    v_cndmask_b32 v16, v16, v18, vcc
    v_cndmask_b32 v17, v17, v19, vcc
    v_cmp_eq_u32 vcc, 2, v9
    s_nop 1
    v_cndmask_b32 v16, v16, v20, vcc
    v_cndmask_b32 v17, v17, v21, vcc
    v_cmp_eq_u32 vcc, 3, v9
    s_nop 1
    v_cndmask_b32 v16, v16, v22, vcc
    v_cndmask_b32 v17, v17, v23, vcc
    s_lshl_b32 s40, s34, 7
    s_add_u32 s40, s40, s36
    s_mul_i32 s41, s34, 245760
    s_add_u32 s41, s41, s37
    s_add_u32 m0, s39, 65536
    s_nop 0
    buffer_load_dwordx4 v4, s[12:15], s40 offen lds
    s_add_u32 m0, s39, 81920
    s_add_u32 s40, s40, 10240
    buffer_load_dwordx4 v3, s[16:19], s41 offen lds
    s_add_u32 s41, s41, 15360
    s_add_u32 m0, s39, 66560
    s_nop 0
    buffer_load_dwordx4 v5, s[12:15], s40 offen lds
    s_add_u32 m0, s39, 82944
    s_add_u32 s40, s40, 10240
    buffer_load_dwordx4 v3, s[16:19], s41 offen lds
    s_add_u32 s41, s41, 15360
    s_add_u32 m0, s39, 67584
    s_nop 0
    buffer_load_dwordx4 v4, s[12:15], s40 offen lds
    s_add_u32 m0, s39, 83968
    s_add_u32 s40, s40, 10240
    buffer_load_dwordx4 v3, s[16:19], s41 offen lds
    s_add_u32 s41, s41, 15360
    s_add_u32 m0, s39, 68608
    s_nop 0
    buffer_load_dwordx4 v5, s[12:15], s40 offen lds
    s_add_u32 m0, s39, 84992
    s_add_u32 s40, s40, 10240
    buffer_load_dwordx4 v3, s[16:19], s41 offen lds
    s_add_u32 s34, s34, 1
    s_cmp_eq_u32 s34, 10
    s_cselect_b32 s34, 0, s34
    s_mov_b32 exec_lo, 0x0f0f0f0f
    s_mov_b32 exec_hi, 0x0f0f0f0f
    buffer_store_dwordx2 v[16:17], v25, s[20:23], s62 offen sc1
    s_mov_b64 exec, -1
    s_waitcnt vmcnt(9)
    s_barrier
    s_lshl_b32 s40, s34, 7
    s_add_u32 s40, s40, s36
    s_mul_i32 s41, s34, 245760
    s_add_u32 s41, s41, s37
    s_add_u32 m0, s39, 98304
    s_nop 0
    buffer_load_dwordx4 v4, s[12:15], s40 offen lds
    s_add_u32 m0, s39, 114688
    s_add_u32 s40, s40, 10240
    buffer_load_dwordx4 v3, s[16:19], s41 offen lds
    s_add_u32 s41, s41, 15360
    s_add_u32 m0, s39, 99328
    s_nop 0
    buffer_load_dwordx4 v5, s[12:15], s40 offen lds
    s_add_u32 m0, s39, 115712
    s_add_u32 s40, s40, 10240
    buffer_load_dwordx4 v3, s[16:19], s41 offen lds
    s_add_u32 s41, s41, 15360
    s_add_u32 m0, s39, 100352
    s_nop 0
    buffer_load_dwordx4 v4, s[12:15], s40 offen lds
    s_add_u32 m0, s39, 116736
    s_add_u32 s40, s40, 10240
    buffer_load_dwordx4 v3, s[16:19], s41 offen lds
    s_add_u32 s41, s41, 15360
    s_add_u32 m0, s39, 101376
    s_nop 0
    buffer_load_dwordx4 v5, s[12:15], s40 offen lds
    s_add_u32 m0, s39, 117760
    s_add_u32 s40, s40, 10240
    buffer_load_dwordx4 v3, s[16:19], s41 offen lds
    s_add_u32 s34, s34, 1
    s_cmp_eq_u32 s34, 10
    s_cselect_b32 s34, 0, s34
    s_waitcnt vmcnt(9)
    s_barrier
    s_lshl_b32 s40, s34, 7
    s_add_u32 s40, s40, s36
    s_mul_i32 s41, s34, 245760
    s_add_u32 s41, s41, s37
    s_add_u32 m0, s39, 0
    s_nop 0
    buffer_load_dwordx4 v4, s[12:15], s40 offen lds
    s_add_u32 m0, s39, 16384
    s_add_u32 s40, s40, 10240
    buffer_load_dwordx4 v3, s[16:19], s41 offen lds
    s_add_u32 s41, s41, 15360
    s_add_u32 m0, s39, 1024
    s_nop 0
    buffer_load_dwordx4 v5, s[12:15], s40 offen lds
    s_add_u32 m0, s39, 17408
    s_add_u32 s40, s40, 10240
    buffer_load_dwordx4 v3, s[16:19], s41 offen lds
    s_add_u32 s41, s41, 15360
    s_add_u32 m0, s39, 2048
    s_nop 0
    buffer_load_dwordx4 v4, s[12:15], s40 offen lds
    s_add_u32 m0, s39, 18432
    s_add_u32 s40, s40, 10240
    buffer_load_dwordx4 v3, s[16:19], s41 offen lds
    s_add_u32 s41, s41, 15360
    s_add_u32 m0, s39, 3072
    s_nop 0
    buffer_load_dwordx4 v5, s[12:15], s40 offen lds
    s_add_u32 m0, s39, 19456
    s_add_u32 s40, s40, 10240
    buffer_load_dwordx4 v3, s[16:19], s41 offen lds
    s_add_u32 s34, s34, 1
    s_cmp_eq_u32 s34, 10
    s_cselect_b32 s34, 0, s34
    s_buffer_load_dword s64, s[76:79], 0
    s_waitcnt vmcnt(8)
    s_cmp_lg_u32 s30, 4
    s_cbranch_scc1 L_nz
    s_waitcnt lgkmcnt(0)
    s_cmp_lt_u32 s64, 64
    s_cbranch_scc1 L_zr5
L_zq4:
L_nz:
    s_barrier
    s_lshl_b32 s40, s34, 7
    s_add_u32 s40, s40, s36
    s_mul_i32 s41, s34, 245760
    s_add_u32 s41, s41, s37
    s_add_u32 m0, s39, 32768
    s_nop 0
    buffer_load_dwordx4 v4, s[12:15], s40 offen lds
    s_add_u32 m0, s39, 49152
    s_add_u32 s40, s40, 10240
    buffer_load_dwordx4 v3, s[16:19], s41 offen lds
    s_add_u32 s41, s41, 15360
    s_add_u32 m0, s39, 33792
    s_nop 0
    buffer_load_dwordx4 v5, s[12:15], s40 offen lds
    s_add_u32 m0, s39, 50176
    s_add_u32 s40, s40, 10240
    buffer_load_dwordx4 v3, s[16:19], s41 offen lds
    s_add_u32 s41, s41, 15360
    s_add_u32 m0, s39, 34816
    s_nop 0
    buffer_load_dwordx4 v4, s[12:15], s40 offen lds
    s_add_u32 m0, s39, 51200
    s_add_u32 s40, s40, 10240
    buffer_load_dwordx4 v3, s[16:19], s41 offen lds
    s_add_u32 s41, s41, 15360
    s_add_u32 m0, s39, 35840
    s_nop 0
    buffer_load_dwordx4 v5, s[12:15], s40 offen lds
    s_add_u32 m0, s39, 52224
    s_add_u32 s40, s40, 10240
    buffer_load_dwordx4 v3, s[16:19], s41 offen lds
    s_add_u32 s34, s34, 1
    s_cmp_eq_u32 s34, 10
    s_cselect_b32 s34, 0, s34
    s_lshl_b32 s42, s33, 10
    s_add_u32 s42, s42, 131072
    s_lshl_b32 s43, s50, 5
    s_mov_b32 s44, s49
    s_add_u32 m0, s42, 0
    s_nop 0
    buffer_load_dwordx4 v13, s[24:27], s44 offen nt lds
    s_add_u32 s44, s44, s43
    s_add_u32 m0, s42, 4096
    s_nop 0
    buffer_load_dwordx4 v13, s[24:27], s44 offen nt lds
    s_add_u32 s44, s44, s43
    s_add_u32 m0, s42, 8192
    s_nop 0
    buffer_load_dwordx4 v13, s[24:27], s44 offen nt lds
    s_add_u32 s44, s44, s43
    s_add_u32 m0, s42, 12288
    s_nop 0
    buffer_load_dwordx4 v13, s[24:27], s44 offen nt lds
    s_add_u32 s44, s44, s43
    s_add_u32 m0, s42, 16384
    s_nop 0
    buffer_load_dwordx4 v13, s[24:27], s44 offen nt lds
    s_cmp_eq_u32 s51, 5
    s_cselect_b32 s43, 0, s43
    s_add_u32 s44, s44, s43
    s_add_u32 m0, s42, 20480
    s_nop 0
    buffer_load_dwordx4 v13, s[24:27], s44 offen nt lds
    s_cmp_eq_u32 s51, 6
    s_cselect_b32 s43, 0, s43
    s_add_u32 s44, s44, s43
    s_add_u32 m0, s42, 24576
    s_nop 0
    buffer_load_dwordx4 v13, s[24:27], s44 offen nt lds
    s_waitcnt vmcnt(15)
    s_barrier
    s_lshl_b32 s40, s34, 7
    s_add_u32 s40, s40, s36
    s_mul_i32 s41, s34, 245760
    s_add_u32 s41, s41, s37
    s_add_u32 m0, s39, 65536
    s_nop 0
    buffer_load_dwordx4 v4, s[12:15], s40 offen lds
    s_add_u32 m0, s39, 81920
    s_add_u32 s40, s40, 10240
    buffer_load_dwordx4 v3, s[16:19], s41 offen lds
    s_add_u32 s41, s41, 15360
    s_add_u32 m0, s39, 66560
    s_nop 0
    buffer_load_dwordx4 v5, s[12:15], s40 offen lds
    s_add_u32 m0, s39, 82944
    s_add_u32 s40, s40, 10240
    buffer_load_dwordx4 v3, s[16:19], s41 offen lds
    s_add_u32 s41, s41, 15360
    s_add_u32 m0, s39, 67584
    s_nop 0
    buffer_load_dwordx4 v4, s[12:15], s40 offen lds
    s_add_u32 m0, s39, 83968
    s_add_u32 s40, s40, 10240
    buffer_load_dwordx4 v3, s[16:19], s41 offen lds
    s_add_u32 s41, s41, 15360
    s_add_u32 m0, s39, 68608
    s_nop 0
    buffer_load_dwordx4 v5, s[12:15], s40 offen lds
    s_add_u32 m0, s39, 84992
    s_add_u32 s40, s40, 10240
    buffer_load_dwordx4 v3, s[16:19], s41 offen lds
    s_add_u32 s34, s34, 1
    s_cmp_eq_u32 s34, 10
    s_cselect_b32 s34, 0, s34
    s_waitcnt vmcnt(15)
    s_barrier
    s_lshl_b32 s40, s34, 7
    s_add_u32 s40, s40, s36
    s_mul_i32 s41, s34, 245760
    s_add_u32 s41, s41, s37
    s_add_u32 m0, s39, 98304
    s_nop 0
    buffer_load_dwordx4 v4, s[12:15], s40 offen lds
    s_add_u32 m0, s39, 114688
    s_add_u32 s40, s40, 10240
    buffer_load_dwordx4 v3, s[16:19], s41 offen lds
    s_add_u32 s41, s41, 15360
    s_add_u32 m0, s39, 99328
    s_nop 0
    buffer_load_dwordx4 v5, s[12:15], s40 offen lds
    s_add_u32 m0, s39, 115712
    s_add_u32 s40, s40, 10240
    buffer_load_dwordx4 v3, s[16:19], s41 offen lds
    s_add_u32 s41, s41, 15360
    s_add_u32 m0, s39, 100352
    s_nop 0
    buffer_load_dwordx4 v4, s[12:15], s40 offen lds
    s_add_u32 m0, s39, 116736
    s_add_u32 s40, s40, 10240
    buffer_load_dwordx4 v3, s[16:19], s41 offen lds
    s_add_u32 s41, s41, 15360
    s_add_u32 m0, s39, 101376
    s_nop 0
    buffer_load_dwordx4 v5, s[12:15], s40 offen lds
    s_add_u32 m0, s39, 117760
    s_add_u32 s40, s40, 10240
    buffer_load_dwordx4 v3, s[16:19], s41 offen lds
    s_add_u32 s34, s34, 1
    s_cmp_eq_u32 s34, 10
    s_cselect_b32 s34, 0, s34
    s_waitcnt vmcnt(8)
    s_barrier
    s_lshl_b32 s40, s34, 7
    s_add_u32 s40, s40, s36
    s_mul_i32 s41, s34, 245760
    s_add_u32 s41, s41, s37
    s_add_u32 m0, s39, 0
    s_nop 0
    buffer_load_dwordx4 v4, s[12:15], s40 offen lds
    s_add_u32 m0, s39, 16384
    s_add_u32 s40, s40, 10240
    buffer_load_dwordx4 v3, s[16:19], s41 offen lds
    s_add_u32 s41, s41, 15360
    s_add_u32 m0, s39, 1024
    s_nop 0
    buffer_load_dwordx4 v5, s[12:15], s40 offen lds
    s_add_u32 m0, s39, 17408
    s_add_u32 s40, s40, 10240
    buffer_load_dwordx4 v3, s[16:19], s41 offen lds
    s_add_u32 s41, s41, 15360
    s_add_u32 m0, s39, 2048
    s_nop 0
    buffer_load_dwordx4 v4, s[12:15], s40 offen lds
    s_add_u32 m0, s39, 18432
    s_add_u32 s40, s40, 10240
    buffer_load_dwordx4 v3, s[16:19], s41 offen lds
    s_add_u32 s41, s41, 15360
    s_add_u32 m0, s39, 3072
    s_nop 0
    buffer_load_dwordx4 v5, s[12:15], s40 offen lds
    s_add_u32 m0, s39, 19456
    s_add_u32 s40, s40, 10240
    buffer_load_dwordx4 v3, s[16:19], s41 offen lds
    s_add_u32 s34, s34, 1
    s_cmp_eq_u32 s34, 10
    s_cselect_b32 s34, 0, s34
    s_waitcnt vmcnt(8)
    s_barrier
    s_lshl_b32 s40, s34, 7
    s_add_u32 s40, s40, s36
    s_mul_i32 s41, s34, 245760
    s_add_u32 s41, s41, s37
    s_add_u32 m0, s39, 32768
    s_nop 0
    buffer_load_dwordx4 v4, s[12:15], s40 offen lds
    s_add_u32 m0, s39, 49152
    s_add_u32 s40, s40, 10240
    buffer_load_dwordx4 v3, s[16:19], s41 offen lds
    s_add_u32 s41, s41, 15360
    s_add_u32 m0, s39, 33792
    s_nop 0
    buffer_load_dwordx4 v5, s[12:15], s40 offen lds
    s_add_u32 m0, s39, 50176
    s_add_u32 s40, s40, 10240
    buffer_load_dwordx4 v3, s[16:19], s41 offen lds
    s_add_u32 s41, s41, 15360
    s_add_u32 m0, s39, 34816
    s_nop 0
    buffer_load_dwordx4 v4, s[12:15], s40 offen lds
    s_add_u32 m0, s39, 51200
    s_add_u32 s40, s40, 10240
    buffer_load_dwordx4 v3, s[16:19], s41 offen lds
    s_add_u32 s41, s41, 15360
    s_add_u32 m0, s39, 35840
    s_nop 0
    buffer_load_dwordx4 v5, s[12:15], s40 offen lds
    s_add_u32 m0, s39, 52224
    s_add_u32 s40, s40, 10240
    buffer_load_dwordx4 v3, s[16:19], s41 offen lds
    s_add_u32 s34, s34, 1
    s_cmp_eq_u32 s34, 10
    s_cselect_b32 s34, 0, s34
    s_and_b32 s56, s33, 1
    s_mul_i32 s56, s56, 5
    s_lshl_b32 s57, s31, 4
    s_add_u32 s57, s57, s56
    s_lshl_b32 s56, s56, 4
    s_add_u32 s56, s56, s32
    s_cmp_lt_u32 s33, 2
    s_cselect_b32 s56, s57, s56
    s_mov_b32 s70, 2048
    s_cmov_b32 s70, 128
    s_lshl_b32 s56, s56, 7
    s_add_u32 s56, s56, 18171904
    s_add_u32 s57, s56, s70
    s_add_u32 s58, s57, s70
    s_add_u32 s59, s58, s70
    s_add_u32 s60, s59, s70
    s_buffer_load_dword s64, s[20:23], s56
    s_buffer_load_dword s65, s[20:23], s57
    s_buffer_load_dword s66, s[20:23], s58
    s_buffer_load_dword s67, s[20:23], s59
    s_buffer_load_dword s68, s[20:23], s60
    s_lshr_b32 s62, s2, 5
    s_mul_i32 s61, s62, 5
    s_and_b32 s61, s61, 0xfc
    s_lshl_b32 s61, s61, 7
    s_add_u32 s61, s61, 18130944
    s_mul_i32 s62, s62, 880640
    s_mul_i32 s63, s33, 12288
    s_add_u32 s62, s62, s63
    s_add_u32 s62, s62, 10752000
    s_buffer_load_dword s88, s[20:23], s61 offset:0
    s_buffer_load_dword s89, s[20:23], s61 offset:128
    s_buffer_load_dword s90, s[20:23], s61 offset:256
    s_buffer_load_dword s91, s[20:23], s61 offset:384
    s_buffer_load_dword s92, s[20:23], s61 offset:512
    s_buffer_load_dword s93, s[20:23], s61 offset:640
    s_buffer_load_dword s94, s[20:23], s61 offset:768
    s_buffer_load_dword s95, s[20:23], s61 offset:896
    s_waitcnt vmcnt(8)
    s_waitcnt lgkmcnt(0)
    s_min_u32 s64, s64, s65
    s_min_u32 s64, s64, s66
    s_min_u32 s64, s64, s67
    s_min_u32 s64, s64, s68
    s_cmp_lt_u32 s64, 1
    s_cbranch_scc1 L_zr14
L_zq13:
    s_waitcnt lgkmcnt(0)
    s_min_u32 s88, s88, s89
    s_min_u32 s88, s88, s90
    s_min_u32 s88, s88, s91
    s_min_u32 s88, s88, s92
    s_min_u32 s88, s88, s93
    s_min_u32 s88, s88, s94
    s_min_u32 s88, s88, s95
    s_cmp_lt_u32 s88, 1
    s_cbranch_scc1 L_zr17
L_zq16:
    s_barrier
    s_mul_i32 s42, s31, 10240
    s_lshl_b32 s43, s33, 8
    s_add_u32 s42, s42, s43
    s_add_u32 s42, s42, 17842176
    s_add_u32 s44, s42, 4096
    s_mul_i32 s43, s32, 5120
    s_lshl_b32 s46, s33, 7
    s_add_u32 s43, s43, s46
    s_add_u32 s43, s43, 18006016
    buffer_load_dwordx2 v[16:17], v51, s[20:23], s42 offen offset:0 sc1
    buffer_load_dwordx2 v[18:19], v51, s[20:23], s42 offen offset:1024 sc1
    buffer_load_dwordx2 v[20:21], v51, s[20:23], s42 offen offset:2048 sc1
    buffer_load_dwordx2 v[22:23], v51, s[20:23], s42 offen offset:3072 sc1
    buffer_load_dwordx2 v[24:25], v51, s[20:23], s44 offen offset:0 sc1
    buffer_load_dword v26, v52, s[20:23], s43 offen offset:0 sc1
    buffer_load_dword v27, v52, s[20:23], s43 offen offset:512 sc1
    buffer_load_dword v28, v52, s[20:23], s43 offen offset:1024 sc1
    buffer_load_dword v29, v52, s[20:23], s43 offen offset:1536 sc1
    buffer_load_dword v30, v52, s[20:23], s43 offen offset:2048 sc1
    s_add_u32 s46, s62, 0
    buffer_load_dwordx4 v[128:131], v14, s[20:23], s46 offen sc1
    s_add_u32 s46, s62, 1024
    buffer_load_dwordx4 v[132:135], v14, s[20:23], s46 offen sc1
    s_add_u32 s46, s62, 2048
    buffer_load_dwordx4 v[136:139], v14, s[20:23], s46 offen sc1
    s_add_u32 s46, s62, 3072
    buffer_load_dwordx4 v[140:143], v14, s[20:23], s46 offen sc1
    s_waitcnt vmcnt(14)
    s_barrier
    s_waitcnt vmcnt(4)
    v_add_f32 v16, v16, v18
    v_add_f32 v17, v17, v19
    v_add_f32 v26, v26, v27
    v_add_f32 v16, v16, v20
    v_add_f32 v17, v17, v21
    v_add_f32 v26, v26, v28
    v_add_f32 v16, v16, v22
    v_add_f32 v17, v17, v23
    v_add_f32 v26, v26, v29
    v_add_f32 v16, v16, v24
    v_add_f32 v17, v17, v25
    v_add_f32 v26, v26, v30
    v_mov_b32 v18, v16
    v_mov_b32 v19, v17
    v_mov_b32 v27, v26
    v_permlane32_swap_b32 v16, v18
    v_permlane32_swap_b32 v17, v19
    v_permlane32_swap_b32 v26, v27
    v_add_f32 v16, v16, v18
    v_add_f32 v17, v17, v19
    v_add_f32 v26, v26, v27
    v_mul_f32 v16, 0x3acccccd, v16
    v_mul_f32 v17, 0x3acccccd, v17
    v_fma_f32 v17, -v16, v16, v17
    v_max_f32 v17, 0, v17
    v_add_f32 v17, 0x3727c5ac, v17
    v_rsq_f32 v17, v17
    s_cmp_lt_u32 s32, 5
    s_cselect_b32 s41, 0x3ea52b5c, 1.0
    s_lshl_b32 s42, s33, 7
    s_add_u32 s42, s42, 159744
    v_and_b32 v18, 31, v1
    v_lshl_add_u32 v18, v18, 2, s42
    v_mul_f32 v17, s41, v17
    v_mul_f32 v16, v16, v17
    ds_write_b32 v18, v17
    ds_write_b32 v18, v16 offset:512
    ds_write_b32 v18, v26 offset:1024
    s_waitcnt lgkmcnt(0)
    s_waitcnt vmcnt(7)
    s_add_u32 s46, s62, 4096
    buffer_load_dwordx4 v[144:147], v14, s[20:23], s46 offen sc1
    s_waitcnt vmcnt(7)
    s_add_u32 s46, s62, 5120
    buffer_load_dwordx4 v[148:151], v14, s[20:23], s46 offen sc1
    s_waitcnt vmcnt(7)
    s_add_u32 s46, s62, 6144
    buffer_load_dwordx4 v[152:155], v14, s[20:23], s46 offen sc1
    s_waitcnt vmcnt(7)
    s_add_u32 s46, s62, 7168
    buffer_load_dwordx4 v[156:159], v14, s[20:23], s46 offen sc1
    s_waitcnt vmcnt(7)
    s_add_u32 s46, s62, 8192
    buffer_load_dwordx4 v[160:163], v14, s[20:23], s46 offen sc1
    s_waitcnt vmcnt(7)
    s_add_u32 s46, s62, 9216
    buffer_load_dwordx4 v[164:167], v14, s[20:23], s46 offen sc1
    s_waitcnt vmcnt(7)
    s_add_u32 s46, s62, 10240
    buffer_load_dwordx4 v[168:171], v14, s[20:23], s46 offen sc1
    s_waitcnt vmcnt(7)
    s_add_u32 s46, s62, 11264
    buffer_load_dwordx4 v[172:175], v14, s[20:23], s46 offen sc1
    s_barrier
    s_and_b32 s42, s2, 7
    s_lshl_b32 s43, s42, 11
    s_add_u32 s43, s43, 18096128
    s_lshl_b32 s44, s42, 10
    s_add_u32 s44, s44, 18087936
    s_cmp_eq_u32 s33, 0
    s_cselect_b32 s43, s43, s44
    s_cselect_b32 s45, 5, 4
    s_lshl_b32 s44, s42, 5
    s_lshr_b32 s42, s2, 3
    s_add_u32 s44, s44, s42
    s_lshl_b32 s44, s44, 10
    s_add_u32 s44, s44, 10485760
    s_cmp_ge_u32 s33, 2
    s_cselect_b32 s43, s44, s43
    v_lshlrev_b32 v124, s45, v1
    buffer_load_dword v120, v124, s[20:23], s43 offen sc1
    v_add_u32 v12, s63, v14
    s_waitcnt vmcnt(12)
    ds_write_b128 v12, v[128:131] offset:0
    s_waitcnt vmcnt(11)
    ds_write_b128 v12, v[132:135] offset:1024
    s_waitcnt vmcnt(10)
    ds_write_b128 v12, v[136:139] offset:2048
    s_waitcnt vmcnt(9)
    ds_write_b128 v12, v[140:143] offset:3072
    s_waitcnt vmcnt(8)
    ds_write_b128 v12, v[144:147] offset:4096
    s_waitcnt vmcnt(7)
    ds_write_b128 v12, v[148:151] offset:5120
    s_waitcnt vmcnt(6)
    ds_write_b128 v12, v[152:155] offset:6144
    s_waitcnt vmcnt(5)
    ds_write_b128 v12, v[156:159] offset:7168
    s_waitcnt vmcnt(4)
    ds_write_b128 v12, v[160:163] offset:8192
    s_waitcnt vmcnt(3)
    ds_write_b128 v12, v[164:167] offset:9216
    s_waitcnt vmcnt(2)
    ds_write_b128 v12, v[168:171] offset:10240
    s_waitcnt vmcnt(1)
    ds_write_b128 v12, v[172:175] offset:11264
L_k1_wo:
    s_branch L_loader
L_k1_spare_h:
    s_load_dwordx2 s[10:11], s[0:1], 16
    v_mul_u32_u24 v13, 1280, v8
    v_lshl_add_u32 v13, v9, 4, v13
    s_and_b32 s69, s31, 3
    s_lshr_b32 s68, s31, 2
    s_mul_i32 s49, s69, 20
    s_add_u32 s49, s49, s33
    s_mul_i32 s49, s49, 10240
    s_lshl_b32 s42, s68, 7
    s_add_u32 s49, s49, s42
    s_lshl_b32 s42, s33, 10
    s_mov_b32 s26, 819200
    s_mov_b32 s27, 0x20000
    s_waitcnt lgkmcnt(0)
    s_mov_b32 s24, s10
    s_and_b32 s25, s11, 0xffff
    s_add_u32 m0, s42, 0
    s_add_u32 s44, s49, 0
    buffer_load_dwordx4 v13, s[24:27], s44 offen nt lds
    s_add_u32 m0, s42, 4096
    s_add_u32 s44, s49, 40960
    buffer_load_dwordx4 v13, s[24:27], s44 offen nt lds
    s_add_u32 m0, s42, 8192
    s_add_u32 s44, s49, 81920
    buffer_load_dwordx4 v13, s[24:27], s44 offen nt lds
    s_add_u32 m0, s42, 12288
    s_add_u32 s44, s49, 122880
    buffer_load_dwordx4 v13, s[24:27], s44 offen nt lds
    s_add_u32 m0, s42, 16384
    s_add_u32 s44, s49, 163840
    buffer_load_dwordx4 v13, s[24:27], s44 offen nt lds
    s_add_u32 m0, s42, 20480
    s_add_u32 s44, s49, 512
    buffer_load_dwordx4 v13, s[24:27], s44 offen nt lds
    s_add_u32 m0, s42, 24576
    s_add_u32 s44, s49, 41472
    buffer_load_dwordx4 v13, s[24:27], s44 offen nt lds
    s_add_u32 m0, s42, 28672
    s_add_u32 s44, s49, 82432
    buffer_load_dwordx4 v13, s[24:27], s44 offen nt lds
    s_add_u32 m0, s42, 32768
    s_add_u32 s44, s49, 123392
    buffer_load_dwordx4 v13, s[24:27], s44 offen nt lds
    s_add_u32 m0, s42, 36864
    s_add_u32 s44, s49, 164352
    buffer_load_dwordx4 v13, s[24:27], s44 offen nt lds
    s_cmp_ge_u32 s31, 8
    s_cbranch_scc1 L_sw1
    s_add_u32 m0, s42, 40960
    s_add_u32 s44, s49, 1024
    buffer_load_dwordx4 v13, s[24:27], s44 offen nt lds
    s_add_u32 m0, s42, 45056
    s_add_u32 s44, s49, 41984
    buffer_load_dwordx4 v13, s[24:27], s44 offen nt lds
    s_add_u32 m0, s42, 49152
    s_add_u32 s44, s49, 82944
    buffer_load_dwordx4 v13, s[24:27], s44 offen nt lds
    s_add_u32 m0, s42, 53248
    s_add_u32 s44, s49, 123904
    buffer_load_dwordx4 v13, s[24:27], s44 offen nt lds
    s_add_u32 m0, s42, 57344
    s_add_u32 s44, s49, 164864
    buffer_load_dwordx4 v13, s[24:27], s44 offen nt lds
L_sw1:
    s_setprio 0
    s_load_dwordx2 s[10:11], s[0:1], 16
    s_load_dwordx8 s[56:63], s[0:1], 32
    v_lshlrev_b32 v14, 4, v1
    v_mov_b32 v2, 0
    s_waitcnt lgkmcnt(0)
    s_mov_b32 s20, s74
    s_and_b32 s21, s75, 0xffff
    s_mov_b32 s22, 18219008
    s_mov_b32 s23, 0x20000
    s_mov_b32 s76, s72
    s_and_b32 s77, s73, 0xffff
    s_mov_b32 s78, 256
    s_mov_b32 s79, 0x20000
    v_mov_b32 v13, 161856
    ds_write_b32 v13, v2
    ds_write_b32 v13, v2 offset:4
    ds_write_b32 v13, v2 offset:8
    ds_write_b32 v13, v2 offset:12
    ds_write_b32 v13, v2 offset:32
    ds_write_b32 v13, v2 offset:36
    ds_write_b32 v13, v2 offset:40
    ds_write_b32 v13, v2 offset:44
    ds_write_b32 v13, v2 offset:48
    ds_write_b32 v13, v2 offset:52
    ds_write_b32 v13, v2 offset:56
    ds_write_b32 v13, v2 offset:60
    s_waitcnt lgkmcnt(0)
    v_bfe_u32 v11, v1, 2, 2
    v_lshrrev_b32 v6, 1, v10
    v_mul_u32_u24 v6, 20, v6
    v_and_b32 v7, 1, v10
    v_lshl_add_u32 v6, v7, 2, v6
    v_add_u32 v6, v6, v11
    v_mul_u32_u24 v7, 40, v10
    v_add3_u32 v7, v7, v11, 16
    v_and_b32 v12, 3, v1
    v_lshlrev_b32 v12, 4, v12
    s_lshr_b32 s42, s33, 1
    s_lshl_b32 s42, s42, 6
    s_and_b32 s43, s33, 1
    s_lshl_b32 s43, s43, 3
    s_add_u32 s42, s42, s43
    v_add_u32 v12, s42, v12
    v_lshl_add_u32 v6, v6, 7, v12
    v_lshl_add_u32 v7, v7, 7, v12
    s_lshl_b32 s42, s68, 2
    s_add_u32 s42, s42, s33
    s_add_u32 s42, s42, 0
    s_mul_i32 s43, s42, 52429
    s_lshr_b32 s43, s43, 18
    s_mul_i32 s44, s43, 5
    s_sub_u32 s44, s42, s44
    s_cmp_eq_u32 s44, 0
    s_cselect_b32 s45, 4, -1
    s_bitcmp1_b32 s43, 0
    s_cselect_b32 s45, s45, 0
    s_add_u32 s44, s44, s45
    s_lshl_b32 s44, s44, 10
    s_mul_i32 s43, s43, 880640
    s_add_u32 s43, s43, s44
    s_mul_i32 s44, s69, 25600
    s_add_u32 s43, s43, s44
    s_add_u32 s92, s43, 10752000
    s_lshl_b32 s42, s68, 2
    s_add_u32 s42, s42, s33
    s_add_u32 s42, s42, 16
    s_mul_i32 s43, s42, 52429
    s_lshr_b32 s43, s43, 18
    s_mul_i32 s44, s43, 5
    s_sub_u32 s44, s42, s44
    s_cmp_eq_u32 s44, 0
    s_cselect_b32 s45, 4, -1
    s_bitcmp1_b32 s43, 0
    s_cselect_b32 s45, s45, 0
    s_add_u32 s44, s44, s45
    s_lshl_b32 s44, s44, 10
    s_mul_i32 s43, s43, 880640
    s_add_u32 s43, s43, s44
    s_mul_i32 s44, s69, 25600
    s_add_u32 s43, s43, s44
    s_add_u32 s93, s43, 10752000
    s_lshl_b32 s42, s68, 2
    s_add_u32 s42, s42, s33
    s_add_u32 s42, s42, 32
    s_mul_i32 s43, s42, 52429
    s_lshr_b32 s43, s43, 18
    s_mul_i32 s44, s43, 5
    s_sub_u32 s44, s42, s44
    s_cmp_eq_u32 s44, 0
    s_cselect_b32 s45, 4, -1
    s_bitcmp1_b32 s43, 0
    s_cselect_b32 s45, s45, 0
    s_add_u32 s44, s44, s45
    s_lshl_b32 s44, s44, 10
    s_mul_i32 s43, s43, 880640
    s_add_u32 s43, s43, s44
    s_mul_i32 s44, s69, 25600
    s_add_u32 s43, s43, s44
    s_add_u32 s94, s43, 10752000
    s_waitcnt vmcnt(0)
    s_barrier
    ds_read_b64_tr_b16 v[64:65], v6 offset:0
    ds_read_b64_tr_b16 v[66:67], v6 offset:1024
    ds_read_b64_tr_b16 v[68:69], v6 offset:5120
    ds_read_b64_tr_b16 v[70:71], v6 offset:6144
    ds_read_b64_tr_b16 v[72:73], v6 offset:10240
    ds_read_b64_tr_b16 v[74:75], v6 offset:11264
    ds_read_b64_tr_b16 v[76:77], v6 offset:15360
    ds_read_b64_tr_b16 v[78:79], v6 offset:16384
    ds_read_b64_tr_b16 v[80:81], v7 offset:0
    ds_read_b64_tr_b16 v[82:83], v7 offset:2560
    ds_read_b64_tr_b16 v[84:85], v6 offset:20480
    ds_read_b64_tr_b16 v[86:87], v6 offset:21504
    ds_read_b64_tr_b16 v[88:89], v6 offset:25600
    ds_read_b64_tr_b16 v[90:91], v6 offset:26624
    ds_read_b64_tr_b16 v[92:93], v6 offset:30720
    ds_read_b64_tr_b16 v[94:95], v6 offset:31744
    ds_read_b64_tr_b16 v[96:97], v6 offset:35840
    ds_read_b64_tr_b16 v[98:99], v6 offset:36864
    ds_read_b64_tr_b16 v[100:101], v7 offset:20480
    ds_read_b64_tr_b16 v[102:103], v7 offset:23040
    ds_read_b64_tr_b16 v[104:105], v6 offset:40960
    ds_read_b64_tr_b16 v[106:107], v6 offset:41984
    ds_read_b64_tr_b16 v[108:109], v6 offset:46080
    ds_read_b64_tr_b16 v[110:111], v6 offset:47104
    ds_read_b64_tr_b16 v[112:113], v6 offset:51200
    ds_read_b64_tr_b16 v[114:115], v6 offset:52224
    ds_read_b64_tr_b16 v[116:117], v6 offset:56320
    ds_read_b64_tr_b16 v[118:119], v6 offset:57344
    ds_read_b64_tr_b16 v[120:121], v7 offset:40960
    ds_read_b64_tr_b16 v[122:123], v7 offset:43520
    s_waitcnt lgkmcnt(0)
    s_add_u32 s44, s92, 0
    buffer_store_dwordx4 v[64:67], v14, s[20:23], s44 offen sc1
    s_add_u32 s44, s92, 5120
    buffer_store_dwordx4 v[68:71], v14, s[20:23], s44 offen sc1
    s_add_u32 s44, s92, 10240
    buffer_store_dwordx4 v[72:75], v14, s[20:23], s44 offen sc1
    s_add_u32 s44, s92, 15360
    buffer_store_dwordx4 v[76:79], v14, s[20:23], s44 offen sc1
    s_add_u32 s44, s92, 20480
    buffer_store_dwordx4 v[80:83], v14, s[20:23], s44 offen sc1
    s_add_u32 s44, s93, 0
    buffer_store_dwordx4 v[84:87], v14, s[20:23], s44 offen sc1
    s_add_u32 s44, s93, 5120
    buffer_store_dwordx4 v[88:91], v14, s[20:23], s44 offen sc1
    s_add_u32 s44, s93, 10240
    buffer_store_dwordx4 v[92:95], v14, s[20:23], s44 offen sc1
    s_add_u32 s44, s93, 15360
    buffer_store_dwordx4 v[96:99], v14, s[20:23], s44 offen sc1
    s_add_u32 s44, s93, 20480
    buffer_store_dwordx4 v[100:103], v14, s[20:23], s44 offen sc1
    s_cmp_ge_u32 s31, 8
    s_cbranch_scc1 L_sw2
    s_add_u32 s44, s94, 0
    buffer_store_dwordx4 v[104:107], v14, s[20:23], s44 offen sc1
    s_add_u32 s44, s94, 5120
    buffer_store_dwordx4 v[108:111], v14, s[20:23], s44 offen sc1
    s_add_u32 s44, s94, 10240
    buffer_store_dwordx4 v[112:115], v14, s[20:23], s44 offen sc1
    s_add_u32 s44, s94, 15360
    buffer_store_dwordx4 v[116:119], v14, s[20:23], s44 offen sc1
    s_add_u32 s44, s94, 20480
    buffer_store_dwordx4 v[120:123], v14, s[20:23], s44 offen sc1
L_sw2:
    s_buffer_load_dword s64, s[76:79], 0
    s_waitcnt lgkmcnt(0)
    s_cmp_lt_u32 s64, 64
    s_cbranch_scc1 L_zr20
L_zq19:
    s_waitcnt vmcnt(0)
    s_barrier
    s_mov_b32 s48, s31
    s_cmp_lt_u32 s31, 8
    s_cselect_b32 s70, 7, 3
    s_mov_b32 s71, 0
    s_cmp_lg_u32 s30, 4
    s_cbranch_scc1 L_fp22
    s_lshl_b32 s42, s48, 7
    s_add_u32 s42, s42, 18130944
    v_mov_b32 v60, 1
    v_lshlrev_b32 v62, 11, v1
    s_mov_b64 exec, s[70:71]
    buffer_store_dword v60, v62, s[20:23], s42 offen sc1
    s_mov_b64 exec, -1
L_fp22:
    s_cmp_lg_u32 s30, 5
    s_cbranch_scc1 L_fx23
    s_getreg_b32 s42, hwreg(HW_REG_XCC_ID)
    s_and_b32 s42, s42, 15
    s_add_u32 s42, s42, 1
    v_mov_b32 v60, s42
    s_and_b32 s42, s2, 7
    s_lshl_b32 s42, s42, 5
    s_lshr_b32 s43, s2, 3
    s_add_u32 s42, s42, s43
    s_lshl_b32 s42, s42, 2
    s_add_u32 s42, s42, 18128896
    s_mov_b64 exec, 1
    buffer_store_dword v60, v2, s[20:23], s42 offen sc1
    s_mov_b64 exec, -1
L_fx23:
    s_cmp_lg_u32 s31, 8
    s_cbranch_scc1 L_sw3
    s_mov_b32 s48, 40
    s_mov_b32 s64, s10
    s_mov_b32 s65, s11
    s_mov_b32 s50, 1280
    s_mov_b32 s51, 5
    s_mov_b32 s52, 0
    s_mov_b32 s53, 0
    s_mov_b32 s55, 0
    s_mov_b32 s66, 819200
    s_mov_b32 s70, 20
    s_mov_b32 s67, s48
    s_cmp_lt_u32 s48, 40
    s_cbranch_scc1 L_dec4b
    s_mov_b32 s64, s56
    s_mov_b32 s65, s57
    s_mov_b32 s52, 5
    s_mov_b32 s55, 17797120
    s_sub_u32 s67, s48, 40
    s_cmp_lt_u32 s48, 80
    s_cbranch_scc1 L_dec4b
    s_mov_b32 s64, s58
    s_mov_b32 s65, s59
    s_mov_b32 s52, 10
    s_mov_b32 s55, 0
    s_sub_u32 s67, s48, 80
    s_cmp_lt_u32 s48, 120
    s_cbranch_scc1 L_dec4b
    s_mov_b32 s64, s60
    s_mov_b32 s65, s61
    s_mov_b32 s50, 3456
    s_mov_b32 s52, 15
    s_mov_b32 s53, 1
    s_mov_b32 s55, 17809408
    s_mov_b32 s66, 2211840
    s_mov_b32 s51, 7
    s_sub_u32 s67, s48, 120
    s_mul_i32 s68, s67, 21846
    s_lshr_b32 s68, s68, 16
    s_mul_i32 s69, s68, 3
    s_sub_u32 s69, s67, s69
    s_cmp_lt_u32 s48, 201
    s_cbranch_scc1 L_decjb
    s_mov_b32 s64, s62
    s_mov_b32 s65, s63
    s_mov_b32 s50, 1280
    s_mov_b32 s52, 29
    s_mov_b32 s53, 2
    s_mov_b32 s55, 0
    s_mov_b32 s70, 54
    s_sub_u32 s67, s48, 201
    s_lshr_b32 s68, s67, 3
    s_and_b32 s69, s67, 7
    s_branch L_decjb
L_dec4b:
    s_lshr_b32 s68, s67, 2
    s_and_b32 s69, s67, 3
L_decjb:
    s_mov_b32 s24, s64
    s_and_b32 s25, s65, 0xffff
    s_mov_b32 s26, s66
    s_mov_b32 s27, 0x20000
    s_mul_i32 s54, s69, s51
    s_sub_u32 s70, s70, s54
    s_min_u32 s51, s51, s70
    s_lshl_b32 s49, s54, 2
    s_add_u32 s49, s49, s33
    s_lshl_b32 s49, s49, 3
    s_mul_i32 s49, s49, s50
    s_lshl_b32 s42, s68, 7
    s_add_u32 s49, s49, s42
    v_mul_lo_u32 v13, v8, s50
    v_lshl_add_u32 v13, v9, 4, v13
    s_lshl_b32 s42, s68, 2
    s_add_u32 s42, s42, s33
    s_mul_i32 s52, s52, 20480
    s_add_u32 s52, s52, 10752000
    s_cmp_eq_u32 s53, 1
    s_cbranch_scc1 L_dw3b
    s_mul_i32 s43, s42, 52429
    s_lshr_b32 s43, s43, 18
    s_mul_i32 s44, s43, 5
    s_sub_u32 s44, s42, s44
    s_cmp_eq_u32 s44, 0
    s_cselect_b32 s45, 4, -1
    s_bitcmp1_b32 s43, 0
    s_cselect_b32 s45, s45, 0
    s_add_u32 s44, s44, s45
    s_add_u32 s42, s42, s45
    s_lshl_b32 s44, s44, 10
    s_mul_i32 s46, s69, 2560
    s_branch L_dj2b
L_dw3b:
    s_lshr_b32 s45, s42, 1
    s_mul_i32 s43, s45, 9363
    s_lshr_b32 s43, s43, 16
    s_cmp_eq_u32 s45, 48
    s_cselect_b32 s43, 7, s43
    s_mul_i32 s44, s43, 7
    s_sub_u32 s44, s45, s44
    s_cmp_eq_u32 s43, 7
    s_addc_u32 s44, s44, 0
    s_lshl_b32 s44, s44, 1
    s_and_b32 s45, s42, 1
    s_add_u32 s44, s44, s45
    s_add_u32 s45, s44, 132
    s_cmp_eq_u32 s44, 7
    s_cselect_b32 s45, 146, s45
    s_cmp_lt_u32 s44, 7
    s_cselect_b32 s44, s44, s45
    s_lshl_b32 s44, s44, 10
    s_mul_i32 s46, s69, 8192
L_dj2b:
    s_mul_i32 s43, s43, 880640
    s_add_u32 s52, s52, s43
    s_add_u32 s52, s52, s44
    s_lshl_b32 s42, s42, 6
    s_add_u32 s42, s42, s46
    s_cmp_eq_u32 s55, 0
    s_cselect_b32 s42, 0, s42
    s_add_u32 s55, s55, s42
    s_lshl_b32 s42, s33, 10
    s_add_u32 s42, s42, 0
    s_lshl_b32 s43, s50, 5
    s_mov_b32 s44, s49
    s_add_u32 m0, s42, 0
    s_nop 0
    buffer_load_dwordx4 v13, s[24:27], s44 offen nt lds
    s_add_u32 s44, s44, s43
    s_add_u32 m0, s42, 4096
    s_nop 0
    buffer_load_dwordx4 v13, s[24:27], s44 offen nt lds
    s_add_u32 s44, s44, s43
    s_add_u32 m0, s42, 8192
    s_nop 0
    buffer_load_dwordx4 v13, s[24:27], s44 offen nt lds
    s_add_u32 s44, s44, s43
    s_add_u32 m0, s42, 12288
    s_nop 0
    buffer_load_dwordx4 v13, s[24:27], s44 offen nt lds
    s_add_u32 s44, s44, s43
    s_add_u32 m0, s42, 16384
    s_nop 0
    buffer_load_dwordx4 v13, s[24:27], s44 offen nt lds
    s_cmp_eq_u32 s51, 5
    s_cselect_b32 s43, 0, s43
    s_add_u32 s44, s44, s43
    s_add_u32 m0, s42, 20480
    s_nop 0
    buffer_load_dwordx4 v13, s[24:27], s44 offen nt lds
    s_cmp_eq_u32 s51, 6
    s_cselect_b32 s43, 0, s43
    s_add_u32 s44, s44, s43
    s_add_u32 m0, s42, 24576
    s_nop 0
    buffer_load_dwordx4 v13, s[24:27], s44 offen nt lds
    v_bfe_u32 v11, v1, 2, 2
    v_lshl_add_u32 v11, v10, 3, v11
    v_lshlrev_b32 v11, 7, v11
    v_and_b32 v12, 3, v1
    v_lshl_add_u32 v11, v12, 4, v11
    s_lshr_b32 s42, s33, 1
    s_lshl_b32 s42, s42, 6
    s_and_b32 s43, s33, 1
    s_lshl_b32 s43, s43, 3
    s_add_u32 s42, s42, s43
    s_add_u32 s42, s42, 0
    v_add_u32 v11, s42, v11
    v_lshrrev_b32 v6, 1, v10
    v_lshlrev_b32 v6, 9, v6
    v_and_b32 v7, 1, v10
    v_lshlrev_b32 v7, 9, v7
    v_sub_u32 v6, v6, v7
    v_add_u32 v6, v6, v11
    v_lshlrev_b32 v7, 12, v10
    v_add_u32 v7, v7, v11
    v_add_u32 v7, 2048, v7
    s_cmp_eq_u32 s53, 1
    s_mov_b32 s46, 5120
    s_cmov_b32 s46, 7168
    s_add_u32 s42, s54, 0
    s_mul_i32 s43, s42, 9363
    s_lshr_b32 s43, s43, 16
    s_cmp_eq_u32 s42, 48
    s_cselect_b32 s43, 7, s43
    s_mul_i32 s44, s43, 7
    s_sub_u32 s44, s42, s44
    s_cmp_eq_u32 s43, 7
    s_addc_u32 s44, s44, 0
    s_lshl_b32 s44, s44, 2
    s_lshr_b32 s44, 0x6315420, s44
    s_and_b32 s44, s44, 7
    s_lshl_b32 s44, s44, 3
    s_add_u32 s44, s44, s43
    s_cmp_eq_u32 s53, 2
    s_cselect_b32 s42, s44, s42
    s_mul_i32 s42, s42, s46
    s_add_u32 s92, s42, s52
    s_add_u32 s42, s54, 1
    s_mul_i32 s43, s42, 9363
    s_lshr_b32 s43, s43, 16
    s_cmp_eq_u32 s42, 48
    s_cselect_b32 s43, 7, s43
    s_mul_i32 s44, s43, 7
    s_sub_u32 s44, s42, s44
    s_cmp_eq_u32 s43, 7
    s_addc_u32 s44, s44, 0
    s_lshl_b32 s44, s44, 2
    s_lshr_b32 s44, 0x6315420, s44
    s_and_b32 s44, s44, 7
    s_lshl_b32 s44, s44, 3
    s_add_u32 s44, s44, s43
    s_cmp_eq_u32 s53, 2
    s_cselect_b32 s42, s44, s42
    s_mul_i32 s42, s42, s46
    s_add_u32 s93, s42, s52
    s_add_u32 s42, s54, 2
    s_mul_i32 s43, s42, 9363
    s_lshr_b32 s43, s43, 16
    s_cmp_eq_u32 s42, 48
    s_cselect_b32 s43, 7, s43
    s_mul_i32 s44, s43, 7
    s_sub_u32 s44, s42, s44
    s_cmp_eq_u32 s43, 7
    s_addc_u32 s44, s44, 0
    s_lshl_b32 s44, s44, 2
    s_lshr_b32 s44, 0x6315420, s44
    s_and_b32 s44, s44, 7
    s_lshl_b32 s44, s44, 3
    s_add_u32 s44, s44, s43
    s_cmp_eq_u32 s53, 2
    s_cselect_b32 s42, s44, s42
    s_mul_i32 s42, s42, s46
    s_add_u32 s94, s42, s52
    s_add_u32 s42, s54, 3
    s_mul_i32 s43, s42, 9363
    s_lshr_b32 s43, s43, 16
    s_cmp_eq_u32 s42, 48
    s_cselect_b32 s43, 7, s43
    s_mul_i32 s44, s43, 7
    s_sub_u32 s44, s42, s44
    s_cmp_eq_u32 s43, 7
    s_addc_u32 s44, s44, 0
    s_lshl_b32 s44, s44, 2
    s_lshr_b32 s44, 0x6315420, s44
    s_and_b32 s44, s44, 7
    s_lshl_b32 s44, s44, 3
    s_add_u32 s44, s44, s43
    s_cmp_eq_u32 s53, 2
    s_cselect_b32 s42, s44, s42
    s_mul_i32 s42, s42, s46
    s_add_u32 s95, s42, s52
    s_add_u32 s42, s54, 4
    s_mul_i32 s43, s42, 9363
    s_lshr_b32 s43, s43, 16
    s_cmp_eq_u32 s42, 48
    s_cselect_b32 s43, 7, s43
    s_mul_i32 s44, s43, 7
    s_sub_u32 s44, s42, s44
    s_cmp_eq_u32 s43, 7
    s_addc_u32 s44, s44, 0
    s_lshl_b32 s44, s44, 2
    s_lshr_b32 s44, 0x6315420, s44
    s_and_b32 s44, s44, 7
    s_lshl_b32 s44, s44, 3
    s_add_u32 s44, s44, s43
    s_cmp_eq_u32 s53, 2
    s_cselect_b32 s42, s44, s42
    s_mul_i32 s42, s42, s46
    s_add_u32 s96, s42, s52
    s_add_u32 s42, s54, 5
    s_mul_i32 s43, s42, 9363
    s_lshr_b32 s43, s43, 16
    s_cmp_eq_u32 s42, 48
    s_cselect_b32 s43, 7, s43
    s_mul_i32 s44, s43, 7
    s_sub_u32 s44, s42, s44
    s_cmp_eq_u32 s43, 7
    s_addc_u32 s44, s44, 0
    s_lshl_b32 s44, s44, 2
    s_lshr_b32 s44, 0x6315420, s44
    s_and_b32 s44, s44, 7
    s_lshl_b32 s44, s44, 3
    s_add_u32 s44, s44, s43
    s_cmp_eq_u32 s53, 2
    s_cselect_b32 s42, s44, s42
    s_mul_i32 s42, s42, s46
    s_add_u32 s97, s42, s52
    s_add_u32 s42, s54, 6
    s_mul_i32 s43, s42, 9363
    s_lshr_b32 s43, s43, 16
    s_cmp_eq_u32 s42, 48
    s_cselect_b32 s43, 7, s43
    s_mul_i32 s44, s43, 7
    s_sub_u32 s44, s42, s44
    s_cmp_eq_u32 s43, 7
    s_addc_u32 s44, s44, 0
    s_lshl_b32 s44, s44, 2
    s_lshr_b32 s44, 0x6315420, s44
    s_and_b32 s44, s44, 7
    s_lshl_b32 s44, s44, 3
    s_add_u32 s44, s44, s43
    s_cmp_eq_u32 s53, 2
    s_cselect_b32 s42, s44, s42
    s_mul_i32 s42, s42, s46
    s_add_u32 s98, s42, s52
L_sw3:
    s_waitcnt vmcnt(0)
    s_barrier
    s_cmp_lg_u32 s31, 8
    s_cbranch_scc1 L_sw4
    ds_read_b64_tr_b16 v[64:65], v11 offset:0
    ds_read_b64_tr_b16 v[66:67], v11 offset:512
    ds_read_b64_tr_b16 v[68:69], v11 offset:4096
    ds_read_b64_tr_b16 v[70:71], v11 offset:4608
    ds_read_b64_tr_b16 v[72:73], v11 offset:8192
    ds_read_b64_tr_b16 v[74:75], v11 offset:8704
    ds_read_b64_tr_b16 v[76:77], v11 offset:12288
    ds_read_b64_tr_b16 v[78:79], v11 offset:12800
    ds_read_b64_tr_b16 v[80:81], v11 offset:16384
    ds_read_b64_tr_b16 v[82:83], v11 offset:16896
    s_waitcnt lgkmcnt(0)
    buffer_store_dwordx4 v[64:67], v14, s[20:23], s92 offen sc1
    buffer_store_dwordx4 v[68:71], v14, s[20:23], s93 offen sc1
    buffer_store_dwordx4 v[72:75], v14, s[20:23], s94 offen sc1
    buffer_store_dwordx4 v[76:79], v14, s[20:23], s95 offen sc1
    buffer_store_dwordx4 v[80:83], v14, s[20:23], s96 offen sc1
    s_cmp_eq_u32 s51, 5
    s_cbranch_scc1 L_pp5b
    buffer_store_dwordx4 v[84:87], v14, s[20:23], s97 offen sc1
    s_cmp_eq_u32 s51, 6
    s_cbranch_scc1 L_pp5b
    buffer_store_dwordx4 v[88:91], v14, s[20:23], s98 offen sc1
L_pp5b:
    s_cmp_eq_u32 s55, 0
    s_cbranch_scc1 L_ppeb
    v_mov_b32 v56, 0x3f803f80
    v_mov_b32 v57, 0x3f803f80
    v_mov_b32 v58, 0x3f803f80
    v_mov_b32 v59, 0x3f803f80
    s_nop 1
    v_mfma_f32_16x16x32_bf16 v[92:95], v[56:59], v[64:67], 0
    v_mfma_f32_16x16x32_bf16 v[92:95], v[56:59], v[68:71], v[92:95]
    v_mfma_f32_16x16x32_bf16 v[92:95], v[56:59], v[72:75], v[92:95]
    v_mfma_f32_16x16x32_bf16 v[92:95], v[56:59], v[76:79], v[92:95]
    v_mfma_f32_16x16x32_bf16 v[92:95], v[56:59], v[80:83], v[92:95]
    s_cmp_eq_u32 s51, 5
    s_cbranch_scc1 L_pc5b
    v_mfma_f32_16x16x32_bf16 v[92:95], v[56:59], v[84:87], v[92:95]
    s_cmp_eq_u32 s51, 6
    s_cbranch_scc1 L_pc5b
    v_mfma_f32_16x16x32_bf16 v[92:95], v[56:59], v[88:91], v[92:95]
L_pc5b:
    v_lshlrev_b32 v62, 2, v1
    s_mov_b64 exec, 0xffff
    s_nop 5
    buffer_store_dword v92, v62, s[20:23], s55 offen sc1
    s_mov_b64 exec, -1
L_ppeb:
L_sw4:
    s_waitcnt vmcnt(0)
    s_barrier
    s_cmp_lg_u32 s31, 8
    s_cbranch_scc1 L_sw5
    s_cmp_lg_u32 s30, 4
    s_cbranch_scc1 L_fp24
    s_lshl_b32 s42, s48, 7
    s_add_u32 s42, s42, 18130944
    v_mov_b32 v60, 1
    v_lshlrev_b32 v62, 11, v1
    s_mov_b64 exec, 1
    buffer_store_dword v60, v62, s[20:23], s42 offen sc1
    s_mov_b64 exec, -1
L_fp24:
L_sw5:
    s_and_b32 s42, s2, 7
    s_lshl_b32 s43, s42, 11
    s_add_u32 s43, s43, 18096128
    s_lshl_b32 s44, s42, 10
    s_add_u32 s44, s44, 18087936
    s_cmp_eq_u32 s33, 0
    s_cselect_b32 s43, s43, s44
    s_cselect_b32 s45, 5, 4
    s_lshl_b32 s44, s42, 5
    s_lshr_b32 s42, s2, 3
    s_add_u32 s44, s44, s42
    s_lshl_b32 s44, s44, 10
    s_add_u32 s44, s44, 10485760
    s_cmp_ge_u32 s33, 2
    s_cselect_b32 s43, s44, s43
    v_lshlrev_b32 v124, s45, v1
    buffer_load_dword v120, v124, s[20:23], s43 offen sc1
    v_mov_b32 v12, 161856
    v_mov_b32 v60, 1
    s_lshr_b32 s44, s2, 5
    s_mul_i32 s43, s44, 5
    s_and_b32 s43, s43, 0xfc
    s_lshl_b32 s43, s43, 7
    s_add_u32 s43, s43, 18130944
    s_buffer_load_dword s56, s[20:23], s43 offset:0
    s_buffer_load_dword s57, s[20:23], s43 offset:128
    s_buffer_load_dword s58, s[20:23], s43 offset:256
    s_buffer_load_dword s59, s[20:23], s43 offset:384
    s_buffer_load_dword s60, s[20:23], s43 offset:512
    s_buffer_load_dword s61, s[20:23], s43 offset:640
    s_buffer_load_dword s62, s[20:23], s43 offset:768
    s_buffer_load_dword s63, s[20:23], s43 offset:896
    s_waitcnt lgkmcnt(0)
    s_min_u32 s56, s56, s57
    s_min_u32 s56, s56, s58
    s_min_u32 s56, s56, s59
    s_min_u32 s56, s56, s60
    s_min_u32 s56, s56, s61
    s_min_u32 s56, s56, s62
    s_min_u32 s56, s56, s63
    s_cmp_lt_u32 s56, 1
    s_cbranch_scc1 L_zr26
L_zq25:
    s_mul_i32 s44, s44, 880640
    s_mul_i32 s42, s33, 12288
    s_add_u32 s44, s44, s42
    s_add_u32 s44, s44, 10752000
    s_add_u32 m0, s42, 0
    s_add_u32 s46, s44, 0
    buffer_load_dwordx4 v14, s[20:23], s46 offen offset:0 sc1 lds
    buffer_load_dwordx4 v14, s[20:23], s46 offen offset:1024 sc1 lds
    buffer_load_dwordx4 v14, s[20:23], s46 offen offset:2048 sc1 lds
    buffer_load_dwordx4 v14, s[20:23], s46 offen offset:3072 sc1 lds
    s_add_u32 m0, s42, 4096
    s_add_u32 s46, s44, 4096
    buffer_load_dwordx4 v14, s[20:23], s46 offen offset:0 sc1 lds
    buffer_load_dwordx4 v14, s[20:23], s46 offen offset:1024 sc1 lds
    buffer_load_dwordx4 v14, s[20:23], s46 offen offset:2048 sc1 lds
    buffer_load_dwordx4 v14, s[20:23], s46 offen offset:3072 sc1 lds
    s_add_u32 m0, s42, 8192
    s_add_u32 s46, s44, 8192
    s_waitcnt vmcnt(7)
    buffer_load_dwordx4 v14, s[20:23], s46 offen offset:0 sc1 lds
    s_waitcnt vmcnt(7)
    buffer_load_dwordx4 v14, s[20:23], s46 offen offset:1024 sc1 lds
    s_waitcnt vmcnt(7)
    buffer_load_dwordx4 v14, s[20:23], s46 offen offset:2048 sc1 lds
    s_waitcnt vmcnt(7)
    buffer_load_dwordx4 v14, s[20:23], s46 offen offset:3072 sc1 lds
    s_branch L_k1_wo
L_k1_comp:
    s_mov_b32 s71, 0
    s_waitcnt lgkmcnt(0)
    s_mov_b32 s20, s74
    s_and_b32 s21, s75, 0xffff
    s_mov_b32 s22, 18219008
    s_mov_b32 s23, 0x20000
    s_sub_u32 s50, s26, 2
    s_lshl_b32 s50, s50, 2
    s_add_u32 s50, s50, s30
    s_cmp_ge_u32 s50, 2
    s_cbranch_scc1 L_notlb
    v_lshlrev_b32 v60, 19, v1
    s_cmp_eq_u32 s50, 0
    s_cbranch_scc1 L_tlbo
    s_sub_u32 s50, s50, 1
    s_lshl_b32 s50, s50, 25
    v_add_u32 v60, s50, v60
    buffer_load_dword v63, v60, s[20:23], 0 offen
    s_branch L_notlb
L_tlbo:
    s_load_dwordx2 s[52:53], s[0:1], 64
    s_waitcnt lgkmcnt(0)
    s_and_b32 s53, s53, 0xffff
    s_mov_b32 s54, 2621440
    s_mov_b32 s55, 0x20000
    v_lshlrev_b32 v60, 16, v1
    buffer_load_dword v63, v60, s[52:55], 0 offen
L_notlb:
    s_lshr_b32 s34, s30, 1
    s_and_b32 s35, s30, 1
    v_and_b32 v36, 31, v1
    v_lshrrev_b32 v39, 5, v1
    s_lshl_b32 s41, s34, 6
    v_add_u32 v10, s41, v36
    v_bfe_u32 v11, v10, 1, 3
    v_xor_b32 v11, v11, v39
    v_lshlrev_b32 v11, 4, v11
    v_lshl_add_u32 v20, v10, 7, v11
    s_lshl_b32 s41, s35, 12
    v_add_u32 v20, s41, v20
    v_xor_b32 v21, 32, v20
    v_xor_b32 v22, 64, v20
    v_xor_b32 v23, 96, v20
    v_add_u32 v24, 0x10000, v20
    v_add_u32 v25, 0x10000, v21
    v_add_u32 v26, 0x10000, v22
    v_add_u32 v27, 0x10000, v23
    v_xor_b32 v40, 0x1000, v20
    v_xor_b32 v41, 0x1000, v21
    v_xor_b32 v42, 0x1000, v22
    v_xor_b32 v43, 0x1000, v23
    v_xor_b32 v44, 0x1000, v24
    v_xor_b32 v45, 0x1000, v25
    v_xor_b32 v46, 0x1000, v26
    v_xor_b32 v47, 0x1000, v27
    v_bfe_u32 v10, v1, 2, 2
    v_lshl_add_u32 v11, v39, 3, v10
    v_lshlrev_b32 v11, 8, v11
    v_bfe_u32 v12, v1, 4, 1
    v_lshl_add_u32 v11, v12, 5, v11
    v_and_b32 v12, 3, v1
    v_lshl_add_u32 v11, v12, 3, v11
    s_lshl_b32 s41, s35, 1
    s_add_u32 s41, s41, s34
    v_xor_b32 v12, s41, v10
    v_lshl_add_u32 v28, v12, 6, v11
    v_xor_b32 v29, 64, v28
    v_add_u32 v30, 0x10000, v28
    v_add_u32 v31, 0x10000, v29
    v_and_b32 v10, 15, v1
    v_bfe_u32 v11, v1, 4, 1
    v_cmp_eq_u32 vcc, v10, v11
    v_mov_b32 v10, 0x3f803f80
    s_nop 0
    v_cndmask_b32 v4, 0, v10, vcc
    v_cndmask_b32 v5, 0, v10, vcc
    v_cndmask_b32 v6, 0, v10, vcc
    v_cndmask_b32 v7, 0, v10, vcc
    s_cmp_ge_u32 s32, 10
    s_cbranch_scc1 L_k1_v
    s_lshl_b32 s43, s31, 2
    s_lshl_b32 s44, s34, 1
    s_add_u32 s43, s43, s44
    s_add_u32 s43, s43, s35
    s_lshr_b32 s44, s43, 3
    s_mul_i32 s44, s44, 327680
    s_and_b32 s45, s43, 7
    s_xor_b32 s46, s45, 1
    s_mul_i32 s45, s45, 1280
    s_mul_i32 s46, s46, 1280
    s_add_u32 s45, s45, s44
    s_add_u32 s46, s46, s44
    s_cmp_ge_u32 s32, 5
    s_cselect_b32 s42, 5, 0
    s_cselect_b32 s47, 2621440, 0
    s_sub_u32 s41, s32, s42
    s_lshl_b32 s41, s41, 5
    s_lshl_b32 s42, s35, 4
    s_add_u32 s41, s41, s42
    s_lshl_b32 s42, s34, 3
    s_add_u32 s41, s41, s42
    s_add_u32 s45, s45, s47
    s_add_u32 s46, s46, s47
    v_add_u32 v10, s41, v39
    v_xor_b32 v10, 0, v10
    v_add_u32 v10, 0, v10
    v_mul_u32_u24 v11, 52429, v10
    v_lshrrev_b32 v11, 18, v11
    v_mul_u32_u24 v11, 8960, v11
    v_lshl_add_u32 v11, v10, 8, v11
    v_lshl_add_u32 v224, v36, 3, v11
    v_add_u32 v10, s41, v39
    v_xor_b32 v10, 0, v10
    v_add_u32 v10, 2, v10
    v_mul_u32_u24 v11, 52429, v10
    v_lshrrev_b32 v11, 18, v11
    v_mul_u32_u24 v11, 8960, v11
    v_lshl_add_u32 v11, v10, 8, v11
    v_lshl_add_u32 v225, v36, 3, v11
    v_add_u32 v10, s41, v39
    v_xor_b32 v10, 0, v10
    v_add_u32 v10, 4, v10
    v_mul_u32_u24 v11, 52429, v10
    v_lshrrev_b32 v11, 18, v11
    v_mul_u32_u24 v11, 8960, v11
    v_lshl_add_u32 v11, v10, 8, v11
    v_lshl_add_u32 v226, v36, 3, v11
    v_add_u32 v10, s41, v39
    v_xor_b32 v10, 0, v10
    v_add_u32 v10, 6, v10
    v_mul_u32_u24 v11, 52429, v10
    v_lshrrev_b32 v11, 18, v11
    v_mul_u32_u24 v11, 8960, v11
    v_lshl_add_u32 v11, v10, 8, v11
    v_lshl_add_u32 v227, v36, 3, v11
    v_add_u32 v10, s41, v39
    v_xor_b32 v10, 8, v10
    v_add_u32 v10, 0, v10
    v_mul_u32_u24 v11, 52429, v10
    v_lshrrev_b32 v11, 18, v11
    v_mul_u32_u24 v11, 8960, v11
    v_lshl_add_u32 v11, v10, 8, v11
    v_lshl_add_u32 v228, v36, 3, v11
    v_add_u32 v10, s41, v39
    v_xor_b32 v10, 8, v10
    v_add_u32 v10, 2, v10
    v_mul_u32_u24 v11, 52429, v10
    v_lshrrev_b32 v11, 18, v11
    v_mul_u32_u24 v11, 8960, v11
    v_lshl_add_u32 v11, v10, 8, v11
    v_lshl_add_u32 v229, v36, 3, v11
    v_add_u32 v10, s41, v39
    v_xor_b32 v10, 8, v10
    v_add_u32 v10, 4, v10
    v_mul_u32_u24 v11, 52429, v10
    v_lshrrev_b32 v11, 18, v11
    v_mul_u32_u24 v11, 8960, v11
    v_lshl_add_u32 v11, v10, 8, v11
    v_lshl_add_u32 v230, v36, 3, v11
    v_add_u32 v10, s41, v39
    v_xor_b32 v10, 8, v10
    v_add_u32 v10, 6, v10
    v_mul_u32_u24 v11, 52429, v10
    v_lshrrev_b32 v11, 18, v11
    v_mul_u32_u24 v11, 8960, v11
    v_lshl_add_u32 v11, v10, 8, v11
    v_lshl_add_u32 v231, v36, 3, v11
    s_lshl_b32 s41, s35, 1
    s_add_u32 s41, s41, s34
    s_lshl_b32 s41, s41, 7
    s_mul_i32 s40, s32, 10
    s_add_u32 s40, s40, s29
    s_lshl_b32 s40, s40, 9
    s_add_u32 s40, s40, s41
    s_add_u32 s40, s40, 18006016
    s_cmp_lt_u32 s31, 10
    s_cselect_b32 s43, 0, 0x40000000
    s_add_u32 s41, s41, 160768
    v_lshl_add_u32 v37, v36, 2, s43
    s_lshl_b32 s42, s34, 1
    s_add_u32 s42, s42, s35
    s_lshl_b32 s42, s42, 7
    s_add_u32 s42, s42, 159744
    v_bfe_u32 v11, v1, 2, 2
    v_lshrrev_b32 v10, 4, v1
    v_lshl_add_u32 v11, v10, 3, v11
    v_lshlrev_b32 v11, 7, v11
    v_and_b32 v12, 3, v1
    v_lshl_add_u32 v11, v12, 4, v11
    s_lshl_b32 s43, s34, 6
    s_lshl_b32 s44, s35, 3
    s_add_u32 s43, s43, s44
    s_add_u32 s43, s43, 131072
    v_add_u32 v14, s43, v11
    v_lshlrev_b32 v15, 4, v1
    s_mul_i32 s71, s31, 15
    s_add_u32 s71, s71, s32
    s_add_u32 s71, s71, 41
    s_lshl_b32 s71, s71, 7
    s_lshl_b32 s43, s30, 6
    s_add_u32 s43, s43, 161280
    v_mov_b32 v13, s43
    v_mov_b32 v56, 0x3f803f80
    v_mov_b32 v57, 0x3f803f80
    v_mov_b32 v58, 0x3f803f80
    v_mov_b32 v59, 0x3f803f80
    s_barrier
    ds_read_b128 v[128:131], v20 offset:0
    ds_read_b64_tr_b16 v[144:145], v28 offset:16384
    ds_read_b64_tr_b16 v[146:147], v28 offset:17408
    ds_read_b64_tr_b16 v[148:149], v29 offset:16384
    ds_read_b64_tr_b16 v[150:151], v29 offset:17408
    ds_read_b128 v[132:135], v40 offset:0
    s_waitcnt lgkmcnt(3)
    v_mfma_f32_32x32x16_bf16 v[64:79], v[144:147], v[128:131], 0
    ds_read_b128 v[136:139], v21 offset:0
    ds_read_b64_tr_b16 v[152:153], v28 offset:20480
    s_waitcnt lgkmcnt(3)
    v_mfma_f32_32x32x16_bf16 v[80:95], v[148:151], v[128:131], 0
    ds_read_b64_tr_b16 v[154:155], v28 offset:21504
    ds_read_b64_tr_b16 v[156:157], v29 offset:20480
    s_waitcnt lgkmcnt(4)
    v_mfma_f32_32x32x16_bf16 v[96:111], v[144:147], v[132:135], 0
    ds_read_b64_tr_b16 v[158:159], v29 offset:21504
    ds_read_b128 v[140:143], v41 offset:0
    v_mfma_f32_32x32x16_bf16 v[112:127], v[148:151], v[132:135], 0
    v_mfma_f32_16x16x32_bf16 v[32:35], v[4:7], v[144:147], 0
    s_waitcnt lgkmcnt(3)
    v_mfma_f32_32x32x16_bf16 v[64:79], v[152:155], v[136:139], v[64:79]
    ds_read_b128 v[128:131], v22 offset:0
    ds_read_b64_tr_b16 v[144:145], v28 offset:24576
    s_waitcnt lgkmcnt(3)
    v_mfma_f32_32x32x16_bf16 v[80:95], v[156:159], v[136:139], v[80:95]
    ds_read_b64_tr_b16 v[146:147], v28 offset:25600
    ds_read_b64_tr_b16 v[148:149], v29 offset:24576
    s_waitcnt lgkmcnt(4)
    v_mfma_f32_32x32x16_bf16 v[96:111], v[152:155], v[140:143], v[96:111]
    ds_read_b64_tr_b16 v[150:151], v29 offset:25600
    ds_read_b128 v[132:135], v42 offset:0
    v_mfma_f32_32x32x16_bf16 v[112:127], v[156:159], v[140:143], v[112:127]
    v_mfma_f32_16x16x32_bf16 v[32:35], v[4:7], v[152:155], v[32:35]
    s_waitcnt lgkmcnt(3)
    v_mfma_f32_32x32x16_bf16 v[64:79], v[144:147], v[128:131], v[64:79]
    ds_read_b128 v[136:139], v23 offset:0
    ds_read_b64_tr_b16 v[152:153], v28 offset:28672
    s_waitcnt lgkmcnt(3)
    v_mfma_f32_32x32x16_bf16 v[80:95], v[148:151], v[128:131], v[80:95]
    ds_read_b64_tr_b16 v[154:155], v28 offset:29696
    ds_read_b64_tr_b16 v[156:157], v29 offset:28672
    s_waitcnt lgkmcnt(4)
    v_mfma_f32_32x32x16_bf16 v[96:111], v[144:147], v[132:135], v[96:111]
    ds_read_b64_tr_b16 v[158:159], v29 offset:29696
    ds_read_b128 v[140:143], v43 offset:0
    v_mfma_f32_32x32x16_bf16 v[112:127], v[148:151], v[132:135], v[112:127]
    v_mfma_f32_16x16x32_bf16 v[32:35], v[4:7], v[144:147], v[32:35]
    s_waitcnt lgkmcnt(3)
    v_mfma_f32_16x16x32_bf16 v[32:35], v[4:7], v[152:155], v[32:35]
    v_mfma_f32_32x32x16_bf16 v[64:79], v[152:155], v[136:139], v[64:79]
    s_mov_b64 exec, 0xffff
    s_nop 5
    buffer_store_dword v32, v37, s[20:23], s40 offen sc1
    buffer_store_dword v33, v37, s[20:23], s40 offen offset:64 sc1
    s_mov_b64 exec, -1
    s_barrier
    ds_read_b128 v[128:131], v20 offset:32768
    ds_read_b64_tr_b16 v[144:145], v28 offset:49152
    s_waitcnt lgkmcnt(3)
    v_mfma_f32_32x32x16_bf16 v[80:95], v[156:159], v[136:139], v[80:95]
    ds_read_b64_tr_b16 v[146:147], v28 offset:50176
    ds_read_b64_tr_b16 v[148:149], v29 offset:49152
    s_waitcnt lgkmcnt(4)
    v_mfma_f32_32x32x16_bf16 v[96:111], v[152:155], v[140:143], v[96:111]
    ds_read_b64_tr_b16 v[150:151], v29 offset:50176
    ds_read_b128 v[132:135], v40 offset:32768
    v_mfma_f32_32x32x16_bf16 v[112:127], v[156:159], v[140:143], v[112:127]
    s_waitcnt lgkmcnt(3)
    v_mfma_f32_32x32x16_bf16 v[64:79], v[144:147], v[128:131], v[64:79]
    ds_read_b128 v[136:139], v21 offset:32768
    ds_read_b64_tr_b16 v[152:153], v28 offset:53248
    s_waitcnt lgkmcnt(3)
    v_mfma_f32_32x32x16_bf16 v[80:95], v[148:151], v[128:131], v[80:95]
    ds_read_b64_tr_b16 v[154:155], v28 offset:54272
    ds_read_b64_tr_b16 v[156:157], v29 offset:53248
    s_waitcnt lgkmcnt(4)
    v_mfma_f32_32x32x16_bf16 v[96:111], v[144:147], v[132:135], v[96:111]
    ds_read_b64_tr_b16 v[158:159], v29 offset:54272
    ds_read_b128 v[140:143], v41 offset:32768
    v_mfma_f32_32x32x16_bf16 v[112:127], v[148:151], v[132:135], v[112:127]
    s_waitcnt lgkmcnt(3)
    v_mfma_f32_32x32x16_bf16 v[64:79], v[152:155], v[136:139], v[64:79]
    ds_read_b128 v[128:131], v22 offset:32768
    ds_read_b64_tr_b16 v[144:145], v28 offset:57344
    s_waitcnt lgkmcnt(3)
    v_mfma_f32_32x32x16_bf16 v[80:95], v[156:159], v[136:139], v[80:95]
    ds_read_b64_tr_b16 v[146:147], v28 offset:58368
    ds_read_b64_tr_b16 v[148:149], v29 offset:57344
    s_waitcnt lgkmcnt(4)
    v_mfma_f32_32x32x16_bf16 v[96:111], v[152:155], v[140:143], v[96:111]
    ds_read_b64_tr_b16 v[150:151], v29 offset:58368
    ds_read_b128 v[132:135], v42 offset:32768
    v_mfma_f32_32x32x16_bf16 v[112:127], v[156:159], v[140:143], v[112:127]
    s_waitcnt lgkmcnt(3)
    v_mfma_f32_32x32x16_bf16 v[64:79], v[144:147], v[128:131], v[64:79]
    ds_read_b128 v[136:139], v23 offset:32768
    ds_read_b64_tr_b16 v[152:153], v28 offset:61440
    s_waitcnt lgkmcnt(3)
    v_mfma_f32_32x32x16_bf16 v[80:95], v[148:151], v[128:131], v[80:95]
    ds_read_b64_tr_b16 v[154:155], v28 offset:62464
    ds_read_b64_tr_b16 v[156:157], v29 offset:61440
    s_waitcnt lgkmcnt(4)
    v_mfma_f32_32x32x16_bf16 v[96:111], v[144:147], v[132:135], v[96:111]
    ds_read_b64_tr_b16 v[158:159], v29 offset:62464
    ds_read_b128 v[140:143], v43 offset:32768
    v_mfma_f32_32x32x16_bf16 v[112:127], v[148:151], v[132:135], v[112:127]
    s_waitcnt lgkmcnt(3)
    v_mfma_f32_32x32x16_bf16 v[64:79], v[152:155], v[136:139], v[64:79]
    s_barrier
    ds_read_b128 v[128:131], v24 offset:0
    ds_read_b64_tr_b16 v[144:145], v30 offset:16384
    s_waitcnt lgkmcnt(3)
    v_mfma_f32_32x32x16_bf16 v[80:95], v[156:159], v[136:139], v[80:95]
    ds_read_b64_tr_b16 v[146:147], v30 offset:17408
    ds_read_b64_tr_b16 v[148:149], v31 offset:16384
    s_waitcnt lgkmcnt(4)
    v_mfma_f32_32x32x16_bf16 v[96:111], v[152:155], v[140:143], v[96:111]
    ds_read_b64_tr_b16 v[150:151], v31 offset:17408
    ds_read_b128 v[132:135], v44 offset:0
    v_mfma_f32_32x32x16_bf16 v[112:127], v[156:159], v[140:143], v[112:127]
    s_waitcnt lgkmcnt(3)
    v_mfma_f32_32x32x16_bf16 v[64:79], v[144:147], v[128:131], v[64:79]
    ds_read_b128 v[136:139], v25 offset:0
    ds_read_b64_tr_b16 v[152:153], v30 offset:20480
    s_waitcnt lgkmcnt(3)
    v_mfma_f32_32x32x16_bf16 v[80:95], v[148:151], v[128:131], v[80:95]
    ds_read_b64_tr_b16 v[154:155], v30 offset:21504
    ds_read_b64_tr_b16 v[156:157], v31 offset:20480
    s_waitcnt lgkmcnt(4)
    v_mfma_f32_32x32x16_bf16 v[96:111], v[144:147], v[132:135], v[96:111]
    ds_read_b64_tr_b16 v[158:159], v31 offset:21504
    ds_read_b128 v[140:143], v45 offset:0
    v_mfma_f32_32x32x16_bf16 v[112:127], v[148:151], v[132:135], v[112:127]
    s_waitcnt lgkmcnt(3)
    v_mfma_f32_32x32x16_bf16 v[64:79], v[152:155], v[136:139], v[64:79]
    ds_read_b128 v[128:131], v26 offset:0
    ds_read_b64_tr_b16 v[144:145], v30 offset:24576
    s_waitcnt lgkmcnt(3)
    v_mfma_f32_32x32x16_bf16 v[80:95], v[156:159], v[136:139], v[80:95]
    ds_read_b64_tr_b16 v[146:147], v30 offset:25600
    ds_read_b64_tr_b16 v[148:149], v31 offset:24576
    s_waitcnt lgkmcnt(4)
    v_mfma_f32_32x32x16_bf16 v[96:111], v[152:155], v[140:143], v[96:111]
    ds_read_b64_tr_b16 v[150:151], v31 offset:25600
    ds_read_b128 v[132:135], v46 offset:0
    v_mfma_f32_32x32x16_bf16 v[112:127], v[156:159], v[140:143], v[112:127]
    s_waitcnt lgkmcnt(3)
    v_mfma_f32_32x32x16_bf16 v[64:79], v[144:147], v[128:131], v[64:79]
    ds_read_b128 v[136:139], v27 offset:0
    ds_read_b64_tr_b16 v[152:153], v30 offset:28672
    s_waitcnt lgkmcnt(3)
    v_mfma_f32_32x32x16_bf16 v[80:95], v[148:151], v[128:131], v[80:95]
    ds_read_b64_tr_b16 v[154:155], v30 offset:29696
    ds_read_b64_tr_b16 v[156:157], v31 offset:28672
    s_waitcnt lgkmcnt(4)
    v_mfma_f32_32x32x16_bf16 v[96:111], v[144:147], v[132:135], v[96:111]
    ds_read_b64_tr_b16 v[158:159], v31 offset:29696
    ds_read_b128 v[140:143], v47 offset:0
    v_mfma_f32_32x32x16_bf16 v[112:127], v[148:151], v[132:135], v[112:127]
    s_waitcnt lgkmcnt(3)
    v_mfma_f32_32x32x16_bf16 v[64:79], v[152:155], v[136:139], v[64:79]
    s_waitcnt vmcnt(0)
    s_barrier
    s_cmp_eq_u32 s30, 0
    s_cbranch_scc1 L_fw28
L_fe29:
    ds_read_b128 v[128:131], v24 offset:32768
    ds_read_b64_tr_b16 v[144:145], v30 offset:49152
    s_waitcnt lgkmcnt(3)
    v_mfma_f32_32x32x16_bf16 v[80:95], v[156:159], v[136:139], v[80:95]
    ds_read_b64_tr_b16 v[146:147], v30 offset:50176
    ds_read_b64_tr_b16 v[148:149], v31 offset:49152
    s_waitcnt lgkmcnt(4)
    v_mfma_f32_32x32x16_bf16 v[96:111], v[152:155], v[140:143], v[96:111]
    ds_read_b64_tr_b16 v[150:151], v31 offset:50176
    ds_read_b128 v[132:135], v44 offset:32768
    v_mfma_f32_32x32x16_bf16 v[112:127], v[156:159], v[140:143], v[112:127]
    s_waitcnt lgkmcnt(3)
    v_mfma_f32_32x32x16_bf16 v[64:79], v[144:147], v[128:131], v[64:79]
    ds_read_b128 v[136:139], v25 offset:32768
    ds_read_b64_tr_b16 v[152:153], v30 offset:53248
    s_waitcnt lgkmcnt(3)
    v_mfma_f32_32x32x16_bf16 v[80:95], v[148:151], v[128:131], v[80:95]
    ds_read_b64_tr_b16 v[154:155], v30 offset:54272
    ds_read_b64_tr_b16 v[156:157], v31 offset:53248
    s_waitcnt lgkmcnt(4)
    v_mfma_f32_32x32x16_bf16 v[96:111], v[144:147], v[132:135], v[96:111]
    ds_read_b64_tr_b16 v[158:159], v31 offset:54272
    ds_read_b128 v[140:143], v45 offset:32768
    v_mfma_f32_32x32x16_bf16 v[112:127], v[148:151], v[132:135], v[112:127]
    s_waitcnt lgkmcnt(3)
    v_mfma_f32_32x32x16_bf16 v[64:79], v[152:155], v[136:139], v[64:79]
    ds_read_b128 v[128:131], v26 offset:32768
    ds_read_b64_tr_b16 v[144:145], v30 offset:57344
    s_waitcnt lgkmcnt(3)
    v_mfma_f32_32x32x16_bf16 v[80:95], v[156:159], v[136:139], v[80:95]
    ds_read_b64_tr_b16 v[146:147], v30 offset:58368
    ds_read_b64_tr_b16 v[148:149], v31 offset:57344
    s_waitcnt lgkmcnt(4)
    v_mfma_f32_32x32x16_bf16 v[96:111], v[152:155], v[140:143], v[96:111]
    ds_read_b64_tr_b16 v[150:151], v31 offset:58368
    ds_read_b128 v[132:135], v46 offset:32768
    v_mfma_f32_32x32x16_bf16 v[112:127], v[156:159], v[140:143], v[112:127]
    s_waitcnt lgkmcnt(3)
    v_mfma_f32_32x32x16_bf16 v[64:79], v[144:147], v[128:131], v[64:79]
    ds_read_b128 v[136:139], v27 offset:32768
    ds_read_b64_tr_b16 v[152:153], v30 offset:61440
    s_waitcnt lgkmcnt(3)
    v_mfma_f32_32x32x16_bf16 v[80:95], v[148:151], v[128:131], v[80:95]
    ds_read_b64_tr_b16 v[154:155], v30 offset:62464
    ds_read_b64_tr_b16 v[156:157], v31 offset:61440
    s_waitcnt lgkmcnt(4)
    v_mfma_f32_32x32x16_bf16 v[96:111], v[144:147], v[132:135], v[96:111]
    ds_read_b64_tr_b16 v[158:159], v31 offset:62464
    ds_read_b128 v[140:143], v47 offset:32768
    v_mfma_f32_32x32x16_bf16 v[112:127], v[148:151], v[132:135], v[112:127]
    s_waitcnt lgkmcnt(3)
    v_mfma_f32_32x32x16_bf16 v[64:79], v[152:155], v[136:139], v[64:79]
    s_barrier
    ds_read_b128 v[128:131], v20 offset:0
    ds_read_b64_tr_b16 v[144:145], v28 offset:16384
    s_waitcnt lgkmcnt(3)
    v_mfma_f32_32x32x16_bf16 v[80:95], v[156:159], v[136:139], v[80:95]
    ds_read_b64_tr_b16 v[146:147], v28 offset:17408
    ds_read_b64_tr_b16 v[148:149], v29 offset:16384
    s_waitcnt lgkmcnt(4)
    v_mfma_f32_32x32x16_bf16 v[96:111], v[152:155], v[140:143], v[96:111]
    ds_read_b64_tr_b16 v[150:151], v29 offset:17408
    ds_read_b128 v[132:135], v40 offset:0
    v_mfma_f32_32x32x16_bf16 v[112:127], v[156:159], v[140:143], v[112:127]
    s_waitcnt lgkmcnt(3)
    v_mfma_f32_32x32x16_bf16 v[64:79], v[144:147], v[128:131], v[64:79]
    ds_read_b128 v[136:139], v21 offset:0
    ds_read_b64_tr_b16 v[152:153], v28 offset:20480
    s_waitcnt lgkmcnt(3)
    v_mfma_f32_32x32x16_bf16 v[80:95], v[148:151], v[128:131], v[80:95]
    ds_read_b64_tr_b16 v[154:155], v28 offset:21504
    ds_read_b64_tr_b16 v[156:157], v29 offset:20480
    s_waitcnt lgkmcnt(4)
    v_mfma_f32_32x32x16_bf16 v[96:111], v[144:147], v[132:135], v[96:111]
    ds_read_b64_tr_b16 v[158:159], v29 offset:21504
    ds_read_b128 v[140:143], v41 offset:0
    v_mfma_f32_32x32x16_bf16 v[112:127], v[148:151], v[132:135], v[112:127]
    s_waitcnt lgkmcnt(3)
    v_mfma_f32_32x32x16_bf16 v[64:79], v[152:155], v[136:139], v[64:79]
    ds_read_b128 v[128:131], v22 offset:0
    ds_read_b64_tr_b16 v[144:145], v28 offset:24576
    s_waitcnt lgkmcnt(3)
    v_mfma_f32_32x32x16_bf16 v[80:95], v[156:159], v[136:139], v[80:95]
    ds_read_b64_tr_b16 v[146:147], v28 offset:25600
    ds_read_b64_tr_b16 v[148:149], v29 offset:24576
    s_waitcnt lgkmcnt(4)
    v_mfma_f32_32x32x16_bf16 v[96:111], v[152:155], v[140:143], v[96:111]
    ds_read_b64_tr_b16 v[150:151], v29 offset:25600
    ds_read_b128 v[132:135], v42 offset:0
    v_mfma_f32_32x32x16_bf16 v[112:127], v[156:159], v[140:143], v[112:127]
    s_waitcnt lgkmcnt(3)
    v_mfma_f32_32x32x16_bf16 v[64:79], v[144:147], v[128:131], v[64:79]
    ds_read_b128 v[136:139], v23 offset:0
    ds_read_b64_tr_b16 v[152:153], v28 offset:28672
    s_waitcnt lgkmcnt(3)
    v_mfma_f32_32x32x16_bf16 v[80:95], v[148:151], v[128:131], v[80:95]
    ds_read_b64_tr_b16 v[154:155], v28 offset:29696
    ds_read_b64_tr_b16 v[156:157], v29 offset:28672
    s_waitcnt lgkmcnt(4)
    v_mfma_f32_32x32x16_bf16 v[96:111], v[144:147], v[132:135], v[96:111]
    ds_read_b64_tr_b16 v[158:159], v29 offset:29696
    ds_read_b128 v[140:143], v43 offset:0
    v_mfma_f32_32x32x16_bf16 v[112:127], v[148:151], v[132:135], v[112:127]
    s_waitcnt lgkmcnt(3)
    v_mfma_f32_32x32x16_bf16 v[64:79], v[152:155], v[136:139], v[64:79]
    s_barrier
    ds_read_b128 v[128:131], v20 offset:32768
    ds_read_b64_tr_b16 v[144:145], v28 offset:49152
    s_waitcnt lgkmcnt(3)
    v_mfma_f32_32x32x16_bf16 v[80:95], v[156:159], v[136:139], v[80:95]
    ds_read_b64_tr_b16 v[146:147], v28 offset:50176
    ds_read_b64_tr_b16 v[148:149], v29 offset:49152
    s_waitcnt lgkmcnt(4)
    v_mfma_f32_32x32x16_bf16 v[96:111], v[152:155], v[140:143], v[96:111]
    ds_read_b64_tr_b16 v[150:151], v29 offset:50176
    ds_read_b128 v[132:135], v40 offset:32768
    v_mfma_f32_32x32x16_bf16 v[112:127], v[156:159], v[140:143], v[112:127]
    s_waitcnt lgkmcnt(3)
    v_mfma_f32_32x32x16_bf16 v[64:79], v[144:147], v[128:131], v[64:79]
    ds_read_b128 v[136:139], v21 offset:32768
    ds_read_b64_tr_b16 v[152:153], v28 offset:53248
    s_waitcnt lgkmcnt(3)
    v_mfma_f32_32x32x16_bf16 v[80:95], v[148:151], v[128:131], v[80:95]
    ds_read_b64_tr_b16 v[154:155], v28 offset:54272
    ds_read_b64_tr_b16 v[156:157], v29 offset:53248
    s_waitcnt lgkmcnt(4)
    v_mfma_f32_32x32x16_bf16 v[96:111], v[144:147], v[132:135], v[96:111]
    ds_read_b64_tr_b16 v[158:159], v29 offset:54272
    ds_read_b128 v[140:143], v41 offset:32768
    v_mfma_f32_32x32x16_bf16 v[112:127], v[148:151], v[132:135], v[112:127]
    s_waitcnt lgkmcnt(3)
    v_mfma_f32_32x32x16_bf16 v[64:79], v[152:155], v[136:139], v[64:79]
    ds_read_b128 v[192:195], v13
    ds_read_b128 v[196:199], v13 offset:16
    ds_read_b32 v200, v13 offset:32
    ds_read_b128 v[128:131], v22 offset:32768
    ds_read_b64_tr_b16 v[144:145], v28 offset:57344
    s_waitcnt lgkmcnt(6)
    v_mfma_f32_32x32x16_bf16 v[80:95], v[156:159], v[136:139], v[80:95]
    ds_read_b64_tr_b16 v[146:147], v28 offset:58368
    ds_read_b64_tr_b16 v[148:149], v29 offset:57344
    s_waitcnt lgkmcnt(7)
    v_mfma_f32_32x32x16_bf16 v[96:111], v[152:155], v[140:143], v[96:111]
    ds_read_b64_tr_b16 v[150:151], v29 offset:58368
    ds_read_b128 v[132:135], v42 offset:32768
    v_mfma_f32_32x32x16_bf16 v[112:127], v[156:159], v[140:143], v[112:127]
    s_waitcnt lgkmcnt(3)
    v_mfma_f32_32x32x16_bf16 v[64:79], v[144:147], v[128:131], v[64:79]
    v_add_u32 v192, v192, v15
    v_add_u32 v193, v193, v15
    v_add_u32 v194, v194, v15
    v_add_u32 v195, v195, v15
    v_add_u32 v196, v196, v15
    v_add_u32 v197, v197, v15
    v_add_u32 v198, v198, v15
    v_readfirstlane_b32 s38, v199
    v_readfirstlane_b32 s39, v200
    ds_read_b128 v[136:139], v23 offset:32768
    ds_read_b64_tr_b16 v[152:153], v28 offset:61440
    s_waitcnt lgkmcnt(3)
    v_mfma_f32_32x32x16_bf16 v[80:95], v[148:151], v[128:131], v[80:95]
    ds_read_b64_tr_b16 v[154:155], v28 offset:62464
    ds_read_b64_tr_b16 v[156:157], v29 offset:61440
    s_waitcnt lgkmcnt(4)
    v_mfma_f32_32x32x16_bf16 v[96:111], v[144:147], v[132:135], v[96:111]
    ds_read_b64_tr_b16 v[158:159], v29 offset:62464
    ds_read_b128 v[140:143], v43 offset:32768
    v_mfma_f32_32x32x16_bf16 v[112:127], v[148:151], v[132:135], v[112:127]
    s_waitcnt lgkmcnt(3)
    v_mfma_f32_32x32x16_bf16 v[64:79], v[152:155], v[136:139], v[64:79]
    s_barrier
    ds_read_b128 v[128:131], v24 offset:0
    ds_read_b64_tr_b16 v[144:145], v30 offset:16384
    s_waitcnt lgkmcnt(3)
    v_mfma_f32_32x32x16_bf16 v[80:95], v[156:159], v[136:139], v[80:95]
    ds_read_b64_tr_b16 v[146:147], v30 offset:17408
    ds_read_b64_tr_b16 v[148:149], v31 offset:16384
    s_waitcnt lgkmcnt(4)
    v_mfma_f32_32x32x16_bf16 v[96:111], v[152:155], v[140:143], v[96:111]
    ds_read_b64_tr_b16 v[150:151], v31 offset:17408
    ds_read_b128 v[132:135], v44 offset:0
    v_mfma_f32_32x32x16_bf16 v[112:127], v[156:159], v[140:143], v[112:127]
    s_waitcnt lgkmcnt(3)
    v_mfma_f32_32x32x16_bf16 v[64:79], v[144:147], v[128:131], v[64:79]
    ds_read_b128 v[136:139], v25 offset:0
    ds_read_b64_tr_b16 v[152:153], v30 offset:20480
    s_waitcnt lgkmcnt(3)
    v_mfma_f32_32x32x16_bf16 v[80:95], v[148:151], v[128:131], v[80:95]
    ds_read_b64_tr_b16 v[154:155], v30 offset:21504
    ds_read_b64_tr_b16 v[156:157], v31 offset:20480
    s_waitcnt lgkmcnt(4)
    v_mfma_f32_32x32x16_bf16 v[96:111], v[144:147], v[132:135], v[96:111]
    ds_read_b64_tr_b16 v[158:159], v31 offset:21504
    ds_read_b128 v[140:143], v45 offset:0
    v_mfma_f32_32x32x16_bf16 v[112:127], v[148:151], v[132:135], v[112:127]
    s_waitcnt lgkmcnt(3)
    v_mfma_f32_32x32x16_bf16 v[64:79], v[152:155], v[136:139], v[64:79]
    ds_read_b64_tr_b16 v[160:161], v14 offset:0
    ds_read_b64_tr_b16 v[162:163], v14 offset:512
    ds_read_b128 v[128:131], v26 offset:0
    ds_read_b64_tr_b16 v[144:145], v30 offset:24576
    s_waitcnt lgkmcnt(5)
    v_mfma_f32_32x32x16_bf16 v[80:95], v[156:159], v[136:139], v[80:95]
    ds_read_b64_tr_b16 v[146:147], v30 offset:25600
    ds_read_b64_tr_b16 v[148:149], v31 offset:24576
    s_waitcnt lgkmcnt(6)
    v_mfma_f32_32x32x16_bf16 v[96:111], v[152:155], v[140:143], v[96:111]
    ds_read_b64_tr_b16 v[150:151], v31 offset:25600
    ds_read_b128 v[132:135], v46 offset:0
    v_mfma_f32_32x32x16_bf16 v[112:127], v[156:159], v[140:143], v[112:127]
    s_waitcnt lgkmcnt(3)
    v_mfma_f32_32x32x16_bf16 v[64:79], v[144:147], v[128:131], v[64:79]
    buffer_store_dwordx4 v[160:163], v192, s[20:23], 0 offen sc1
    v_mfma_f32_16x16x32_bf16 v[16:19], v[56:59], v[160:163], 0
L_ps30:
    ds_read_b128 v[136:139], v27 offset:0
    ds_read_b64_tr_b16 v[152:153], v30 offset:28672
    s_waitcnt lgkmcnt(3)
    v_mfma_f32_32x32x16_bf16 v[80:95], v[148:151], v[128:131], v[80:95]
    ds_read_b64_tr_b16 v[154:155], v30 offset:29696
    ds_read_b64_tr_b16 v[156:157], v31 offset:28672
    s_waitcnt lgkmcnt(4)
    v_mfma_f32_32x32x16_bf16 v[96:111], v[144:147], v[132:135], v[96:111]
    ds_read_b64_tr_b16 v[158:159], v31 offset:29696
    ds_read_b128 v[140:143], v47 offset:0
    v_mfma_f32_32x32x16_bf16 v[112:127], v[148:151], v[132:135], v[112:127]
    s_waitcnt lgkmcnt(3)
    v_mfma_f32_32x32x16_bf16 v[64:79], v[152:155], v[136:139], v[64:79]
    s_barrier
    ds_read_b64_tr_b16 v[164:165], v14 offset:4096
    ds_read_b64_tr_b16 v[166:167], v14 offset:4608
    ds_read_b128 v[128:131], v24 offset:32768
    ds_read_b64_tr_b16 v[144:145], v30 offset:49152
    s_waitcnt lgkmcnt(5)
    v_mfma_f32_32x32x16_bf16 v[80:95], v[156:159], v[136:139], v[80:95]
    ds_read_b64_tr_b16 v[146:147], v30 offset:50176
    ds_read_b64_tr_b16 v[148:149], v31 offset:49152
    s_waitcnt lgkmcnt(6)
    v_mfma_f32_32x32x16_bf16 v[96:111], v[152:155], v[140:143], v[96:111]
    ds_read_b64_tr_b16 v[150:151], v31 offset:50176
    ds_read_b128 v[132:135], v44 offset:32768
    v_mfma_f32_32x32x16_bf16 v[112:127], v[156:159], v[140:143], v[112:127]
    s_waitcnt lgkmcnt(3)
    v_mfma_f32_32x32x16_bf16 v[64:79], v[144:147], v[128:131], v[64:79]
    buffer_store_dwordx4 v[164:167], v193, s[20:23], 0 offen sc1
    v_mfma_f32_16x16x32_bf16 v[16:19], v[56:59], v[164:167], v[16:19]
L_ps31:
    ds_read_b128 v[136:139], v25 offset:32768
    ds_read_b64_tr_b16 v[152:153], v30 offset:53248
    s_waitcnt lgkmcnt(3)
    v_mfma_f32_32x32x16_bf16 v[80:95], v[148:151], v[128:131], v[80:95]
    ds_read_b64_tr_b16 v[154:155], v30 offset:54272
    ds_read_b64_tr_b16 v[156:157], v31 offset:53248
    s_waitcnt lgkmcnt(4)
    v_mfma_f32_32x32x16_bf16 v[96:111], v[144:147], v[132:135], v[96:111]
    ds_read_b64_tr_b16 v[158:159], v31 offset:54272
    ds_read_b128 v[140:143], v45 offset:32768
    v_mfma_f32_32x32x16_bf16 v[112:127], v[148:151], v[132:135], v[112:127]
    s_waitcnt lgkmcnt(3)
    v_mfma_f32_32x32x16_bf16 v[64:79], v[152:155], v[136:139], v[64:79]
    ds_read_b64_tr_b16 v[168:169], v14 offset:8192
    ds_read_b64_tr_b16 v[170:171], v14 offset:8704
    ds_read_b128 v[128:131], v26 offset:32768
    ds_read_b64_tr_b16 v[144:145], v30 offset:57344
    s_waitcnt lgkmcnt(5)
    v_mfma_f32_32x32x16_bf16 v[80:95], v[156:159], v[136:139], v[80:95]
    ds_read_b64_tr_b16 v[146:147], v30 offset:58368
    ds_read_b64_tr_b16 v[148:149], v31 offset:57344
    s_waitcnt lgkmcnt(6)
    v_mfma_f32_32x32x16_bf16 v[96:111], v[152:155], v[140:143], v[96:111]
    ds_read_b64_tr_b16 v[150:151], v31 offset:58368
    ds_read_b128 v[132:135], v46 offset:32768
    v_mfma_f32_32x32x16_bf16 v[112:127], v[156:159], v[140:143], v[112:127]
    s_waitcnt lgkmcnt(3)
    v_mfma_f32_32x32x16_bf16 v[64:79], v[144:147], v[128:131], v[64:79]
    buffer_store_dwordx4 v[168:171], v194, s[20:23], 0 offen sc1
    v_mfma_f32_16x16x32_bf16 v[16:19], v[56:59], v[168:171], v[16:19]
L_ps32:
    ds_read_b128 v[136:139], v27 offset:32768
    ds_read_b64_tr_b16 v[152:153], v30 offset:61440
    s_waitcnt lgkmcnt(3)
    v_mfma_f32_32x32x16_bf16 v[80:95], v[148:151], v[128:131], v[80:95]
    ds_read_b64_tr_b16 v[154:155], v30 offset:62464
    ds_read_b64_tr_b16 v[156:157], v31 offset:61440
    s_waitcnt lgkmcnt(4)
    v_mfma_f32_32x32x16_bf16 v[96:111], v[144:147], v[132:135], v[96:111]
    ds_read_b64_tr_b16 v[158:159], v31 offset:62464
    ds_read_b128 v[140:143], v47 offset:32768
    v_mfma_f32_32x32x16_bf16 v[112:127], v[148:151], v[132:135], v[112:127]
    s_waitcnt lgkmcnt(3)
    v_mfma_f32_32x32x16_bf16 v[64:79], v[152:155], v[136:139], v[64:79]
    s_barrier
    ds_read_b64_tr_b16 v[172:173], v14 offset:12288
    ds_read_b64_tr_b16 v[174:175], v14 offset:12800
    ds_read_b128 v[128:131], v20 offset:0
    ds_read_b64_tr_b16 v[144:145], v28 offset:16384
    s_waitcnt lgkmcnt(5)
    v_mfma_f32_32x32x16_bf16 v[80:95], v[156:159], v[136:139], v[80:95]
    ds_read_b64_tr_b16 v[146:147], v28 offset:17408
    ds_read_b64_tr_b16 v[148:149], v29 offset:16384
    s_waitcnt lgkmcnt(6)
    v_mfma_f32_32x32x16_bf16 v[96:111], v[152:155], v[140:143], v[96:111]
    ds_read_b64_tr_b16 v[150:151], v29 offset:17408
    ds_read_b128 v[132:135], v40 offset:0
    v_mfma_f32_32x32x16_bf16 v[112:127], v[156:159], v[140:143], v[112:127]
    s_waitcnt lgkmcnt(3)
    v_mfma_f32_32x32x16_bf16 v[64:79], v[144:147], v[128:131], v[64:79]
    buffer_store_dwordx4 v[172:175], v195, s[20:23], 0 offen sc1
    v_mfma_f32_16x16x32_bf16 v[16:19], v[56:59], v[172:175], v[16:19]
L_ps33:
    ds_read_b128 v[136:139], v21 offset:0
    ds_read_b64_tr_b16 v[152:153], v28 offset:20480
    s_waitcnt lgkmcnt(3)
    v_mfma_f32_32x32x16_bf16 v[80:95], v[148:151], v[128:131], v[80:95]
    ds_read_b64_tr_b16 v[154:155], v28 offset:21504
    ds_read_b64_tr_b16 v[156:157], v29 offset:20480
    s_waitcnt lgkmcnt(4)
    v_mfma_f32_32x32x16_bf16 v[96:111], v[144:147], v[132:135], v[96:111]
    ds_read_b64_tr_b16 v[158:159], v29 offset:21504
    ds_read_b128 v[140:143], v41 offset:0
    v_mfma_f32_32x32x16_bf16 v[112:127], v[148:151], v[132:135], v[112:127]
    s_waitcnt lgkmcnt(3)
    v_mfma_f32_32x32x16_bf16 v[64:79], v[152:155], v[136:139], v[64:79]
    ds_read_b64_tr_b16 v[176:177], v14 offset:16384
    ds_read_b64_tr_b16 v[178:179], v14 offset:16896
    ds_read_b128 v[128:131], v22 offset:0
    ds_read_b64_tr_b16 v[144:145], v28 offset:24576
    s_waitcnt lgkmcnt(5)
    v_mfma_f32_32x32x16_bf16 v[80:95], v[156:159], v[136:139], v[80:95]
    ds_read_b64_tr_b16 v[146:147], v28 offset:25600
    ds_read_b64_tr_b16 v[148:149], v29 offset:24576
    s_waitcnt lgkmcnt(6)
    v_mfma_f32_32x32x16_bf16 v[96:111], v[152:155], v[140:143], v[96:111]
    ds_read_b64_tr_b16 v[150:151], v29 offset:25600
    ds_read_b128 v[132:135], v42 offset:0
    v_mfma_f32_32x32x16_bf16 v[112:127], v[156:159], v[140:143], v[112:127]
    s_waitcnt lgkmcnt(3)
    v_mfma_f32_32x32x16_bf16 v[64:79], v[144:147], v[128:131], v[64:79]
    buffer_store_dwordx4 v[176:179], v196, s[20:23], 0 offen sc1
    v_mfma_f32_16x16x32_bf16 v[16:19], v[56:59], v[176:179], v[16:19]
L_ps34:
    ds_read_b128 v[136:139], v23 offset:0
    ds_read_b64_tr_b16 v[152:153], v28 offset:28672
    s_waitcnt lgkmcnt(3)
    v_mfma_f32_32x32x16_bf16 v[80:95], v[148:151], v[128:131], v[80:95]
    ds_read_b64_tr_b16 v[154:155], v28 offset:29696
    ds_read_b64_tr_b16 v[156:157], v29 offset:28672
    s_waitcnt lgkmcnt(4)
    v_mfma_f32_32x32x16_bf16 v[96:111], v[144:147], v[132:135], v[96:111]
    ds_read_b64_tr_b16 v[158:159], v29 offset:29696
    ds_read_b128 v[140:143], v43 offset:0
    v_mfma_f32_32x32x16_bf16 v[112:127], v[148:151], v[132:135], v[112:127]
    s_waitcnt lgkmcnt(3)
    v_mfma_f32_32x32x16_bf16 v[64:79], v[152:155], v[136:139], v[64:79]
    s_barrier
    ds_read_b64_tr_b16 v[180:181], v14 offset:20480
    ds_read_b64_tr_b16 v[182:183], v14 offset:20992
    ds_read_b128 v[128:131], v20 offset:32768
    ds_read_b64_tr_b16 v[144:145], v28 offset:49152
    s_waitcnt lgkmcnt(5)
    v_mfma_f32_32x32x16_bf16 v[80:95], v[156:159], v[136:139], v[80:95]
    ds_read_b64_tr_b16 v[146:147], v28 offset:50176
    ds_read_b64_tr_b16 v[148:149], v29 offset:49152
    s_waitcnt lgkmcnt(6)
    v_mfma_f32_32x32x16_bf16 v[96:111], v[152:155], v[140:143], v[96:111]
    ds_read_b64_tr_b16 v[150:151], v29 offset:50176
    ds_read_b128 v[132:135], v40 offset:32768
    v_mfma_f32_32x32x16_bf16 v[112:127], v[156:159], v[140:143], v[112:127]
    s_waitcnt lgkmcnt(3)
    v_mfma_f32_32x32x16_bf16 v[64:79], v[144:147], v[128:131], v[64:79]
    s_cmp_le_u32 s38, 5
    s_cbranch_scc1 L_ps35
    buffer_store_dwordx4 v[180:183], v197, s[20:23], 0 offen sc1
    v_mfma_f32_16x16x32_bf16 v[16:19], v[56:59], v[180:183], v[16:19]
L_ps35:
    ds_read_b128 v[136:139], v21 offset:32768
    ds_read_b64_tr_b16 v[152:153], v28 offset:53248
    s_waitcnt lgkmcnt(3)
    v_mfma_f32_32x32x16_bf16 v[80:95], v[148:151], v[128:131], v[80:95]
    ds_read_b64_tr_b16 v[154:155], v28 offset:54272
    ds_read_b64_tr_b16 v[156:157], v29 offset:53248
    s_waitcnt lgkmcnt(4)
    v_mfma_f32_32x32x16_bf16 v[96:111], v[144:147], v[132:135], v[96:111]
    ds_read_b64_tr_b16 v[158:159], v29 offset:54272
    ds_read_b128 v[140:143], v41 offset:32768
    v_mfma_f32_32x32x16_bf16 v[112:127], v[148:151], v[132:135], v[112:127]
    s_waitcnt lgkmcnt(3)
    v_mfma_f32_32x32x16_bf16 v[64:79], v[152:155], v[136:139], v[64:79]
    ds_read_b64_tr_b16 v[184:185], v14 offset:24576
    ds_read_b64_tr_b16 v[186:187], v14 offset:25088
    ds_read_b128 v[128:131], v22 offset:32768
    ds_read_b64_tr_b16 v[144:145], v28 offset:57344
    s_waitcnt lgkmcnt(5)
    v_mfma_f32_32x32x16_bf16 v[80:95], v[156:159], v[136:139], v[80:95]
    ds_read_b64_tr_b16 v[146:147], v28 offset:58368
    ds_read_b64_tr_b16 v[148:149], v29 offset:57344
    s_waitcnt lgkmcnt(6)
    v_mfma_f32_32x32x16_bf16 v[96:111], v[152:155], v[140:143], v[96:111]
    ds_read_b64_tr_b16 v[150:151], v29 offset:58368
    ds_read_b128 v[132:135], v42 offset:32768
    v_mfma_f32_32x32x16_bf16 v[112:127], v[156:159], v[140:143], v[112:127]
    s_waitcnt lgkmcnt(3)
    v_mfma_f32_32x32x16_bf16 v[64:79], v[144:147], v[128:131], v[64:79]
    s_cmp_le_u32 s38, 6
    s_cbranch_scc1 L_ps36
    buffer_store_dwordx4 v[184:187], v198, s[20:23], 0 offen sc1
    v_mfma_f32_16x16x32_bf16 v[16:19], v[56:59], v[184:187], v[16:19]
L_ps36:
    ds_read_b128 v[136:139], v23 offset:32768
    ds_read_b64_tr_b16 v[152:153], v28 offset:61440
    s_waitcnt lgkmcnt(3)
    v_mfma_f32_32x32x16_bf16 v[80:95], v[148:151], v[128:131], v[80:95]
    ds_read_b64_tr_b16 v[154:155], v28 offset:62464
    ds_read_b64_tr_b16 v[156:157], v29 offset:61440
    s_waitcnt lgkmcnt(4)
    v_mfma_f32_32x32x16_bf16 v[96:111], v[144:147], v[132:135], v[96:111]
    ds_read_b64_tr_b16 v[158:159], v29 offset:62464
    ds_read_b128 v[140:143], v43 offset:32768
    v_mfma_f32_32x32x16_bf16 v[112:127], v[148:151], v[132:135], v[112:127]
    s_waitcnt lgkmcnt(3)
    v_mfma_f32_32x32x16_bf16 v[64:79], v[152:155], v[136:139], v[64:79]
    s_waitcnt lgkmcnt(1)
    v_mfma_f32_32x32x16_bf16 v[80:95], v[156:159], v[136:139], v[80:95]
    s_waitcnt lgkmcnt(0)
    v_mfma_f32_32x32x16_bf16 v[96:111], v[152:155], v[140:143], v[96:111]
    v_mfma_f32_32x32x16_bf16 v[112:127], v[156:159], v[140:143], v[112:127]
    s_cmp_eq_u32 s39, 0
    s_cbranch_scc1 L_pc37
    v_lshlrev_b32 v62, 2, v1
    s_mov_b64 exec, 0xffff
    buffer_store_dword v16, v62, s[20:23], s39 offen sc1
    s_mov_b64 exec, -1
L_pc37:
    s_barrier
    v_lshl_add_u32 v37, v36, 2, s42
    v_xor_b32 v38, 128, v37
    ds_read_b32 v40, v37
    ds_read_b32 v42, v37 offset:512
    ds_read_b32 v44, v38
    ds_read_b32 v46, v38 offset:512
    v_lshl_add_u32 v37, v39, 4, s41
    v_xor_b32 v38, 128, v37
    ds_read_b128 v[128:131], v37 offset:0
    ds_read_b128 v[132:135], v37 offset:32
    ds_read_b128 v[136:139], v37 offset:64
    ds_read_b128 v[140:143], v37 offset:96
    ds_read_b128 v[144:147], v38 offset:0
    ds_read_b128 v[148:151], v38 offset:32
    ds_read_b128 v[152:155], v38 offset:64
    ds_read_b128 v[156:159], v38 offset:96
    s_waitcnt lgkmcnt(8)
    v_mov_b32 v41, v40
    v_mov_b32 v43, v42
    v_mov_b32 v45, v44
    v_mov_b32 v47, v46
    s_waitcnt lgkmcnt(0)
    v_pk_mul_f32 v[48:49], v[128:129], v[42:43]
    v_pk_fma_f32 v[64:65], v[64:65], v[40:41], v[48:49] neg_lo:[0,0,1] neg_hi:[0,0,1]
    v_pk_mul_f32 v[50:51], v[130:131], v[42:43]
    v_pk_fma_f32 v[66:67], v[66:67], v[40:41], v[50:51] neg_lo:[0,0,1] neg_hi:[0,0,1]
    v_pk_mul_f32 v[52:53], v[132:133], v[42:43]
    v_pk_fma_f32 v[68:69], v[68:69], v[40:41], v[52:53] neg_lo:[0,0,1] neg_hi:[0,0,1]
    v_pk_mul_f32 v[54:55], v[134:135], v[42:43]
    v_pk_fma_f32 v[70:71], v[70:71], v[40:41], v[54:55] neg_lo:[0,0,1] neg_hi:[0,0,1]
    v_pk_mul_f32 v[48:49], v[136:137], v[42:43]
    v_pk_fma_f32 v[72:73], v[72:73], v[40:41], v[48:49] neg_lo:[0,0,1] neg_hi:[0,0,1]
    v_pk_mul_f32 v[50:51], v[138:139], v[42:43]
    v_pk_fma_f32 v[74:75], v[74:75], v[40:41], v[50:51] neg_lo:[0,0,1] neg_hi:[0,0,1]
    v_pk_mul_f32 v[52:53], v[140:141], v[42:43]
    v_pk_fma_f32 v[76:77], v[76:77], v[40:41], v[52:53] neg_lo:[0,0,1] neg_hi:[0,0,1]
    v_pk_mul_f32 v[54:55], v[142:143], v[42:43]
    v_pk_fma_f32 v[78:79], v[78:79], v[40:41], v[54:55] neg_lo:[0,0,1] neg_hi:[0,0,1]
    v_cvt_pk_bf16_f32 v160, v64, v65
    v_cvt_pk_bf16_f32 v161, v66, v67
    v_cvt_pk_bf16_f32 v162, v68, v69
    v_cvt_pk_bf16_f32 v163, v70, v71
    v_cvt_pk_bf16_f32 v164, v72, v73
    v_cvt_pk_bf16_f32 v165, v74, v75
    v_cvt_pk_bf16_f32 v166, v76, v77
    v_cvt_pk_bf16_f32 v167, v78, v79
    buffer_store_dwordx2 v[160:161], v224, s[20:23], s45 offen sc1
    buffer_store_dwordx2 v[162:163], v225, s[20:23], s45 offen sc1
    buffer_store_dwordx2 v[164:165], v226, s[20:23], s45 offen sc1
    buffer_store_dwordx2 v[166:167], v227, s[20:23], s45 offen sc1
    v_pk_mul_f32 v[48:49], v[144:145], v[42:43]
    v_pk_fma_f32 v[80:81], v[80:81], v[40:41], v[48:49] neg_lo:[0,0,1] neg_hi:[0,0,1]
    v_pk_mul_f32 v[50:51], v[146:147], v[42:43]
    v_pk_fma_f32 v[82:83], v[82:83], v[40:41], v[50:51] neg_lo:[0,0,1] neg_hi:[0,0,1]
    v_pk_mul_f32 v[52:53], v[148:149], v[42:43]
    v_pk_fma_f32 v[84:85], v[84:85], v[40:41], v[52:53] neg_lo:[0,0,1] neg_hi:[0,0,1]
    v_pk_mul_f32 v[54:55], v[150:151], v[42:43]
    v_pk_fma_f32 v[86:87], v[86:87], v[40:41], v[54:55] neg_lo:[0,0,1] neg_hi:[0,0,1]
    v_pk_mul_f32 v[48:49], v[152:153], v[42:43]
    v_pk_fma_f32 v[88:89], v[88:89], v[40:41], v[48:49] neg_lo:[0,0,1] neg_hi:[0,0,1]
    v_pk_mul_f32 v[50:51], v[154:155], v[42:43]
    v_pk_fma_f32 v[90:91], v[90:91], v[40:41], v[50:51] neg_lo:[0,0,1] neg_hi:[0,0,1]
    v_pk_mul_f32 v[52:53], v[156:157], v[42:43]
    v_pk_fma_f32 v[92:93], v[92:93], v[40:41], v[52:53] neg_lo:[0,0,1] neg_hi:[0,0,1]
    v_pk_mul_f32 v[54:55], v[158:159], v[42:43]
    v_pk_fma_f32 v[94:95], v[94:95], v[40:41], v[54:55] neg_lo:[0,0,1] neg_hi:[0,0,1]
    v_cvt_pk_bf16_f32 v168, v80, v81
    v_cvt_pk_bf16_f32 v169, v82, v83
    v_cvt_pk_bf16_f32 v170, v84, v85
    v_cvt_pk_bf16_f32 v171, v86, v87
    v_cvt_pk_bf16_f32 v172, v88, v89
    v_cvt_pk_bf16_f32 v173, v90, v91
    v_cvt_pk_bf16_f32 v174, v92, v93
    v_cvt_pk_bf16_f32 v175, v94, v95
    buffer_store_dwordx2 v[168:169], v228, s[20:23], s45 offen sc1
    buffer_store_dwordx2 v[170:171], v229, s[20:23], s45 offen sc1
    buffer_store_dwordx2 v[172:173], v230, s[20:23], s45 offen sc1
    buffer_store_dwordx2 v[174:175], v231, s[20:23], s45 offen sc1
    v_pk_mul_f32 v[48:49], v[128:129], v[46:47]
    v_pk_fma_f32 v[96:97], v[96:97], v[44:45], v[48:49] neg_lo:[0,0,1] neg_hi:[0,0,1]
    v_pk_mul_f32 v[50:51], v[130:131], v[46:47]
    v_pk_fma_f32 v[98:99], v[98:99], v[44:45], v[50:51] neg_lo:[0,0,1] neg_hi:[0,0,1]
    v_pk_mul_f32 v[52:53], v[132:133], v[46:47]
    v_pk_fma_f32 v[100:101], v[100:101], v[44:45], v[52:53] neg_lo:[0,0,1] neg_hi:[0,0,1]
    v_pk_mul_f32 v[54:55], v[134:135], v[46:47]
    v_pk_fma_f32 v[102:103], v[102:103], v[44:45], v[54:55] neg_lo:[0,0,1] neg_hi:[0,0,1]
    v_pk_mul_f32 v[48:49], v[136:137], v[46:47]
    v_pk_fma_f32 v[104:105], v[104:105], v[44:45], v[48:49] neg_lo:[0,0,1] neg_hi:[0,0,1]
    v_pk_mul_f32 v[50:51], v[138:139], v[46:47]
    v_pk_fma_f32 v[106:107], v[106:107], v[44:45], v[50:51] neg_lo:[0,0,1] neg_hi:[0,0,1]
    v_pk_mul_f32 v[52:53], v[140:141], v[46:47]
    v_pk_fma_f32 v[108:109], v[108:109], v[44:45], v[52:53] neg_lo:[0,0,1] neg_hi:[0,0,1]
    v_pk_mul_f32 v[54:55], v[142:143], v[46:47]
    v_pk_fma_f32 v[110:111], v[110:111], v[44:45], v[54:55] neg_lo:[0,0,1] neg_hi:[0,0,1]
    v_cvt_pk_bf16_f32 v176, v96, v97
    v_cvt_pk_bf16_f32 v177, v98, v99
    v_cvt_pk_bf16_f32 v178, v100, v101
    v_cvt_pk_bf16_f32 v179, v102, v103
    v_cvt_pk_bf16_f32 v180, v104, v105
    v_cvt_pk_bf16_f32 v181, v106, v107
    v_cvt_pk_bf16_f32 v182, v108, v109
    v_cvt_pk_bf16_f32 v183, v110, v111
    buffer_store_dwordx2 v[176:177], v224, s[20:23], s46 offen sc1
    buffer_store_dwordx2 v[178:179], v225, s[20:23], s46 offen sc1
    buffer_store_dwordx2 v[180:181], v226, s[20:23], s46 offen sc1
    buffer_store_dwordx2 v[182:183], v227, s[20:23], s46 offen sc1
    v_pk_mul_f32 v[48:49], v[144:145], v[46:47]
    v_pk_fma_f32 v[112:113], v[112:113], v[44:45], v[48:49] neg_lo:[0,0,1] neg_hi:[0,0,1]
    v_pk_mul_f32 v[50:51], v[146:147], v[46:47]
    v_pk_fma_f32 v[114:115], v[114:115], v[44:45], v[50:51] neg_lo:[0,0,1] neg_hi:[0,0,1]
    v_pk_mul_f32 v[52:53], v[148:149], v[46:47]
    v_pk_fma_f32 v[116:117], v[116:117], v[44:45], v[52:53] neg_lo:[0,0,1] neg_hi:[0,0,1]
    v_pk_mul_f32 v[54:55], v[150:151], v[46:47]
    v_pk_fma_f32 v[118:119], v[118:119], v[44:45], v[54:55] neg_lo:[0,0,1] neg_hi:[0,0,1]
    v_pk_mul_f32 v[48:49], v[152:153], v[46:47]
    v_pk_fma_f32 v[120:121], v[120:121], v[44:45], v[48:49] neg_lo:[0,0,1] neg_hi:[0,0,1]
    v_pk_mul_f32 v[50:51], v[154:155], v[46:47]
    v_pk_fma_f32 v[122:123], v[122:123], v[44:45], v[50:51] neg_lo:[0,0,1] neg_hi:[0,0,1]
    v_pk_mul_f32 v[52:53], v[156:157], v[46:47]
    v_pk_fma_f32 v[124:125], v[124:125], v[44:45], v[52:53] neg_lo:[0,0,1] neg_hi:[0,0,1]
    v_pk_mul_f32 v[54:55], v[158:159], v[46:47]
    v_pk_fma_f32 v[126:127], v[126:127], v[44:45], v[54:55] neg_lo:[0,0,1] neg_hi:[0,0,1]
    v_cvt_pk_bf16_f32 v184, v112, v113
    v_cvt_pk_bf16_f32 v185, v114, v115
    v_cvt_pk_bf16_f32 v186, v116, v117
    v_cvt_pk_bf16_f32 v187, v118, v119
    v_cvt_pk_bf16_f32 v188, v120, v121
    v_cvt_pk_bf16_f32 v189, v122, v123
    v_cvt_pk_bf16_f32 v190, v124, v125
    v_cvt_pk_bf16_f32 v191, v126, v127
    buffer_store_dwordx2 v[184:185], v228, s[20:23], s46 offen sc1
    buffer_store_dwordx2 v[186:187], v229, s[20:23], s46 offen sc1
    buffer_store_dwordx2 v[188:189], v230, s[20:23], s46 offen sc1
    buffer_store_dwordx2 v[190:191], v231, s[20:23], s46 offen sc1
    v_mov_b32 v10, 161856
    v_mov_b32 v11, 1
    s_mov_b64 exec, 1
    ds_add_u32 v10, v11 offset:12
    s_mov_b64 exec, -1
    s_mov_b32 s24, 1
    s_branch L_k2
L_k1_v:
    s_lshl_b32 s43, s31, 2
    s_lshl_b32 s44, s34, 1
    s_add_u32 s43, s43, s44
    s_add_u32 s43, s43, s35
    s_lshr_b32 s44, s43, 3
    s_mul_i32 s44, s44, 327680
    s_and_b32 s45, s43, 7
    s_xor_b32 s46, s45, 1
    s_mul_i32 s45, s45, 1280
    s_mul_i32 s46, s46, 1280
    s_add_u32 s45, s45, s44
    s_add_u32 s46, s46, s44
    s_sub_u32 s41, s32, 10
    s_lshl_b32 s41, s41, 7
    s_lshl_b32 s42, s35, 6
    s_add_u32 s41, s41, s42
    s_lshl_b32 s42, s34, 5
    s_add_u32 s41, s41, s42
    s_add_u32 s45, s45, 5242880
    s_add_u32 s46, s46, 5242880
    v_add_u32 v10, s41, v36
    v_xor_b32 v10, 0, v10
    v_mul_u32_u24 v11, 52429, v10
    v_lshrrev_b32 v11, 20, v11
    v_mul_u32_u24 v11, 9920, v11
    v_lshl_add_u32 v11, v10, 4, v11
    v_mul_u32_u24 v12, 320, v39
    v_add_u32 v224, v11, v12
    v_add_u32 v10, s41, v36
    v_xor_b32 v10, 32, v10
    v_mul_u32_u24 v11, 52429, v10
    v_lshrrev_b32 v11, 20, v11
    v_mul_u32_u24 v11, 9920, v11
    v_lshl_add_u32 v11, v10, 4, v11
    v_mul_u32_u24 v12, 320, v39
    v_add_u32 v225, v11, v12
    s_lshl_b32 s41, s35, 1
    s_add_u32 s41, s41, s34
    s_lshl_b32 s41, s41, 7
    s_mul_i32 s40, s32, 10
    s_add_u32 s40, s40, s29
    s_lshl_b32 s40, s40, 9
    s_add_u32 s40, s40, s41
    s_add_u32 s40, s40, 18006016
    s_cmp_lt_u32 s31, 10
    s_cselect_b32 s43, 0, 0x40000000
    s_add_u32 s41, s41, 160768
    v_lshl_add_u32 v37, v36, 2, s43
    s_lshl_b32 s42, s34, 1
    s_add_u32 s42, s42, s35
    s_lshl_b32 s42, s42, 7
    s_add_u32 s42, s42, 159744
    v_bfe_u32 v11, v1, 2, 2
    v_lshrrev_b32 v10, 4, v1
    v_lshl_add_u32 v11, v10, 3, v11
    v_lshlrev_b32 v11, 7, v11
    v_and_b32 v12, 3, v1
    v_lshl_add_u32 v11, v12, 4, v11
    s_lshl_b32 s43, s34, 6
    s_lshl_b32 s44, s35, 3
    s_add_u32 s43, s43, s44
    s_add_u32 s43, s43, 131072
    v_add_u32 v14, s43, v11
    v_lshlrev_b32 v15, 4, v1
    s_mul_i32 s71, s31, 15
    s_add_u32 s71, s71, s32
    s_add_u32 s71, s71, 41
    s_lshl_b32 s71, s71, 7
    s_lshl_b32 s43, s30, 6
    s_add_u32 s43, s43, 161280
    v_mov_b32 v13, s43
    v_mov_b32 v56, 0x3f803f80
    v_mov_b32 v57, 0x3f803f80
    v_mov_b32 v58, 0x3f803f80
    v_mov_b32 v59, 0x3f803f80
    s_barrier
    ds_read_b128 v[128:131], v20 offset:0
    ds_read_b64_tr_b16 v[144:145], v28 offset:16384
    ds_read_b64_tr_b16 v[146:147], v28 offset:17408
    ds_read_b64_tr_b16 v[148:149], v29 offset:16384
    ds_read_b64_tr_b16 v[150:151], v29 offset:17408
    ds_read_b128 v[132:135], v40 offset:0
    s_waitcnt lgkmcnt(3)
    v_mfma_f32_32x32x16_bf16 v[64:79], v[128:131], v[144:147], 0
    ds_read_b128 v[136:139], v21 offset:0
    ds_read_b64_tr_b16 v[152:153], v28 offset:20480
    s_waitcnt lgkmcnt(3)
    v_mfma_f32_32x32x16_bf16 v[80:95], v[128:131], v[148:151], 0
    ds_read_b64_tr_b16 v[154:155], v28 offset:21504
    ds_read_b64_tr_b16 v[156:157], v29 offset:20480
    s_waitcnt lgkmcnt(4)
    v_mfma_f32_32x32x16_bf16 v[96:111], v[132:135], v[144:147], 0
    ds_read_b64_tr_b16 v[158:159], v29 offset:21504
    ds_read_b128 v[140:143], v41 offset:0
    v_mfma_f32_32x32x16_bf16 v[112:127], v[132:135], v[148:151], 0
    v_mfma_f32_16x16x32_bf16 v[32:35], v[4:7], v[144:147], 0
    s_waitcnt lgkmcnt(3)
    v_mfma_f32_32x32x16_bf16 v[64:79], v[136:139], v[152:155], v[64:79]
    ds_read_b128 v[128:131], v22 offset:0
    ds_read_b64_tr_b16 v[144:145], v28 offset:24576
    s_waitcnt lgkmcnt(3)
    v_mfma_f32_32x32x16_bf16 v[80:95], v[136:139], v[156:159], v[80:95]
    ds_read_b64_tr_b16 v[146:147], v28 offset:25600
    ds_read_b64_tr_b16 v[148:149], v29 offset:24576
    s_waitcnt lgkmcnt(4)
    v_mfma_f32_32x32x16_bf16 v[96:111], v[140:143], v[152:155], v[96:111]
    ds_read_b64_tr_b16 v[150:151], v29 offset:25600
    ds_read_b128 v[132:135], v42 offset:0
    v_mfma_f32_32x32x16_bf16 v[112:127], v[140:143], v[156:159], v[112:127]
    v_mfma_f32_16x16x32_bf16 v[32:35], v[4:7], v[152:155], v[32:35]
    s_waitcnt lgkmcnt(3)
    v_mfma_f32_32x32x16_bf16 v[64:79], v[128:131], v[144:147], v[64:79]
    ds_read_b128 v[136:139], v23 offset:0
    ds_read_b64_tr_b16 v[152:153], v28 offset:28672
    s_waitcnt lgkmcnt(3)
    v_mfma_f32_32x32x16_bf16 v[80:95], v[128:131], v[148:151], v[80:95]
    ds_read_b64_tr_b16 v[154:155], v28 offset:29696
    ds_read_b64_tr_b16 v[156:157], v29 offset:28672
    s_waitcnt lgkmcnt(4)
    v_mfma_f32_32x32x16_bf16 v[96:111], v[132:135], v[144:147], v[96:111]
    ds_read_b64_tr_b16 v[158:159], v29 offset:29696
    ds_read_b128 v[140:143], v43 offset:0
    v_mfma_f32_32x32x16_bf16 v[112:127], v[132:135], v[148:151], v[112:127]
    v_mfma_f32_16x16x32_bf16 v[32:35], v[4:7], v[144:147], v[32:35]
    s_waitcnt lgkmcnt(3)
    v_mfma_f32_16x16x32_bf16 v[32:35], v[4:7], v[152:155], v[32:35]
    v_mfma_f32_32x32x16_bf16 v[64:79], v[136:139], v[152:155], v[64:79]
    s_mov_b64 exec, 0xffff
    s_nop 5
    buffer_store_dword v32, v37, s[20:23], s40 offen sc1
    buffer_store_dword v33, v37, s[20:23], s40 offen offset:64 sc1
    s_mov_b64 exec, -1
    s_barrier
    ds_read_b128 v[128:131], v20 offset:32768
    ds_read_b64_tr_b16 v[144:145], v28 offset:49152
    s_waitcnt lgkmcnt(3)
    v_mfma_f32_32x32x16_bf16 v[80:95], v[136:139], v[156:159], v[80:95]
    ds_read_b64_tr_b16 v[146:147], v28 offset:50176
    ds_read_b64_tr_b16 v[148:149], v29 offset:49152
    s_waitcnt lgkmcnt(4)
    v_mfma_f32_32x32x16_bf16 v[96:111], v[140:143], v[152:155], v[96:111]
    ds_read_b64_tr_b16 v[150:151], v29 offset:50176
    ds_read_b128 v[132:135], v40 offset:32768
    v_mfma_f32_32x32x16_bf16 v[112:127], v[140:143], v[156:159], v[112:127]
    s_waitcnt lgkmcnt(3)
    v_mfma_f32_32x32x16_bf16 v[64:79], v[128:131], v[144:147], v[64:79]
    ds_read_b128 v[136:139], v21 offset:32768
    ds_read_b64_tr_b16 v[152:153], v28 offset:53248
    s_waitcnt lgkmcnt(3)
    v_mfma_f32_32x32x16_bf16 v[80:95], v[128:131], v[148:151], v[80:95]
    ds_read_b64_tr_b16 v[154:155], v28 offset:54272
    ds_read_b64_tr_b16 v[156:157], v29 offset:53248
    s_waitcnt lgkmcnt(4)
    v_mfma_f32_32x32x16_bf16 v[96:111], v[132:135], v[144:147], v[96:111]
    ds_read_b64_tr_b16 v[158:159], v29 offset:54272
    ds_read_b128 v[140:143], v41 offset:32768
    v_mfma_f32_32x32x16_bf16 v[112:127], v[132:135], v[148:151], v[112:127]
    s_waitcnt lgkmcnt(3)
    v_mfma_f32_32x32x16_bf16 v[64:79], v[136:139], v[152:155], v[64:79]
    ds_read_b128 v[128:131], v22 offset:32768
    ds_read_b64_tr_b16 v[144:145], v28 offset:57344
    s_waitcnt lgkmcnt(3)
    v_mfma_f32_32x32x16_bf16 v[80:95], v[136:139], v[156:159], v[80:95]
    ds_read_b64_tr_b16 v[146:147], v28 offset:58368
    ds_read_b64_tr_b16 v[148:149], v29 offset:57344
    s_waitcnt lgkmcnt(4)
    v_mfma_f32_32x32x16_bf16 v[96:111], v[140:143], v[152:155], v[96:111]
    ds_read_b64_tr_b16 v[150:151], v29 offset:58368
    ds_read_b128 v[132:135], v42 offset:32768
    v_mfma_f32_32x32x16_bf16 v[112:127], v[140:143], v[156:159], v[112:127]
    s_waitcnt lgkmcnt(3)
    v_mfma_f32_32x32x16_bf16 v[64:79], v[128:131], v[144:147], v[64:79]
    ds_read_b128 v[136:139], v23 offset:32768
    ds_read_b64_tr_b16 v[152:153], v28 offset:61440
    s_waitcnt lgkmcnt(3)
    v_mfma_f32_32x32x16_bf16 v[80:95], v[128:131], v[148:151], v[80:95]
    ds_read_b64_tr_b16 v[154:155], v28 offset:62464
    ds_read_b64_tr_b16 v[156:157], v29 offset:61440
    s_waitcnt lgkmcnt(4)
    v_mfma_f32_32x32x16_bf16 v[96:111], v[132:135], v[144:147], v[96:111]
    ds_read_b64_tr_b16 v[158:159], v29 offset:62464
    ds_read_b128 v[140:143], v43 offset:32768
    v_mfma_f32_32x32x16_bf16 v[112:127], v[132:135], v[148:151], v[112:127]
    s_waitcnt lgkmcnt(3)
    v_mfma_f32_32x32x16_bf16 v[64:79], v[136:139], v[152:155], v[64:79]
    s_barrier
    ds_read_b128 v[128:131], v24 offset:0
    ds_read_b64_tr_b16 v[144:145], v30 offset:16384
    s_waitcnt lgkmcnt(3)
    v_mfma_f32_32x32x16_bf16 v[80:95], v[136:139], v[156:159], v[80:95]
    ds_read_b64_tr_b16 v[146:147], v30 offset:17408
    ds_read_b64_tr_b16 v[148:149], v31 offset:16384
    s_waitcnt lgkmcnt(4)
    v_mfma_f32_32x32x16_bf16 v[96:111], v[140:143], v[152:155], v[96:111]
    ds_read_b64_tr_b16 v[150:151], v31 offset:17408
    ds_read_b128 v[132:135], v44 offset:0
    v_mfma_f32_32x32x16_bf16 v[112:127], v[140:143], v[156:159], v[112:127]
    s_waitcnt lgkmcnt(3)
    v_mfma_f32_32x32x16_bf16 v[64:79], v[128:131], v[144:147], v[64:79]
    ds_read_b128 v[136:139], v25 offset:0
    ds_read_b64_tr_b16 v[152:153], v30 offset:20480
    s_waitcnt lgkmcnt(3)
    v_mfma_f32_32x32x16_bf16 v[80:95], v[128:131], v[148:151], v[80:95]
    ds_read_b64_tr_b16 v[154:155], v30 offset:21504
    ds_read_b64_tr_b16 v[156:157], v31 offset:20480
    s_waitcnt lgkmcnt(4)
    v_mfma_f32_32x32x16_bf16 v[96:111], v[132:135], v[144:147], v[96:111]
    ds_read_b64_tr_b16 v[158:159], v31 offset:21504
    ds_read_b128 v[140:143], v45 offset:0
    v_mfma_f32_32x32x16_bf16 v[112:127], v[132:135], v[148:151], v[112:127]
    s_waitcnt lgkmcnt(3)
    v_mfma_f32_32x32x16_bf16 v[64:79], v[136:139], v[152:155], v[64:79]
    ds_read_b128 v[128:131], v26 offset:0
    ds_read_b64_tr_b16 v[144:145], v30 offset:24576
    s_waitcnt lgkmcnt(3)
    v_mfma_f32_32x32x16_bf16 v[80:95], v[136:139], v[156:159], v[80:95]
    ds_read_b64_tr_b16 v[146:147], v30 offset:25600
    ds_read_b64_tr_b16 v[148:149], v31 offset:24576
    s_waitcnt lgkmcnt(4)
    v_mfma_f32_32x32x16_bf16 v[96:111], v[140:143], v[152:155], v[96:111]
    ds_read_b64_tr_b16 v[150:151], v31 offset:25600
    ds_read_b128 v[132:135], v46 offset:0
    v_mfma_f32_32x32x16_bf16 v[112:127], v[140:143], v[156:159], v[112:127]
    s_waitcnt lgkmcnt(3)
    v_mfma_f32_32x32x16_bf16 v[64:79], v[128:131], v[144:147], v[64:79]
    ds_read_b128 v[136:139], v27 offset:0
    ds_read_b64_tr_b16 v[152:153], v30 offset:28672
    s_waitcnt lgkmcnt(3)
    v_mfma_f32_32x32x16_bf16 v[80:95], v[128:131], v[148:151], v[80:95]
    ds_read_b64_tr_b16 v[154:155], v30 offset:29696
    ds_read_b64_tr_b16 v[156:157], v31 offset:28672
    s_waitcnt lgkmcnt(4)
    v_mfma_f32_32x32x16_bf16 v[96:111], v[132:135], v[144:147], v[96:111]
    ds_read_b64_tr_b16 v[158:159], v31 offset:29696
    ds_read_b128 v[140:143], v47 offset:0
    v_mfma_f32_32x32x16_bf16 v[112:127], v[132:135], v[148:151], v[112:127]
    s_waitcnt lgkmcnt(3)
    v_mfma_f32_32x32x16_bf16 v[64:79], v[136:139], v[152:155], v[64:79]
    s_waitcnt vmcnt(0)
    s_barrier
    s_cmp_eq_u32 s30, 0
    s_cbranch_scc1 L_fw38
L_fe39:
    ds_read_b128 v[128:131], v24 offset:32768
    ds_read_b64_tr_b16 v[144:145], v30 offset:49152
    s_waitcnt lgkmcnt(3)
    v_mfma_f32_32x32x16_bf16 v[80:95], v[136:139], v[156:159], v[80:95]
    ds_read_b64_tr_b16 v[146:147], v30 offset:50176
    ds_read_b64_tr_b16 v[148:149], v31 offset:49152
    s_waitcnt lgkmcnt(4)
    v_mfma_f32_32x32x16_bf16 v[96:111], v[140:143], v[152:155], v[96:111]
    ds_read_b64_tr_b16 v[150:151], v31 offset:50176
    ds_read_b128 v[132:135], v44 offset:32768
    v_mfma_f32_32x32x16_bf16 v[112:127], v[140:143], v[156:159], v[112:127]
    s_waitcnt lgkmcnt(3)
    v_mfma_f32_32x32x16_bf16 v[64:79], v[128:131], v[144:147], v[64:79]
    ds_read_b128 v[136:139], v25 offset:32768
    ds_read_b64_tr_b16 v[152:153], v30 offset:53248
    s_waitcnt lgkmcnt(3)
    v_mfma_f32_32x32x16_bf16 v[80:95], v[128:131], v[148:151], v[80:95]
    ds_read_b64_tr_b16 v[154:155], v30 offset:54272
    ds_read_b64_tr_b16 v[156:157], v31 offset:53248
    s_waitcnt lgkmcnt(4)
    v_mfma_f32_32x32x16_bf16 v[96:111], v[132:135], v[144:147], v[96:111]
    ds_read_b64_tr_b16 v[158:159], v31 offset:54272
    ds_read_b128 v[140:143], v45 offset:32768
    v_mfma_f32_32x32x16_bf16 v[112:127], v[132:135], v[148:151], v[112:127]
    s_waitcnt lgkmcnt(3)
    v_mfma_f32_32x32x16_bf16 v[64:79], v[136:139], v[152:155], v[64:79]
    ds_read_b128 v[128:131], v26 offset:32768
    ds_read_b64_tr_b16 v[144:145], v30 offset:57344
    s_waitcnt lgkmcnt(3)
    v_mfma_f32_32x32x16_bf16 v[80:95], v[136:139], v[156:159], v[80:95]
    ds_read_b64_tr_b16 v[146:147], v30 offset:58368
    ds_read_b64_tr_b16 v[148:149], v31 offset:57344
    s_waitcnt lgkmcnt(4)
    v_mfma_f32_32x32x16_bf16 v[96:111], v[140:143], v[152:155], v[96:111]
    ds_read_b64_tr_b16 v[150:151], v31 offset:58368
    ds_read_b128 v[132:135], v46 offset:32768
    v_mfma_f32_32x32x16_bf16 v[112:127], v[140:143], v[156:159], v[112:127]
    s_waitcnt lgkmcnt(3)
    v_mfma_f32_32x32x16_bf16 v[64:79], v[128:131], v[144:147], v[64:79]
    ds_read_b128 v[136:139], v27 offset:32768
    ds_read_b64_tr_b16 v[152:153], v30 offset:61440
    s_waitcnt lgkmcnt(3)
    v_mfma_f32_32x32x16_bf16 v[80:95], v[128:131], v[148:151], v[80:95]
    ds_read_b64_tr_b16 v[154:155], v30 offset:62464
    ds_read_b64_tr_b16 v[156:157], v31 offset:61440
    s_waitcnt lgkmcnt(4)
    v_mfma_f32_32x32x16_bf16 v[96:111], v[132:135], v[144:147], v[96:111]
    ds_read_b64_tr_b16 v[158:159], v31 offset:62464
    ds_read_b128 v[140:143], v47 offset:32768
    v_mfma_f32_32x32x16_bf16 v[112:127], v[132:135], v[148:151], v[112:127]
    s_waitcnt lgkmcnt(3)
    v_mfma_f32_32x32x16_bf16 v[64:79], v[136:139], v[152:155], v[64:79]
    s_barrier
    ds_read_b128 v[128:131], v20 offset:0
    ds_read_b64_tr_b16 v[144:145], v28 offset:16384
    s_waitcnt lgkmcnt(3)
    v_mfma_f32_32x32x16_bf16 v[80:95], v[136:139], v[156:159], v[80:95]
    ds_read_b64_tr_b16 v[146:147], v28 offset:17408
    ds_read_b64_tr_b16 v[148:149], v29 offset:16384
    s_waitcnt lgkmcnt(4)
    v_mfma_f32_32x32x16_bf16 v[96:111], v[140:143], v[152:155], v[96:111]
    ds_read_b64_tr_b16 v[150:151], v29 offset:17408
    ds_read_b128 v[132:135], v40 offset:0
    v_mfma_f32_32x32x16_bf16 v[112:127], v[140:143], v[156:159], v[112:127]
    s_waitcnt lgkmcnt(3)
    v_mfma_f32_32x32x16_bf16 v[64:79], v[128:131], v[144:147], v[64:79]
    ds_read_b128 v[136:139], v21 offset:0
    ds_read_b64_tr_b16 v[152:153], v28 offset:20480
    s_waitcnt lgkmcnt(3)
    v_mfma_f32_32x32x16_bf16 v[80:95], v[128:131], v[148:151], v[80:95]
    ds_read_b64_tr_b16 v[154:155], v28 offset:21504
    ds_read_b64_tr_b16 v[156:157], v29 offset:20480
    s_waitcnt lgkmcnt(4)
    v_mfma_f32_32x32x16_bf16 v[96:111], v[132:135], v[144:147], v[96:111]
    ds_read_b64_tr_b16 v[158:159], v29 offset:21504
    ds_read_b128 v[140:143], v41 offset:0
    v_mfma_f32_32x32x16_bf16 v[112:127], v[132:135], v[148:151], v[112:127]
    s_waitcnt lgkmcnt(3)
    v_mfma_f32_32x32x16_bf16 v[64:79], v[136:139], v[152:155], v[64:79]
    ds_read_b128 v[128:131], v22 offset:0
    ds_read_b64_tr_b16 v[144:145], v28 offset:24576
    s_waitcnt lgkmcnt(3)
    v_mfma_f32_32x32x16_bf16 v[80:95], v[136:139], v[156:159], v[80:95]
    ds_read_b64_tr_b16 v[146:147], v28 offset:25600
    ds_read_b64_tr_b16 v[148:149], v29 offset:24576
    s_waitcnt lgkmcnt(4)
    v_mfma_f32_32x32x16_bf16 v[96:111], v[140:143], v[152:155], v[96:111]
    ds_read_b64_tr_b16 v[150:151], v29 offset:25600
    ds_read_b128 v[132:135], v42 offset:0
    v_mfma_f32_32x32x16_bf16 v[112:127], v[140:143], v[156:159], v[112:127]
    s_waitcnt lgkmcnt(3)
    v_mfma_f32_32x32x16_bf16 v[64:79], v[128:131], v[144:147], v[64:79]
    ds_read_b128 v[136:139], v23 offset:0
    ds_read_b64_tr_b16 v[152:153], v28 offset:28672
    s_waitcnt lgkmcnt(3)
    v_mfma_f32_32x32x16_bf16 v[80:95], v[128:131], v[148:151], v[80:95]
    ds_read_b64_tr_b16 v[154:155], v28 offset:29696
    ds_read_b64_tr_b16 v[156:157], v29 offset:28672
    s_waitcnt lgkmcnt(4)
    v_mfma_f32_32x32x16_bf16 v[96:111], v[132:135], v[144:147], v[96:111]
    ds_read_b64_tr_b16 v[158:159], v29 offset:29696
    ds_read_b128 v[140:143], v43 offset:0
    v_mfma_f32_32x32x16_bf16 v[112:127], v[132:135], v[148:151], v[112:127]
    s_waitcnt lgkmcnt(3)
    v_mfma_f32_32x32x16_bf16 v[64:79], v[136:139], v[152:155], v[64:79]
    s_barrier
    ds_read_b128 v[128:131], v20 offset:32768
    ds_read_b64_tr_b16 v[144:145], v28 offset:49152
    s_waitcnt lgkmcnt(3)
    v_mfma_f32_32x32x16_bf16 v[80:95], v[136:139], v[156:159], v[80:95]
    ds_read_b64_tr_b16 v[146:147], v28 offset:50176
    ds_read_b64_tr_b16 v[148:149], v29 offset:49152
    s_waitcnt lgkmcnt(4)
    v_mfma_f32_32x32x16_bf16 v[96:111], v[140:143], v[152:155], v[96:111]
    ds_read_b64_tr_b16 v[150:151], v29 offset:50176
    ds_read_b128 v[132:135], v40 offset:32768
    v_mfma_f32_32x32x16_bf16 v[112:127], v[140:143], v[156:159], v[112:127]
    s_waitcnt lgkmcnt(3)
    v_mfma_f32_32x32x16_bf16 v[64:79], v[128:131], v[144:147], v[64:79]
    ds_read_b128 v[136:139], v21 offset:32768
    ds_read_b64_tr_b16 v[152:153], v28 offset:53248
    s_waitcnt lgkmcnt(3)
    v_mfma_f32_32x32x16_bf16 v[80:95], v[128:131], v[148:151], v[80:95]
    ds_read_b64_tr_b16 v[154:155], v28 offset:54272
    ds_read_b64_tr_b16 v[156:157], v29 offset:53248
    s_waitcnt lgkmcnt(4)
    v_mfma_f32_32x32x16_bf16 v[96:111], v[132:135], v[144:147], v[96:111]
    ds_read_b64_tr_b16 v[158:159], v29 offset:54272
    ds_read_b128 v[140:143], v41 offset:32768
    v_mfma_f32_32x32x16_bf16 v[112:127], v[132:135], v[148:151], v[112:127]
    s_waitcnt lgkmcnt(3)
    v_mfma_f32_32x32x16_bf16 v[64:79], v[136:139], v[152:155], v[64:79]
    ds_read_b128 v[192:195], v13
    ds_read_b128 v[196:199], v13 offset:16
    ds_read_b32 v200, v13 offset:32
    ds_read_b128 v[128:131], v22 offset:32768
    ds_read_b64_tr_b16 v[144:145], v28 offset:57344
    s_waitcnt lgkmcnt(6)
    v_mfma_f32_32x32x16_bf16 v[80:95], v[136:139], v[156:159], v[80:95]
    ds_read_b64_tr_b16 v[146:147], v28 offset:58368
    ds_read_b64_tr_b16 v[148:149], v29 offset:57344
    s_waitcnt lgkmcnt(7)
    v_mfma_f32_32x32x16_bf16 v[96:111], v[140:143], v[152:155], v[96:111]
    ds_read_b64_tr_b16 v[150:151], v29 offset:58368
    ds_read_b128 v[132:135], v42 offset:32768
    v_mfma_f32_32x32x16_bf16 v[112:127], v[140:143], v[156:159], v[112:127]
    s_waitcnt lgkmcnt(3)
    v_mfma_f32_32x32x16_bf16 v[64:79], v[128:131], v[144:147], v[64:79]
    v_add_u32 v192, v192, v15
    v_add_u32 v193, v193, v15
    v_add_u32 v194, v194, v15
    v_add_u32 v195, v195, v15
    v_add_u32 v196, v196, v15
    v_add_u32 v197, v197, v15
    v_add_u32 v198, v198, v15
    v_readfirstlane_b32 s38, v199
    v_readfirstlane_b32 s39, v200
    ds_read_b128 v[136:139], v23 offset:32768
    ds_read_b64_tr_b16 v[152:153], v28 offset:61440
    s_waitcnt lgkmcnt(3)
    v_mfma_f32_32x32x16_bf16 v[80:95], v[128:131], v[148:151], v[80:95]
    ds_read_b64_tr_b16 v[154:155], v28 offset:62464
    ds_read_b64_tr_b16 v[156:157], v29 offset:61440
    s_waitcnt lgkmcnt(4)
    v_mfma_f32_32x32x16_bf16 v[96:111], v[132:135], v[144:147], v[96:111]
    ds_read_b64_tr_b16 v[158:159], v29 offset:62464
    ds_read_b128 v[140:143], v43 offset:32768
    v_mfma_f32_32x32x16_bf16 v[112:127], v[132:135], v[148:151], v[112:127]
    s_waitcnt lgkmcnt(3)
    v_mfma_f32_32x32x16_bf16 v[64:79], v[136:139], v[152:155], v[64:79]
    s_barrier
    ds_read_b128 v[128:131], v24 offset:0
    ds_read_b64_tr_b16 v[144:145], v30 offset:16384
    s_waitcnt lgkmcnt(3)
    v_mfma_f32_32x32x16_bf16 v[80:95], v[136:139], v[156:159], v[80:95]
    ds_read_b64_tr_b16 v[146:147], v30 offset:17408
    ds_read_b64_tr_b16 v[148:149], v31 offset:16384
    s_waitcnt lgkmcnt(4)
    v_mfma_f32_32x32x16_bf16 v[96:111], v[140:143], v[152:155], v[96:111]
    ds_read_b64_tr_b16 v[150:151], v31 offset:17408
    ds_read_b128 v[132:135], v44 offset:0
    v_mfma_f32_32x32x16_bf16 v[112:127], v[140:143], v[156:159], v[112:127]
    s_waitcnt lgkmcnt(3)
    v_mfma_f32_32x32x16_bf16 v[64:79], v[128:131], v[144:147], v[64:79]
    ds_read_b128 v[136:139], v25 offset:0
    ds_read_b64_tr_b16 v[152:153], v30 offset:20480
    s_waitcnt lgkmcnt(3)
    v_mfma_f32_32x32x16_bf16 v[80:95], v[128:131], v[148:151], v[80:95]
    ds_read_b64_tr_b16 v[154:155], v30 offset:21504
    ds_read_b64_tr_b16 v[156:157], v31 offset:20480
    s_waitcnt lgkmcnt(4)
    v_mfma_f32_32x32x16_bf16 v[96:111], v[132:135], v[144:147], v[96:111]
    ds_read_b64_tr_b16 v[158:159], v31 offset:21504
    ds_read_b128 v[140:143], v45 offset:0
    v_mfma_f32_32x32x16_bf16 v[112:127], v[132:135], v[148:151], v[112:127]
    s_waitcnt lgkmcnt(3)
    v_mfma_f32_32x32x16_bf16 v[64:79], v[136:139], v[152:155], v[64:79]
    ds_read_b64_tr_b16 v[160:161], v14 offset:0
    ds_read_b64_tr_b16 v[162:163], v14 offset:512
    ds_read_b128 v[128:131], v26 offset:0
    ds_read_b64_tr_b16 v[144:145], v30 offset:24576
    s_waitcnt lgkmcnt(5)
    v_mfma_f32_32x32x16_bf16 v[80:95], v[136:139], v[156:159], v[80:95]
    ds_read_b64_tr_b16 v[146:147], v30 offset:25600
    ds_read_b64_tr_b16 v[148:149], v31 offset:24576
    s_waitcnt lgkmcnt(6)
    v_mfma_f32_32x32x16_bf16 v[96:111], v[140:143], v[152:155], v[96:111]
    ds_read_b64_tr_b16 v[150:151], v31 offset:25600
    ds_read_b128 v[132:135], v46 offset:0
    v_mfma_f32_32x32x16_bf16 v[112:127], v[140:143], v[156:159], v[112:127]
    s_waitcnt lgkmcnt(3)
    v_mfma_f32_32x32x16_bf16 v[64:79], v[128:131], v[144:147], v[64:79]
    buffer_store_dwordx4 v[160:163], v192, s[20:23], 0 offen sc1
    v_mfma_f32_16x16x32_bf16 v[16:19], v[56:59], v[160:163], 0
L_ps40:
    ds_read_b128 v[136:139], v27 offset:0
    ds_read_b64_tr_b16 v[152:153], v30 offset:28672
    s_waitcnt lgkmcnt(3)
    v_mfma_f32_32x32x16_bf16 v[80:95], v[128:131], v[148:151], v[80:95]
    ds_read_b64_tr_b16 v[154:155], v30 offset:29696
    ds_read_b64_tr_b16 v[156:157], v31 offset:28672
    s_waitcnt lgkmcnt(4)
    v_mfma_f32_32x32x16_bf16 v[96:111], v[132:135], v[144:147], v[96:111]
    ds_read_b64_tr_b16 v[158:159], v31 offset:29696
    ds_read_b128 v[140:143], v47 offset:0
    v_mfma_f32_32x32x16_bf16 v[112:127], v[132:135], v[148:151], v[112:127]
    s_waitcnt lgkmcnt(3)
    v_mfma_f32_32x32x16_bf16 v[64:79], v[136:139], v[152:155], v[64:79]
    s_barrier
    ds_read_b64_tr_b16 v[164:165], v14 offset:4096
    ds_read_b64_tr_b16 v[166:167], v14 offset:4608
    ds_read_b128 v[128:131], v24 offset:32768
    ds_read_b64_tr_b16 v[144:145], v30 offset:49152
    s_waitcnt lgkmcnt(5)
    v_mfma_f32_32x32x16_bf16 v[80:95], v[136:139], v[156:159], v[80:95]
    ds_read_b64_tr_b16 v[146:147], v30 offset:50176
    ds_read_b64_tr_b16 v[148:149], v31 offset:49152
    s_waitcnt lgkmcnt(6)
    v_mfma_f32_32x32x16_bf16 v[96:111], v[140:143], v[152:155], v[96:111]
    ds_read_b64_tr_b16 v[150:151], v31 offset:50176
    ds_read_b128 v[132:135], v44 offset:32768
    v_mfma_f32_32x32x16_bf16 v[112:127], v[140:143], v[156:159], v[112:127]
    s_waitcnt lgkmcnt(3)
    v_mfma_f32_32x32x16_bf16 v[64:79], v[128:131], v[144:147], v[64:79]
    buffer_store_dwordx4 v[164:167], v193, s[20:23], 0 offen sc1
    v_mfma_f32_16x16x32_bf16 v[16:19], v[56:59], v[164:167], v[16:19]
L_ps41:
    ds_read_b128 v[136:139], v25 offset:32768
    ds_read_b64_tr_b16 v[152:153], v30 offset:53248
    s_waitcnt lgkmcnt(3)
    v_mfma_f32_32x32x16_bf16 v[80:95], v[128:131], v[148:151], v[80:95]
    ds_read_b64_tr_b16 v[154:155], v30 offset:54272
    ds_read_b64_tr_b16 v[156:157], v31 offset:53248
    s_waitcnt lgkmcnt(4)
    v_mfma_f32_32x32x16_bf16 v[96:111], v[132:135], v[144:147], v[96:111]
    ds_read_b64_tr_b16 v[158:159], v31 offset:54272
    ds_read_b128 v[140:143], v45 offset:32768
    v_mfma_f32_32x32x16_bf16 v[112:127], v[132:135], v[148:151], v[112:127]
    s_waitcnt lgkmcnt(3)
    v_mfma_f32_32x32x16_bf16 v[64:79], v[136:139], v[152:155], v[64:79]
    ds_read_b64_tr_b16 v[168:169], v14 offset:8192
    ds_read_b64_tr_b16 v[170:171], v14 offset:8704
    ds_read_b128 v[128:131], v26 offset:32768
    ds_read_b64_tr_b16 v[144:145], v30 offset:57344
    s_waitcnt lgkmcnt(5)
    v_mfma_f32_32x32x16_bf16 v[80:95], v[136:139], v[156:159], v[80:95]
    ds_read_b64_tr_b16 v[146:147], v30 offset:58368
    ds_read_b64_tr_b16 v[148:149], v31 offset:57344
    s_waitcnt lgkmcnt(6)
    v_mfma_f32_32x32x16_bf16 v[96:111], v[140:143], v[152:155], v[96:111]
    ds_read_b64_tr_b16 v[150:151], v31 offset:58368
    ds_read_b128 v[132:135], v46 offset:32768
    v_mfma_f32_32x32x16_bf16 v[112:127], v[140:143], v[156:159], v[112:127]
    s_waitcnt lgkmcnt(3)
    v_mfma_f32_32x32x16_bf16 v[64:79], v[128:131], v[144:147], v[64:79]
    buffer_store_dwordx4 v[168:171], v194, s[20:23], 0 offen sc1
    v_mfma_f32_16x16x32_bf16 v[16:19], v[56:59], v[168:171], v[16:19]
L_ps42:
    ds_read_b128 v[136:139], v27 offset:32768
    ds_read_b64_tr_b16 v[152:153], v30 offset:61440
    s_waitcnt lgkmcnt(3)
    v_mfma_f32_32x32x16_bf16 v[80:95], v[128:131], v[148:151], v[80:95]
    ds_read_b64_tr_b16 v[154:155], v30 offset:62464
    ds_read_b64_tr_b16 v[156:157], v31 offset:61440
    s_waitcnt lgkmcnt(4)
    v_mfma_f32_32x32x16_bf16 v[96:111], v[132:135], v[144:147], v[96:111]
    ds_read_b64_tr_b16 v[158:159], v31 offset:62464
    ds_read_b128 v[140:143], v47 offset:32768
    v_mfma_f32_32x32x16_bf16 v[112:127], v[132:135], v[148:151], v[112:127]
    s_waitcnt lgkmcnt(3)
    v_mfma_f32_32x32x16_bf16 v[64:79], v[136:139], v[152:155], v[64:79]
    s_barrier
    ds_read_b64_tr_b16 v[172:173], v14 offset:12288
    ds_read_b64_tr_b16 v[174:175], v14 offset:12800
    ds_read_b128 v[128:131], v20 offset:0
    ds_read_b64_tr_b16 v[144:145], v28 offset:16384
    s_waitcnt lgkmcnt(5)
    v_mfma_f32_32x32x16_bf16 v[80:95], v[136:139], v[156:159], v[80:95]
    ds_read_b64_tr_b16 v[146:147], v28 offset:17408
    ds_read_b64_tr_b16 v[148:149], v29 offset:16384
    s_waitcnt lgkmcnt(6)
    v_mfma_f32_32x32x16_bf16 v[96:111], v[140:143], v[152:155], v[96:111]
    ds_read_b64_tr_b16 v[150:151], v29 offset:17408
    ds_read_b128 v[132:135], v40 offset:0
    v_mfma_f32_32x32x16_bf16 v[112:127], v[140:143], v[156:159], v[112:127]
    s_waitcnt lgkmcnt(3)
    v_mfma_f32_32x32x16_bf16 v[64:79], v[128:131], v[144:147], v[64:79]
    buffer_store_dwordx4 v[172:175], v195, s[20:23], 0 offen sc1
    v_mfma_f32_16x16x32_bf16 v[16:19], v[56:59], v[172:175], v[16:19]
L_ps43:
    ds_read_b128 v[136:139], v21 offset:0
    ds_read_b64_tr_b16 v[152:153], v28 offset:20480
    s_waitcnt lgkmcnt(3)
    v_mfma_f32_32x32x16_bf16 v[80:95], v[128:131], v[148:151], v[80:95]
    ds_read_b64_tr_b16 v[154:155], v28 offset:21504
    ds_read_b64_tr_b16 v[156:157], v29 offset:20480
    s_waitcnt lgkmcnt(4)
    v_mfma_f32_32x32x16_bf16 v[96:111], v[132:135], v[144:147], v[96:111]
    ds_read_b64_tr_b16 v[158:159], v29 offset:21504
    ds_read_b128 v[140:143], v41 offset:0
    v_mfma_f32_32x32x16_bf16 v[112:127], v[132:135], v[148:151], v[112:127]
    s_waitcnt lgkmcnt(3)
    v_mfma_f32_32x32x16_bf16 v[64:79], v[136:139], v[152:155], v[64:79]
    ds_read_b64_tr_b16 v[176:177], v14 offset:16384
    ds_read_b64_tr_b16 v[178:179], v14 offset:16896
    ds_read_b128 v[128:131], v22 offset:0
    ds_read_b64_tr_b16 v[144:145], v28 offset:24576
    s_waitcnt lgkmcnt(5)
    v_mfma_f32_32x32x16_bf16 v[80:95], v[136:139], v[156:159], v[80:95]
    ds_read_b64_tr_b16 v[146:147], v28 offset:25600
    ds_read_b64_tr_b16 v[148:149], v29 offset:24576
    s_waitcnt lgkmcnt(6)
    v_mfma_f32_32x32x16_bf16 v[96:111], v[140:143], v[152:155], v[96:111]
    ds_read_b64_tr_b16 v[150:151], v29 offset:25600
    ds_read_b128 v[132:135], v42 offset:0
    v_mfma_f32_32x32x16_bf16 v[112:127], v[140:143], v[156:159], v[112:127]
    s_waitcnt lgkmcnt(3)
    v_mfma_f32_32x32x16_bf16 v[64:79], v[128:131], v[144:147], v[64:79]
    buffer_store_dwordx4 v[176:179], v196, s[20:23], 0 offen sc1
    v_mfma_f32_16x16x32_bf16 v[16:19], v[56:59], v[176:179], v[16:19]
L_ps44:
    ds_read_b128 v[136:139], v23 offset:0
    ds_read_b64_tr_b16 v[152:153], v28 offset:28672
    s_waitcnt lgkmcnt(3)
    v_mfma_f32_32x32x16_bf16 v[80:95], v[128:131], v[148:151], v[80:95]
    ds_read_b64_tr_b16 v[154:155], v28 offset:29696
    ds_read_b64_tr_b16 v[156:157], v29 offset:28672
    s_waitcnt lgkmcnt(4)
    v_mfma_f32_32x32x16_bf16 v[96:111], v[132:135], v[144:147], v[96:111]
    ds_read_b64_tr_b16 v[158:159], v29 offset:29696
    ds_read_b128 v[140:143], v43 offset:0
    v_mfma_f32_32x32x16_bf16 v[112:127], v[132:135], v[148:151], v[112:127]
    s_waitcnt lgkmcnt(3)
    v_mfma_f32_32x32x16_bf16 v[64:79], v[136:139], v[152:155], v[64:79]
    s_barrier
    ds_read_b64_tr_b16 v[180:181], v14 offset:20480
    ds_read_b64_tr_b16 v[182:183], v14 offset:20992
    ds_read_b128 v[128:131], v20 offset:32768
    ds_read_b64_tr_b16 v[144:145], v28 offset:49152
    s_waitcnt lgkmcnt(5)
    v_mfma_f32_32x32x16_bf16 v[80:95], v[136:139], v[156:159], v[80:95]
    ds_read_b64_tr_b16 v[146:147], v28 offset:50176
    ds_read_b64_tr_b16 v[148:149], v29 offset:49152
    s_waitcnt lgkmcnt(6)
    v_mfma_f32_32x32x16_bf16 v[96:111], v[140:143], v[152:155], v[96:111]
    ds_read_b64_tr_b16 v[150:151], v29 offset:50176
    ds_read_b128 v[132:135], v40 offset:32768
    v_mfma_f32_32x32x16_bf16 v[112:127], v[140:143], v[156:159], v[112:127]
    s_waitcnt lgkmcnt(3)
    v_mfma_f32_32x32x16_bf16 v[64:79], v[128:131], v[144:147], v[64:79]
    s_cmp_le_u32 s38, 5
    s_cbranch_scc1 L_ps45
    buffer_store_dwordx4 v[180:183], v197, s[20:23], 0 offen sc1
    v_mfma_f32_16x16x32_bf16 v[16:19], v[56:59], v[180:183], v[16:19]
L_ps45:
    ds_read_b128 v[136:139], v21 offset:32768
    ds_read_b64_tr_b16 v[152:153], v28 offset:53248
    s_waitcnt lgkmcnt(3)
    v_mfma_f32_32x32x16_bf16 v[80:95], v[128:131], v[148:151], v[80:95]
    ds_read_b64_tr_b16 v[154:155], v28 offset:54272
    ds_read_b64_tr_b16 v[156:157], v29 offset:53248
    s_waitcnt lgkmcnt(4)
    v_mfma_f32_32x32x16_bf16 v[96:111], v[132:135], v[144:147], v[96:111]
    ds_read_b64_tr_b16 v[158:159], v29 offset:54272
    ds_read_b128 v[140:143], v41 offset:32768
    v_mfma_f32_32x32x16_bf16 v[112:127], v[132:135], v[148:151], v[112:127]
    s_waitcnt lgkmcnt(3)
    v_mfma_f32_32x32x16_bf16 v[64:79], v[136:139], v[152:155], v[64:79]
    ds_read_b64_tr_b16 v[184:185], v14 offset:24576
    ds_read_b64_tr_b16 v[186:187], v14 offset:25088
    ds_read_b128 v[128:131], v22 offset:32768
    ds_read_b64_tr_b16 v[144:145], v28 offset:57344
    s_waitcnt lgkmcnt(5)
    v_mfma_f32_32x32x16_bf16 v[80:95], v[136:139], v[156:159], v[80:95]
    ds_read_b64_tr_b16 v[146:147], v28 offset:58368
    ds_read_b64_tr_b16 v[148:149], v29 offset:57344
    s_waitcnt lgkmcnt(6)
    v_mfma_f32_32x32x16_bf16 v[96:111], v[140:143], v[152:155], v[96:111]
    ds_read_b64_tr_b16 v[150:151], v29 offset:58368
    ds_read_b128 v[132:135], v42 offset:32768
    v_mfma_f32_32x32x16_bf16 v[112:127], v[140:143], v[156:159], v[112:127]
    s_waitcnt lgkmcnt(3)
    v_mfma_f32_32x32x16_bf16 v[64:79], v[128:131], v[144:147], v[64:79]
    s_cmp_le_u32 s38, 6
    s_cbranch_scc1 L_ps46
    buffer_store_dwordx4 v[184:187], v198, s[20:23], 0 offen sc1
    v_mfma_f32_16x16x32_bf16 v[16:19], v[56:59], v[184:187], v[16:19]
L_ps46:
    ds_read_b128 v[136:139], v23 offset:32768
    ds_read_b64_tr_b16 v[152:153], v28 offset:61440
    s_waitcnt lgkmcnt(3)
    v_mfma_f32_32x32x16_bf16 v[80:95], v[128:131], v[148:151], v[80:95]
    ds_read_b64_tr_b16 v[154:155], v28 offset:62464
    ds_read_b64_tr_b16 v[156:157], v29 offset:61440
    s_waitcnt lgkmcnt(4)
    v_mfma_f32_32x32x16_bf16 v[96:111], v[132:135], v[144:147], v[96:111]
    ds_read_b64_tr_b16 v[158:159], v29 offset:62464
    ds_read_b128 v[140:143], v43 offset:32768
    v_mfma_f32_32x32x16_bf16 v[112:127], v[132:135], v[148:151], v[112:127]
    s_waitcnt lgkmcnt(3)
    v_mfma_f32_32x32x16_bf16 v[64:79], v[136:139], v[152:155], v[64:79]
    s_waitcnt lgkmcnt(1)
    v_mfma_f32_32x32x16_bf16 v[80:95], v[136:139], v[156:159], v[80:95]
    s_waitcnt lgkmcnt(0)
    v_mfma_f32_32x32x16_bf16 v[96:111], v[140:143], v[152:155], v[96:111]
    v_mfma_f32_32x32x16_bf16 v[112:127], v[140:143], v[156:159], v[112:127]
    s_cmp_eq_u32 s39, 0
    s_cbranch_scc1 L_pc47
    v_lshlrev_b32 v62, 2, v1
    s_mov_b64 exec, 0xffff
    buffer_store_dword v16, v62, s[20:23], s39 offen sc1
    s_mov_b64 exec, -1
L_pc47:
    s_barrier
    v_lshl_add_u32 v37, v36, 2, s41
    v_xor_b32 v38, 128, v37
    ds_read_b32 v40, v37
    ds_read_b32 v42, v38
    v_lshl_add_u32 v37, v39, 4, s42
    v_xor_b32 v38, 128, v37
    ds_read_b128 v[128:131], v37 offset:0
    ds_read_b128 v[144:147], v37 offset:512
    ds_read_b128 v[132:135], v37 offset:32
    ds_read_b128 v[148:151], v37 offset:544
    ds_read_b128 v[136:139], v37 offset:64
    ds_read_b128 v[152:155], v37 offset:576
    ds_read_b128 v[140:143], v37 offset:96
    ds_read_b128 v[156:159], v37 offset:608
    ds_read_b128 v[160:163], v38 offset:0
    ds_read_b128 v[176:179], v38 offset:512
    ds_read_b128 v[164:167], v38 offset:32
    ds_read_b128 v[180:183], v38 offset:544
    ds_read_b128 v[168:171], v38 offset:64
    ds_read_b128 v[184:187], v38 offset:576
    ds_read_b128 v[172:175], v38 offset:96
    ds_read_b128 v[188:191], v38 offset:608
    s_waitcnt lgkmcnt(0)
    v_mov_b32 v41, v40
    v_mov_b32 v43, v42
    v_pk_mul_f32 v[48:49], v[144:145], v[40:41]
    v_pk_fma_f32 v[64:65], v[64:65], v[128:129], v[48:49] neg_lo:[0,0,1] neg_hi:[0,0,1]
    v_pk_mul_f32 v[50:51], v[146:147], v[40:41]
    v_pk_fma_f32 v[66:67], v[66:67], v[130:131], v[50:51] neg_lo:[0,0,1] neg_hi:[0,0,1]
    v_pk_mul_f32 v[52:53], v[148:149], v[40:41]
    v_pk_fma_f32 v[68:69], v[68:69], v[132:133], v[52:53] neg_lo:[0,0,1] neg_hi:[0,0,1]
    v_pk_mul_f32 v[54:55], v[150:151], v[40:41]
    v_pk_fma_f32 v[70:71], v[70:71], v[134:135], v[54:55] neg_lo:[0,0,1] neg_hi:[0,0,1]
    v_pk_mul_f32 v[48:49], v[152:153], v[40:41]
    v_pk_fma_f32 v[72:73], v[72:73], v[136:137], v[48:49] neg_lo:[0,0,1] neg_hi:[0,0,1]
    v_pk_mul_f32 v[50:51], v[154:155], v[40:41]
    v_pk_fma_f32 v[74:75], v[74:75], v[138:139], v[50:51] neg_lo:[0,0,1] neg_hi:[0,0,1]
    v_pk_mul_f32 v[52:53], v[156:157], v[40:41]
    v_pk_fma_f32 v[76:77], v[76:77], v[140:141], v[52:53] neg_lo:[0,0,1] neg_hi:[0,0,1]
    v_pk_mul_f32 v[54:55], v[158:159], v[40:41]
    v_pk_fma_f32 v[78:79], v[78:79], v[142:143], v[54:55] neg_lo:[0,0,1] neg_hi:[0,0,1]
    v_cvt_pk_bf16_f32 v64, v64, v65
    v_cvt_pk_bf16_f32 v65, v66, v67
    v_cvt_pk_bf16_f32 v66, v68, v69
    v_cvt_pk_bf16_f32 v67, v70, v71
    v_cvt_pk_bf16_f32 v68, v72, v73
    v_cvt_pk_bf16_f32 v69, v74, v75
    v_cvt_pk_bf16_f32 v70, v76, v77
    v_cvt_pk_bf16_f32 v71, v78, v79
    buffer_store_dwordx4 v[64:67], v224, s[20:23], s45 offen offset:0 sc1
    buffer_store_dwordx4 v[68:71], v224, s[20:23], s45 offen offset:640 sc1
    v_pk_mul_f32 v[48:49], v[144:145], v[42:43]
    v_pk_fma_f32 v[80:81], v[80:81], v[128:129], v[48:49] neg_lo:[0,0,1] neg_hi:[0,0,1]
    v_pk_mul_f32 v[50:51], v[146:147], v[42:43]
    v_pk_fma_f32 v[82:83], v[82:83], v[130:131], v[50:51] neg_lo:[0,0,1] neg_hi:[0,0,1]
    v_pk_mul_f32 v[52:53], v[148:149], v[42:43]
    v_pk_fma_f32 v[84:85], v[84:85], v[132:133], v[52:53] neg_lo:[0,0,1] neg_hi:[0,0,1]
    v_pk_mul_f32 v[54:55], v[150:151], v[42:43]
    v_pk_fma_f32 v[86:87], v[86:87], v[134:135], v[54:55] neg_lo:[0,0,1] neg_hi:[0,0,1]
    v_pk_mul_f32 v[48:49], v[152:153], v[42:43]
    v_pk_fma_f32 v[88:89], v[88:89], v[136:137], v[48:49] neg_lo:[0,0,1] neg_hi:[0,0,1]
    v_pk_mul_f32 v[50:51], v[154:155], v[42:43]
    v_pk_fma_f32 v[90:91], v[90:91], v[138:139], v[50:51] neg_lo:[0,0,1] neg_hi:[0,0,1]
    v_pk_mul_f32 v[52:53], v[156:157], v[42:43]
    v_pk_fma_f32 v[92:93], v[92:93], v[140:141], v[52:53] neg_lo:[0,0,1] neg_hi:[0,0,1]
    v_pk_mul_f32 v[54:55], v[158:159], v[42:43]
    v_pk_fma_f32 v[94:95], v[94:95], v[142:143], v[54:55] neg_lo:[0,0,1] neg_hi:[0,0,1]
    v_cvt_pk_bf16_f32 v80, v80, v81
    v_cvt_pk_bf16_f32 v81, v82, v83
    v_cvt_pk_bf16_f32 v82, v84, v85
    v_cvt_pk_bf16_f32 v83, v86, v87
    v_cvt_pk_bf16_f32 v84, v88, v89
    v_cvt_pk_bf16_f32 v85, v90, v91
    v_cvt_pk_bf16_f32 v86, v92, v93
    v_cvt_pk_bf16_f32 v87, v94, v95
    buffer_store_dwordx4 v[80:83], v225, s[20:23], s45 offen offset:0 sc1
    buffer_store_dwordx4 v[84:87], v225, s[20:23], s45 offen offset:640 sc1
    v_pk_mul_f32 v[48:49], v[176:177], v[40:41]
    v_pk_fma_f32 v[96:97], v[96:97], v[160:161], v[48:49] neg_lo:[0,0,1] neg_hi:[0,0,1]
    v_pk_mul_f32 v[50:51], v[178:179], v[40:41]
    v_pk_fma_f32 v[98:99], v[98:99], v[162:163], v[50:51] neg_lo:[0,0,1] neg_hi:[0,0,1]
    v_pk_mul_f32 v[52:53], v[180:181], v[40:41]
    v_pk_fma_f32 v[100:101], v[100:101], v[164:165], v[52:53] neg_lo:[0,0,1] neg_hi:[0,0,1]
    v_pk_mul_f32 v[54:55], v[182:183], v[40:41]
    v_pk_fma_f32 v[102:103], v[102:103], v[166:167], v[54:55] neg_lo:[0,0,1] neg_hi:[0,0,1]
    v_pk_mul_f32 v[48:49], v[184:185], v[40:41]
    v_pk_fma_f32 v[104:105], v[104:105], v[168:169], v[48:49] neg_lo:[0,0,1] neg_hi:[0,0,1]
    v_pk_mul_f32 v[50:51], v[186:187], v[40:41]
    v_pk_fma_f32 v[106:107], v[106:107], v[170:171], v[50:51] neg_lo:[0,0,1] neg_hi:[0,0,1]
    v_pk_mul_f32 v[52:53], v[188:189], v[40:41]
    v_pk_fma_f32 v[108:109], v[108:109], v[172:173], v[52:53] neg_lo:[0,0,1] neg_hi:[0,0,1]
    v_pk_mul_f32 v[54:55], v[190:191], v[40:41]
    v_pk_fma_f32 v[110:111], v[110:111], v[174:175], v[54:55] neg_lo:[0,0,1] neg_hi:[0,0,1]
    v_cvt_pk_bf16_f32 v96, v96, v97
    v_cvt_pk_bf16_f32 v97, v98, v99
    v_cvt_pk_bf16_f32 v98, v100, v101
    v_cvt_pk_bf16_f32 v99, v102, v103
    v_cvt_pk_bf16_f32 v100, v104, v105
    v_cvt_pk_bf16_f32 v101, v106, v107
    v_cvt_pk_bf16_f32 v102, v108, v109
    v_cvt_pk_bf16_f32 v103, v110, v111
    buffer_store_dwordx4 v[96:99], v224, s[20:23], s46 offen offset:0 sc1
    buffer_store_dwordx4 v[100:103], v224, s[20:23], s46 offen offset:640 sc1
    v_pk_mul_f32 v[48:49], v[176:177], v[42:43]
    v_pk_fma_f32 v[112:113], v[112:113], v[160:161], v[48:49] neg_lo:[0,0,1] neg_hi:[0,0,1]
    v_pk_mul_f32 v[50:51], v[178:179], v[42:43]
    v_pk_fma_f32 v[114:115], v[114:115], v[162:163], v[50:51] neg_lo:[0,0,1] neg_hi:[0,0,1]
    v_pk_mul_f32 v[52:53], v[180:181], v[42:43]
    v_pk_fma_f32 v[116:117], v[116:117], v[164:165], v[52:53] neg_lo:[0,0,1] neg_hi:[0,0,1]
    v_pk_mul_f32 v[54:55], v[182:183], v[42:43]
    v_pk_fma_f32 v[118:119], v[118:119], v[166:167], v[54:55] neg_lo:[0,0,1] neg_hi:[0,0,1]
    v_pk_mul_f32 v[48:49], v[184:185], v[42:43]
    v_pk_fma_f32 v[120:121], v[120:121], v[168:169], v[48:49] neg_lo:[0,0,1] neg_hi:[0,0,1]
    v_pk_mul_f32 v[50:51], v[186:187], v[42:43]
    v_pk_fma_f32 v[122:123], v[122:123], v[170:171], v[50:51] neg_lo:[0,0,1] neg_hi:[0,0,1]
    v_pk_mul_f32 v[52:53], v[188:189], v[42:43]
    v_pk_fma_f32 v[124:125], v[124:125], v[172:173], v[52:53] neg_lo:[0,0,1] neg_hi:[0,0,1]
    v_pk_mul_f32 v[54:55], v[190:191], v[42:43]
    v_pk_fma_f32 v[126:127], v[126:127], v[174:175], v[54:55] neg_lo:[0,0,1] neg_hi:[0,0,1]
    v_cvt_pk_bf16_f32 v112, v112, v113
    v_cvt_pk_bf16_f32 v113, v114, v115
    v_cvt_pk_bf16_f32 v114, v116, v117
    v_cvt_pk_bf16_f32 v115, v118, v119
    v_cvt_pk_bf16_f32 v116, v120, v121
    v_cvt_pk_bf16_f32 v117, v122, v123
    v_cvt_pk_bf16_f32 v118, v124, v125
    v_cvt_pk_bf16_f32 v119, v126, v127
    buffer_store_dwordx4 v[112:115], v225, s[20:23], s46 offen offset:0 sc1
    buffer_store_dwordx4 v[116:119], v225, s[20:23], s46 offen offset:640 sc1
    s_mov_b32 s4, s45
    s_mov_b32 s5, s46
    v_mov_b32 v10, 161856
    v_mov_b32 v11, 1
    s_mov_b64 exec, 1
    ds_add_u32 v10, v11 offset:12
    s_mov_b64 exec, -1
    s_mov_b32 s24, 1
    s_branch L_k2
L_k1_spare_c2:
    s_barrier
    s_barrier
    s_barrier
    s_barrier
    s_mov_b32 s24, 0
    s_mov_b32 s71, 0
L_k2:
    s_load_dwordx2 s[6:7], s[0:1], 64
    s_lshl_b32 s42, s31, 4
    s_add_u32 s42, s42, s32
    s_lshl_b32 s42, s42, 7
    s_add_u32 s42, s42, 18171904
    s_add_u32 s9, s71, 18130944
    s_and_b32 s25, s2, 7
    s_lshr_b32 s26, s2, 3
    s_and_b32 s27, s26, 3
    s_lshl_b32 s28, s25, 2
    s_add_u32 s27, s27, s28
    s_lshr_b32 s28, s2, 5
    s_and_b32 s29, s30, 3
    s_lshl_b32 s43, s27, 2
    s_add_u32 s29, s29, s43
    s_mul_i32 s34, s28, 5
    s_and_b32 s37, s28, 1
    s_lshr_b32 s35, s34, 1
    s_add_u32 s36, s35, 2
    s_lshl_b32 s43, s37, 1
    s_sub_u32 s36, s36, s43
    s_add_u32 s35, s35, s37
    v_lshlrev_b32 v3, 4, v1
    s_mul_i32 s40, s25, 327680
    s_mul_i32 s41, s26, 10240
    s_add_u32 s40, s40, s41
    s_mul_i32 s41, s30, 1280
    s_add_u32 s40, s40, s41
    s_add_u32 s39, s40, 5120
    s_lshl_b32 s31, s25, 3
    s_add_u32 s31, s31, s30
    v_and_b32 v30, 31, v1
    v_lshrrev_b32 v31, 5, v1
    v_lshlrev_b32 v27, 3, v30
    v_lshl_add_u32 v28, v31, 9, v27
    s_add_u32 s41, s41, 102400
    v_add_u32 v24, s41, v28
    v_add_u32 v25, s41, v27
    v_mul_u32_u24 v26, 320, v31
    v_lshl_add_u32 v26, v30, 4, v26
    v_add_u32 v26, s41, v26
    v_lshlrev_b32 v252, 2, v30
    s_lshl_b32 s44, s25, 1
    s_add_u32 s43, s30, s44
    s_max_u32 s43, s43, 2
    s_sub_u32 s43, s43, 2
    s_mul_i32 s45, s26, 20
    s_lshr_b32 s44, s45, 7
    s_add_u32 s45, s45, 19
    s_lshr_b32 s45, s45, 7
    s_sub_u32 s45, s45, s44
    s_lshl_b32 s45, s45, 7
    s_lshl_b32 s43, s43, 4
    s_add_u32 s43, s43, s44
    s_lshl_b32 s43, s43, 7
    s_add_u32 s38, s43, 18171904
    s_mov_b32 s32, s24
    v_lshrrev_b32 v58, 1, v1
    v_mul_u32_u24 v58, 640, v58
    v_and_b32 v59, 1, v1
    v_mul_lo_u32 v59, v59, s45
    v_add_u32 v58, v58, v59
    s_lshl_b32 s33, s25, 7
    s_add_u32 s33, s33, 18128896
    v_mov_b32 v2, 0
    v_mov_b32 v5, 1
    v_mov_b32 v6, 161860
    s_mov_b32 s48, 0xffffffff
    s_mov_b32 s49, 0xfffffff0
    s_mov_b32 s50, 0xfffffffe
    s_mov_b32 s51, 0xffffffe0
    s_mov_b32 s52, 0xfffffffc
    s_mov_b32 s53, 0xffffffc0
    s_mov_b32 s54, 0xfffffff8
    s_mov_b32 s55, 0xffffff80
    s_mov_b32 s56, 0xffffff00
    s_mov_b32 s57, 0xfffff000
    s_mov_b32 s58, 0xfffffe00
    s_mov_b32 s59, 0xffffe000
    s_mov_b32 s60, 0xfffffc00
    s_mov_b32 s61, 0xffffc000
    s_mov_b32 s62, 0xfffff800
    s_mov_b32 s63, 0xffff8000
    s_mov_b32 s64, 0xffff0000
    s_mov_b32 s65, 0xfff00000
    s_mov_b32 s66, 0xfffe0000
    s_mov_b32 s67, 0xffe00000
    s_mov_b32 s68, 0xfffc0000
    s_mov_b32 s69, 0xffc00000
    s_mov_b32 s70, 0xfff80000
    s_mov_b32 s71, 0xff800000
    s_mov_b32 s72, 0xff000000
    s_mov_b32 s73, 0xf0000000
    s_mov_b32 s74, 0xfe000000
    s_mov_b32 s75, 0xe0000000
    s_mov_b32 s76, 0xfc000000
    s_mov_b32 s77, 0xc0000000
    s_mov_b32 s78, 0xf8000000
    s_mov_b32 s79, 0x80000000
    s_cmp_eq_u32 s24, 0
    s_cbranch_scc1 L_nofq
    s_mov_b64 exec, 1
    s_waitcnt vmcnt(0)
    ds_add_rtn_u32 v7, v6, v5
    s_waitcnt lgkmcnt(0)
    v_readfirstlane_b32 s46, v7
    s_nop 0
    s_cmp_lg_u32 s46, 3
    s_cbranch_scc1 L_nofq
    v_mov_b32 v7, 2
    s_cmp_eq_u32 s24, 3
    s_cbranch_scc1 L_nofq2
    buffer_store_dword v7, v2, s[20:23], s42 offen sc1
L_nofq2:
    buffer_store_dword v7, v2, s[20:23], s9 offen sc1
L_nofq:
    s_mov_b64 exec, -1
    buffer_load_dword v253, v252, s[20:23], s33 offen sc1
    s_waitcnt lgkmcnt(0)
    s_mov_b32 s16, s6
    s_and_b32 s17, s7, 0xffff
    s_mov_b32 s18, 2621440
    s_mov_b32 s19, 0x20000
    v_mov_b32 v182, 0
    v_mov_b32 v183, 0
    v_mov_b32 v190, 0
    v_mov_b32 v191, 0
    v_mov_b32 v198, 0
    v_mov_b32 v199, 0
    v_mov_b32 v200, 0x3f803f80
    v_mov_b32 v201, 0x3f803f80
    v_mov_b32 v202, 0x3f803f80
    v_mov_b32 v203, 0x3f803f80
    v_mov_b32 v204, 0x3f803f80
    v_mov_b32 v205, 0x3f803f80
    v_mov_b32 v206, 0x3f803f80
    v_mov_b32 v207, 0x3f803f80
    v_mov_b32 v208, 0x3f803f80
    v_mov_b32 v209, 0x3f803f80
    v_mov_b32 v210, 0x3f803f80
    v_mov_b32 v211, 0x3f803f80
    v_mov_b32 v212, 0x3f803f80
    v_mov_b32 v213, 0x3f803f80
    v_mov_b32 v214, 0x3f803f80
    v_mov_b32 v215, 0x3f803f80
    v_mov_b32 v216, 0x3f803f80
    v_mov_b32 v217, 0x3f803f80
    v_mov_b32 v218, 0x3f803f80
    v_mov_b32 v219, 0x3f803f80
    v_mov_b32 v220, 0x3f803f80
    v_mov_b32 v221, 0x3f803f80
    v_mov_b32 v222, 0x3f803f80
    v_mov_b32 v223, 0x3f803f80
    v_mov_b32 v4, 0xffff
    v_mov_b32 v7, 0xffff0000
    v_cndmask_b32 v240, 0, v4, s[48:49]
    v_cndmask_b32 v12, 0, v7, s[50:51]
    v_or_b32 v240, v240, v12
    v_cndmask_b32 v241, 0, v4, s[52:53]
    v_cndmask_b32 v12, 0, v7, s[54:55]
    v_or_b32 v241, v241, v12
    v_cndmask_b32 v242, 0, v4, s[56:57]
    v_cndmask_b32 v12, 0, v7, s[58:59]
    v_or_b32 v242, v242, v12
    v_cndmask_b32 v243, 0, v4, s[60:61]
    v_cndmask_b32 v12, 0, v7, s[62:63]
    v_or_b32 v243, v243, v12
    v_cndmask_b32 v244, 0, v4, s[64:65]
    v_cndmask_b32 v12, 0, v7, s[66:67]
    v_or_b32 v244, v244, v12
    v_cndmask_b32 v245, 0, v4, s[68:69]
    v_cndmask_b32 v12, 0, v7, s[70:71]
    v_or_b32 v245, v245, v12
    v_cndmask_b32 v246, 0, v4, s[72:73]
    v_cndmask_b32 v12, 0, v7, s[74:75]
    v_or_b32 v246, v246, v12
    v_cndmask_b32 v247, 0, v4, s[76:77]
    v_cndmask_b32 v12, 0, v7, s[78:79]
    v_or_b32 v247, v247, v12
    v_cmp_gt_u32 vcc, 32, v1
    v_mov_b32 v4, 0xbf80bf80
    v_mov_b32 v7, 0x0000bf80
    v_cndmask_b32 v248, 0, v4, vcc
    v_cndmask_b32 v249, 0, v7, vcc
    v_mov_b32 v250, 0
    v_mov_b32 v251, 0
    v_mov_b32 v4, 0x7ffffff0
    v_cndmask_b32 v27, v4, v27, vcc
    s_mov_b32 s44, 0x000fffff
    s_mov_b32 s45, 0x000fffff
    v_mov_b32 v6, 0
    v_mov_b32 v7, 0
    v_mov_b32 v14, 0
    v_mov_b32 v15, 0
    v_mov_b32 v22, 0
    v_mov_b32 v23, 0
    v_and_b32 v254, 3, v1
    v_lshlrev_b32 v254, 2, v254
    v_add_u32 v254, 161888, v254
    s_lshl_b32 s43, s30, 2
    s_add_u32 s43, s43, 161888
    v_mov_b32 v255, s43
    s_lshl_b32 s8, s31, 5
    s_add_u32 s8, s8, s26
    s_lshl_b32 s8, s8, 2
    s_add_u32 s8, s8, 18087936
    s_waitcnt vmcnt(0)
    v_cmp_gt_u32 vcc, 1, v253
    s_cbranch_vccnz L_pl48
L_pd49:
    v_readfirstlane_b32 s43, v253
    s_nop 1
    v_cmp_ne_u32 vcc, s43, v253
    s_nop 0
    s_cmp_lg_u32 vcc_lo, 0
    s_cselect_b32 s24, 1, 0
    s_mov_b64 exec, 63
    buffer_load_dword v59, v58, s[20:23], s38 offen sc1
    s_waitcnt vmcnt(0)
    v_cmp_gt_u32 vcc, 2, v59
    s_cbranch_vccnz L_pl51
L_pd52:
    s_mov_b64 exec, -1
    s_barrier
    buffer_load_dwordx2 v[16:17], v28, s[20:23], s40 offen sc1
    buffer_load_dwordx2 v[18:19], v28, s[20:23], s40 offen offset:256 sc1
    buffer_load_dwordx2 v[20:21], v27, s[20:23], s40 offen offset:1024 sc1
    buffer_load_dwordx2 v[8:9], v28, s[20:23], s39 offen sc1
    buffer_load_dwordx2 v[10:11], v28, s[20:23], s39 offen offset:256 sc1
    buffer_load_dwordx2 v[12:13], v27, s[20:23], s39 offen offset:1024 sc1
    s_waitcnt vmcnt(0)
    ds_read_b32 v253, v254
    s_waitcnt lgkmcnt(0)
    v_cmp_gt_u32 vcc, 1, v253
    s_cbranch_vccnz L_ll54
L_ld55:
    ds_read_b64 v[176:177], v24 offset:10240
    ds_read_b64 v[178:179], v24 offset:10496
    ds_read_b64 v[180:181], v25 offset:11264
    ds_read_b64 v[184:185], v24 offset:0
    ds_read_b64 v[186:187], v24 offset:256
    ds_read_b64 v[188:189], v25 offset:1024
    ds_read_b64 v[192:193], v24 offset:1280
    ds_read_b64 v[194:195], v24 offset:1536
    ds_read_b64 v[196:197], v25 offset:2304
    s_waitcnt lgkmcnt(6)
    v_mfma_f32_32x32x16_bf16 v[160:175], v[176:179], v[16:19], 0
    s_waitcnt lgkmcnt(3)
    v_mfma_f32_32x32x16_bf16 v[32:47], v[184:187], v[16:19], 0
    v_mfma_f32_32x32x16_bf16 v[160:175], v[180:183], v[20:23], v[160:175]
    ds_read_b64 v[176:177], v24 offset:2560
    ds_read_b64 v[178:179], v24 offset:2816
    ds_read_b64 v[180:181], v25 offset:3584
    s_waitcnt lgkmcnt(3)
    v_mfma_f32_32x32x16_bf16 v[48:63], v[192:195], v[16:19], 0
    v_mfma_f32_32x32x16_bf16 v[32:47], v[188:191], v[20:23], v[32:47]
    ds_read_b64 v[184:185], v24 offset:3840
    ds_read_b64 v[186:187], v24 offset:4096
    ds_read_b64 v[188:189], v25 offset:4864
    s_waitcnt lgkmcnt(3)
    v_mfma_f32_32x32x16_bf16 v[64:79], v[176:179], v[16:19], 0
    s_nop 6
    v_cndmask_b32 v32, v32, v160, s[48:49]
    v_cndmask_b32 v33, v33, v161, s[50:51]
    v_cndmask_b32 v34, v34, v162, s[52:53]
    v_cndmask_b32 v35, v35, v163, s[54:55]
    v_cndmask_b32 v36, v36, v164, s[56:57]
    v_cndmask_b32 v37, v37, v165, s[58:59]
    v_cndmask_b32 v38, v38, v166, s[60:61]
    v_cndmask_b32 v39, v39, v167, s[62:63]
    v_cndmask_b32 v40, v40, v168, s[64:65]
    v_cndmask_b32 v41, v41, v169, s[66:67]
    v_cndmask_b32 v42, v42, v170, s[68:69]
    v_cndmask_b32 v43, v43, v171, s[70:71]
    v_mfma_f32_32x32x16_bf16 v[48:63], v[196:199], v[20:23], v[48:63]
    ds_read_b64 v[192:193], v24 offset:5120
    ds_read_b64 v[194:195], v24 offset:5376
    ds_read_b64 v[196:197], v25 offset:6144
    v_cndmask_b32 v44, v44, v172, s[72:73]
    v_cndmask_b32 v45, v45, v173, s[74:75]
    v_cndmask_b32 v46, v46, v174, s[76:77]
    v_cndmask_b32 v47, v47, v175, s[78:79]
    v_max_f32 v28, v32, v33
    v_max_f32 v29, v34, v35
    v_max3_f32 v28, v28, v36, v37
    v_max3_f32 v29, v29, v38, v39
    v_max3_f32 v28, v28, v40, v41
    v_max3_f32 v29, v29, v42, v43
    v_max3_f32 v28, v28, v44, v45
    v_max3_f32 v29, v29, v46, v47
    s_waitcnt lgkmcnt(3)
    v_mfma_f32_32x32x16_bf16 v[80:95], v[184:187], v[16:19], 0
    v_max3_f32 v28, v28, v48, v49
    v_max3_f32 v29, v29, v50, v51
    v_max3_f32 v28, v28, v52, v53
    v_max3_f32 v29, v29, v54, v55
    v_mfma_f32_32x32x16_bf16 v[64:79], v[180:183], v[20:23], v[64:79]
    ds_read_b64 v[176:177], v24 offset:6400
    ds_read_b64 v[178:179], v24 offset:6656
    ds_read_b64 v[180:181], v25 offset:7424
    v_max3_f32 v28, v28, v56, v57
    v_max3_f32 v29, v29, v58, v59
    v_max3_f32 v28, v28, v60, v61
    v_max3_f32 v29, v29, v62, v63
    s_waitcnt lgkmcnt(3)
    v_mfma_f32_32x32x16_bf16 v[96:111], v[192:195], v[16:19], 0
    s_nop 2
    v_max3_f32 v28, v28, v64, v65
    v_max3_f32 v29, v29, v66, v67
    v_max3_f32 v28, v28, v68, v69
    v_max3_f32 v29, v29, v70, v71
    v_mfma_f32_32x32x16_bf16 v[80:95], v[188:191], v[20:23], v[80:95]
    ds_read_b64 v[184:185], v24 offset:7680
    ds_read_b64 v[186:187], v24 offset:7936
    ds_read_b64 v[188:189], v25 offset:8704
    v_max3_f32 v28, v28, v72, v73
    v_max3_f32 v29, v29, v74, v75
    v_max3_f32 v28, v28, v76, v77
    v_max3_f32 v29, v29, v78, v79
    s_waitcnt lgkmcnt(3)
    v_mfma_f32_32x32x16_bf16 v[112:127], v[176:179], v[16:19], 0
    s_nop 2
    v_max3_f32 v28, v28, v80, v81
    v_max3_f32 v29, v29, v82, v83
    v_max3_f32 v28, v28, v84, v85
    v_max3_f32 v29, v29, v86, v87
    v_mfma_f32_32x32x16_bf16 v[96:111], v[196:199], v[20:23], v[96:111]
    ds_read_b64 v[192:193], v24 offset:8960
    ds_read_b64 v[194:195], v24 offset:9216
    ds_read_b64 v[196:197], v25 offset:9984
    v_max3_f32 v28, v28, v88, v89
    v_max3_f32 v29, v29, v90, v91
    v_max3_f32 v28, v28, v92, v93
    v_max3_f32 v29, v29, v94, v95
    s_waitcnt lgkmcnt(3)
    v_mfma_f32_32x32x16_bf16 v[128:143], v[184:187], v[16:19], 0
    s_nop 2
    v_max3_f32 v28, v28, v96, v97
    v_max3_f32 v29, v29, v98, v99
    v_max3_f32 v28, v28, v100, v101
    v_max3_f32 v29, v29, v102, v103
    v_mfma_f32_32x32x16_bf16 v[112:127], v[180:183], v[20:23], v[112:127]
    ds_read_b64 v[176:177], v24 offset:15360
    ds_read_b64 v[178:179], v24 offset:15616
    ds_read_b64 v[180:181], v25 offset:16384
    v_max3_f32 v28, v28, v104, v105
    v_max3_f32 v29, v29, v106, v107
    v_max3_f32 v28, v28, v108, v109
    v_max3_f32 v29, v29, v110, v111
    s_waitcnt lgkmcnt(3)
    v_mfma_f32_32x32x16_bf16 v[144:159], v[192:195], v[16:19], 0
    s_nop 2
    v_max3_f32 v28, v28, v112, v113
    v_max3_f32 v29, v29, v114, v115
    v_max3_f32 v28, v28, v116, v117
    v_max3_f32 v29, v29, v118, v119
    v_mfma_f32_32x32x16_bf16 v[128:143], v[188:191], v[20:23], v[128:143]
    ds_read_b64 v[184:185], v24 offset:5120
    ds_read_b64 v[186:187], v24 offset:5376
    ds_read_b64 v[188:189], v25 offset:6144
    v_max3_f32 v28, v28, v120, v121
    v_max3_f32 v29, v29, v122, v123
    v_max3_f32 v28, v28, v124, v125
    v_max3_f32 v29, v29, v126, v127
    v_mfma_f32_32x32x16_bf16 v[144:159], v[196:199], v[20:23], v[144:159]
    ds_read_b64 v[192:193], v24 offset:6400
    ds_read_b64 v[194:195], v24 offset:6656
    ds_read_b64 v[196:197], v25 offset:7424
    s_nop 0
    v_max3_f32 v28, v28, v128, v129
    v_max3_f32 v29, v29, v130, v131
    v_max3_f32 v28, v28, v132, v133
    v_max3_f32 v29, v29, v134, v135
    v_max3_f32 v28, v28, v136, v137
    v_max3_f32 v29, v29, v138, v139
    v_max3_f32 v28, v28, v140, v141
    v_max3_f32 v29, v29, v142, v143
    v_max3_f32 v28, v28, v144, v145
    v_max3_f32 v29, v29, v146, v147
    v_max3_f32 v28, v28, v148, v149
    v_max3_f32 v29, v29, v150, v151
    v_max3_f32 v28, v28, v152, v153
    v_max3_f32 v29, v29, v154, v155
    v_max3_f32 v28, v28, v156, v157
    v_max3_f32 v29, v29, v158, v159
    s_cmp_lt_u32 s31, 8
    s_cbranch_scc1 L_ab57
L_ae58:
    v_max_f32 v28, v28, v29
    v_mov_b32 v29, v28
    s_nop 1
    v_permlane32_swap_b32 v28, v29
    v_max_f32 v28, v28, v29
    v_and_b32 v29, 0xffff0000, v28
    v_sub_f32 v30, v28, v29
    v_and_b32 v31, 0xffff0000, v30
    v_sub_f32 v30, v30, v31
    v_lshrrev_b32 v29, 16, v29
    v_or_b32 v4, v29, v31
    v_lshrrev_b32 v5, 16, v30
    s_nop 1
    v_mfma_f32_32x32x16_bf16 v[32:47], v[248:251], v[4:7], v[32:47]
    v_mfma_f32_32x32x16_bf16 v[48:63], v[248:251], v[4:7], v[48:63]
    s_nop 10
    v_exp_f32 v32, v32
    v_exp_f32 v33, v33
    v_exp_f32 v34, v34
    v_exp_f32 v35, v35
    v_exp_f32 v36, v36
    v_exp_f32 v37, v37
    v_exp_f32 v38, v38
    v_exp_f32 v39, v39
    v_exp_f32 v40, v40
    v_exp_f32 v41, v41
    v_exp_f32 v42, v42
    v_exp_f32 v43, v43
    v_exp_f32 v44, v44
    v_exp_f32 v45, v45
    v_exp_f32 v46, v46
    v_exp_f32 v47, v47
    v_cvt_pk_bf16_f32 v32, v32, v33
    v_cvt_pk_bf16_f32 v33, v34, v35
    v_cvt_pk_bf16_f32 v34, v36, v37
    v_cvt_pk_bf16_f32 v35, v38, v39
    v_cvt_pk_bf16_f32 v36, v40, v41
    v_cvt_pk_bf16_f32 v37, v42, v43
    v_cvt_pk_bf16_f32 v38, v44, v45
    v_cvt_pk_bf16_f32 v39, v46, v47
    ds_read_b32 v253, v254
    s_waitcnt lgkmcnt(0)
    v_cmp_gt_u32 vcc, 2, v253
    s_cbranch_vccnz L_ll60
L_ld61:
    s_mov_b64 exec, s[44:45]
    ds_read_b128 v[200:203], v26 offset:30720
    ds_read_b128 v[204:207], v26 offset:31360
    ds_read_b128 v[208:211], v26 offset:20480
    ds_read_b128 v[212:215], v26 offset:21120
    ds_read_b128 v[216:219], v26 offset:21760
    ds_read_b128 v[220:223], v26 offset:22400
    s_mov_b64 exec, -1
    s_cmp_eq_u32 s30, 0
    s_cbranch_scc1 L_kvl
L_kvle:
    v_and_b32 v160, v240, v32
    v_bfi_b32 v32, v240, 0, v32
    v_and_b32 v161, v241, v33
    v_bfi_b32 v33, v241, 0, v33
    v_and_b32 v162, v242, v34
    v_bfi_b32 v34, v242, 0, v34
    v_and_b32 v163, v243, v35
    v_bfi_b32 v35, v243, 0, v35
    v_and_b32 v164, v244, v36
    v_bfi_b32 v36, v244, 0, v36
    v_and_b32 v165, v245, v37
    v_bfi_b32 v37, v245, 0, v37
    v_and_b32 v166, v246, v38
    v_bfi_b32 v38, v246, 0, v38
    v_and_b32 v167, v247, v39
    v_bfi_b32 v39, v247, 0, v39
    v_mfma_f32_32x32x16_bf16 v[64:79], v[248:251], v[4:7], v[64:79]
    v_exp_f32 v48, v48
    v_exp_f32 v49, v49
    v_exp_f32 v50, v50
    v_exp_f32 v51, v51
    s_waitcnt lgkmcnt(4)
    v_mfma_f32_32x32x16_bf16 v[224:239], v[200:203], v[160:163], 0
    v_exp_f32 v52, v52
    v_exp_f32 v53, v53
    v_exp_f32 v54, v54
    v_exp_f32 v55, v55
    v_mfma_f32_32x32x16_bf16 v[224:239], v[204:207], v[164:167], v[224:239]
    s_mov_b64 exec, s[44:45]
    ds_read_b128 v[200:203], v26 offset:23040
    ds_read_b128 v[204:207], v26 offset:23680
    s_mov_b64 exec, -1
    v_exp_f32 v56, v56
    v_exp_f32 v57, v57
    v_exp_f32 v58, v58
    v_exp_f32 v59, v59
    s_waitcnt lgkmcnt(4)
    v_mfma_f32_32x32x16_bf16 v[224:239], v[208:211], v[32:35], v[224:239]
    v_exp_f32 v60, v60
    v_exp_f32 v61, v61
    v_exp_f32 v62, v62
    v_exp_f32 v63, v63
    v_mfma_f32_32x32x16_bf16 v[224:239], v[212:215], v[36:39], v[224:239]
    s_mov_b64 exec, s[44:45]
    ds_read_b128 v[208:211], v26 offset:24320
    ds_read_b128 v[212:215], v26 offset:24960
    s_mov_b64 exec, -1
    v_cvt_pk_bf16_f32 v48, v48, v49
    v_cvt_pk_bf16_f32 v49, v50, v51
    v_cvt_pk_bf16_f32 v50, v52, v53
    v_cvt_pk_bf16_f32 v51, v54, v55
    v_cvt_pk_bf16_f32 v52, v56, v57
    v_cvt_pk_bf16_f32 v53, v58, v59
    v_cvt_pk_bf16_f32 v54, v60, v61
    v_cvt_pk_bf16_f32 v55, v62, v63
    v_mfma_f32_32x32x16_bf16 v[80:95], v[248:251], v[4:7], v[80:95]
    v_exp_f32 v64, v64
    v_exp_f32 v65, v65
    v_exp_f32 v66, v66
    s_waitcnt lgkmcnt(4)
    v_mfma_f32_32x32x16_bf16 v[224:239], v[216:219], v[48:51], v[224:239]
    v_exp_f32 v67, v67
    v_exp_f32 v68, v68
    v_exp_f32 v69, v69
    v_mfma_f32_32x32x16_bf16 v[224:239], v[220:223], v[52:55], v[224:239]
    s_mov_b64 exec, s[44:45]
    ds_read_b128 v[216:219], v26 offset:25600
    ds_read_b128 v[220:223], v26 offset:26240
    s_mov_b64 exec, -1
    v_exp_f32 v70, v70
    v_exp_f32 v71, v71
    v_exp_f32 v72, v72
    s_waitcnt lgkmcnt(15)
    v_mfma_f32_32x32x16_bf16 v[160:175], v[176:179], v[8:11], 0
    v_exp_f32 v73, v73
    v_exp_f32 v74, v74
    v_exp_f32 v75, v75
    v_mfma_f32_32x32x16_bf16 v[160:175], v[180:183], v[12:15], v[160:175]
    ds_read_b64 v[176:177], v24 offset:7680
    ds_read_b64 v[178:179], v24 offset:7936
    ds_read_b64 v[180:181], v25 offset:8704
    v_exp_f32 v76, v76
    v_exp_f32 v77, v77
    v_exp_f32 v78, v78
    s_waitcnt lgkmcnt(15)
    v_mfma_f32_32x32x16_bf16 v[32:47], v[184:187], v[8:11], 0
    v_exp_f32 v79, v79
    v_cvt_pk_bf16_f32 v64, v64, v65
    v_cvt_pk_bf16_f32 v65, v66, v67
    v_cvt_pk_bf16_f32 v66, v68, v69
    v_mfma_f32_32x32x16_bf16 v[32:47], v[188:191], v[12:15], v[32:47]
    ds_read_b64 v[184:185], v24 offset:8960
    ds_read_b64 v[186:187], v24 offset:9216
    ds_read_b64 v[188:189], v25 offset:9984
    v_cvt_pk_bf16_f32 v67, v70, v71
    v_cvt_pk_bf16_f32 v68, v72, v73
    v_cvt_pk_bf16_f32 v69, v74, v75
    v_cvt_pk_bf16_f32 v70, v76, v77
    v_cvt_pk_bf16_f32 v71, v78, v79
    v_mfma_f32_32x32x16_bf16 v[96:111], v[248:251], v[4:7], v[96:111]
    v_exp_f32 v80, v80
    v_exp_f32 v81, v81
    v_exp_f32 v82, v82
    v_exp_f32 v83, v83
    v_exp_f32 v84, v84
    v_exp_f32 v85, v85
    v_exp_f32 v86, v86
    s_waitcnt lgkmcnt(10)
    v_mfma_f32_32x32x16_bf16 v[224:239], v[200:203], v[64:67], v[224:239]
    v_exp_f32 v87, v87
    v_exp_f32 v88, v88
    v_exp_f32 v89, v89
    v_exp_f32 v90, v90
    v_exp_f32 v91, v91
    v_exp_f32 v92, v92
    v_mfma_f32_32x32x16_bf16 v[224:239], v[204:207], v[68:71], v[224:239]
    s_mov_b64 exec, s[44:45]
    ds_read_b128 v[200:203], v26 offset:26880
    ds_read_b128 v[204:207], v26 offset:27520
    s_mov_b64 exec, -1
    v_exp_f32 v93, v93
    v_exp_f32 v94, v94
    v_exp_f32 v95, v95
    v_cndmask_b32 v32, v32, v160, s[48:49]
    v_cndmask_b32 v33, v33, v161, s[50:51]
    v_cndmask_b32 v34, v34, v162, s[52:53]
    v_cndmask_b32 v35, v35, v163, s[54:55]
    v_cndmask_b32 v36, v36, v164, s[56:57]
    v_cndmask_b32 v37, v37, v165, s[58:59]
    v_cndmask_b32 v38, v38, v166, s[60:61]
    s_waitcnt lgkmcnt(15)
    v_mfma_f32_32x32x16_bf16 v[48:63], v[192:195], v[8:11], 0
    v_cndmask_b32 v39, v39, v167, s[62:63]
    v_cndmask_b32 v40, v40, v168, s[64:65]
    v_cndmask_b32 v41, v41, v169, s[66:67]
    v_cndmask_b32 v42, v42, v170, s[68:69]
    v_cndmask_b32 v43, v43, v171, s[70:71]
    v_cndmask_b32 v44, v44, v172, s[72:73]
    v_cndmask_b32 v45, v45, v173, s[74:75]
    v_cndmask_b32 v46, v46, v174, s[76:77]
    v_cndmask_b32 v47, v47, v175, s[78:79]
    v_max_f32 v28, v32, v33
    v_max_f32 v29, v34, v35
    v_max3_f32 v28, v28, v36, v37
    v_max3_f32 v29, v29, v38, v39
    v_mfma_f32_32x32x16_bf16 v[48:63], v[196:199], v[12:15], v[48:63]
    ds_read_b64 v[192:193], v24 offset:10240
    ds_read_b64 v[194:195], v24 offset:10496
    ds_read_b64 v[196:197], v25 offset:11264
    v_max3_f32 v28, v28, v40, v41
    v_max3_f32 v29, v29, v42, v43
    v_max3_f32 v28, v28, v44, v45
    v_max3_f32 v29, v29, v46, v47
    v_cvt_pk_bf16_f32 v80, v80, v81
    v_cvt_pk_bf16_f32 v81, v82, v83
    v_cvt_pk_bf16_f32 v82, v84, v85
    v_cvt_pk_bf16_f32 v83, v86, v87
    v_cvt_pk_bf16_f32 v84, v88, v89
    v_cvt_pk_bf16_f32 v85, v90, v91
    v_cvt_pk_bf16_f32 v86, v92, v93
    v_cvt_pk_bf16_f32 v87, v94, v95
    v_mfma_f32_32x32x16_bf16 v[112:127], v[248:251], v[4:7], v[112:127]
    v_exp_f32 v96, v96
    v_exp_f32 v97, v97
    v_exp_f32 v98, v98
    v_exp_f32 v99, v99
    v_exp_f32 v100, v100
    s_waitcnt lgkmcnt(13)
    v_mfma_f32_32x32x16_bf16 v[224:239], v[208:211], v[80:83], v[224:239]
    v_exp_f32 v101, v101
    v_exp_f32 v102, v102
    v_exp_f32 v103, v103
    v_exp_f32 v104, v104
    v_exp_f32 v105, v105
    v_mfma_f32_32x32x16_bf16 v[224:239], v[212:215], v[84:87], v[224:239]
    s_mov_b64 exec, s[44:45]
    ds_read_b128 v[208:211], v26 offset:28160
    ds_read_b128 v[212:215], v26 offset:28800
    s_mov_b64 exec, -1
    v_exp_f32 v106, v106
    v_exp_f32 v107, v107
    v_exp_f32 v108, v108
    v_exp_f32 v109, v109
    v_exp_f32 v110, v110
    s_waitcnt lgkmcnt(10)
    v_mfma_f32_32x32x16_bf16 v[64:79], v[176:179], v[8:11], 0
    v_exp_f32 v111, v111
    v_max3_f32 v28, v28, v48, v49
    v_max3_f32 v29, v29, v50, v51
    v_max3_f32 v28, v28, v52, v53
    v_max3_f32 v29, v29, v54, v55
    v_max3_f32 v28, v28, v56, v57
    v_max3_f32 v29, v29, v58, v59
    v_max3_f32 v28, v28, v60, v61
    v_mfma_f32_32x32x16_bf16 v[64:79], v[180:183], v[12:15], v[64:79]
    ds_read_b64 v[176:177], v24 offset:11520
    ds_read_b64 v[178:179], v24 offset:11776
    ds_read_b64 v[180:181], v25 offset:12544
    v_max3_f32 v29, v29, v62, v63
    v_cvt_pk_bf16_f32 v96, v96, v97
    v_cvt_pk_bf16_f32 v97, v98, v99
    v_cvt_pk_bf16_f32 v98, v100, v101
    v_cvt_pk_bf16_f32 v99, v102, v103
    v_cvt_pk_bf16_f32 v100, v104, v105
    v_cvt_pk_bf16_f32 v101, v106, v107
    v_cvt_pk_bf16_f32 v102, v108, v109
    v_cvt_pk_bf16_f32 v103, v110, v111
    v_mfma_f32_32x32x16_bf16 v[128:143], v[248:251], v[4:7], v[128:143]
    v_exp_f32 v112, v112
    v_exp_f32 v113, v113
    v_exp_f32 v114, v114
    v_exp_f32 v115, v115
    v_exp_f32 v116, v116
    s_waitcnt lgkmcnt(15)
    v_mfma_f32_32x32x16_bf16 v[224:239], v[216:219], v[96:99], v[224:239]
    v_exp_f32 v117, v117
    v_exp_f32 v118, v118
    v_exp_f32 v119, v119
    v_exp_f32 v120, v120
    v_exp_f32 v121, v121
    v_mfma_f32_32x32x16_bf16 v[224:239], v[220:223], v[100:103], v[224:239]
    s_mov_b64 exec, s[44:45]
    ds_read_b128 v[216:219], v26 offset:29440
    ds_read_b128 v[220:223], v26 offset:30080
    s_mov_b64 exec, -1
    v_exp_f32 v122, v122
    v_exp_f32 v123, v123
    v_exp_f32 v124, v124
    v_exp_f32 v125, v125
    v_exp_f32 v126, v126
    s_waitcnt lgkmcnt(12)
    v_mfma_f32_32x32x16_bf16 v[80:95], v[184:187], v[8:11], 0
    v_exp_f32 v127, v127
    v_max3_f32 v28, v28, v64, v65
    v_max3_f32 v29, v29, v66, v67
    v_max3_f32 v28, v28, v68, v69
    v_max3_f32 v29, v29, v70, v71
    v_max3_f32 v28, v28, v72, v73
    v_max3_f32 v29, v29, v74, v75
    v_max3_f32 v28, v28, v76, v77
    v_mfma_f32_32x32x16_bf16 v[80:95], v[188:191], v[12:15], v[80:95]
    ds_read_b64 v[184:185], v24 offset:12800
    ds_read_b64 v[186:187], v24 offset:13056
    ds_read_b64 v[188:189], v25 offset:13824
    v_max3_f32 v29, v29, v78, v79
    v_cvt_pk_bf16_f32 v112, v112, v113
    v_cvt_pk_bf16_f32 v113, v114, v115
    v_cvt_pk_bf16_f32 v114, v116, v117
    v_cvt_pk_bf16_f32 v115, v118, v119
    v_cvt_pk_bf16_f32 v116, v120, v121
    v_cvt_pk_bf16_f32 v117, v122, v123
    v_cvt_pk_bf16_f32 v118, v124, v125
    v_cvt_pk_bf16_f32 v119, v126, v127
    v_mfma_f32_32x32x16_bf16 v[144:159], v[248:251], v[4:7], v[144:159]
    v_exp_f32 v128, v128
    v_exp_f32 v129, v129
    v_exp_f32 v130, v130
    v_exp_f32 v131, v131
    v_exp_f32 v132, v132
    s_waitcnt lgkmcnt(13)
    v_mfma_f32_32x32x16_bf16 v[224:239], v[200:203], v[112:115], v[224:239]
    v_exp_f32 v133, v133
    v_exp_f32 v134, v134
    v_exp_f32 v135, v135
    v_exp_f32 v136, v136
    v_exp_f32 v137, v137
    v_mfma_f32_32x32x16_bf16 v[224:239], v[204:207], v[116:119], v[224:239]
    s_mov_b64 exec, s[44:45]
    ds_read_b128 v[200:203], v26 offset:35840
    ds_read_b128 v[204:207], v26 offset:36480
    s_mov_b64 exec, -1
    v_exp_f32 v138, v138
    v_exp_f32 v139, v139
    v_exp_f32 v140, v140
    v_exp_f32 v141, v141
    v_exp_f32 v142, v142
    s_waitcnt lgkmcnt(12)
    v_mfma_f32_32x32x16_bf16 v[96:111], v[192:195], v[8:11], 0
    v_exp_f32 v143, v143
    v_max3_f32 v28, v28, v80, v81
    v_max3_f32 v29, v29, v82, v83
    v_max3_f32 v28, v28, v84, v85
    v_max3_f32 v29, v29, v86, v87
    v_max3_f32 v28, v28, v88, v89
    v_max3_f32 v29, v29, v90, v91
    v_max3_f32 v28, v28, v92, v93
    v_mfma_f32_32x32x16_bf16 v[96:111], v[196:199], v[12:15], v[96:111]
    ds_read_b64 v[192:193], v24 offset:14080
    ds_read_b64 v[194:195], v24 offset:14336
    ds_read_b64 v[196:197], v25 offset:15104
    v_max3_f32 v29, v29, v94, v95
    v_cvt_pk_bf16_f32 v128, v128, v129
    v_cvt_pk_bf16_f32 v129, v130, v131
    v_cvt_pk_bf16_f32 v130, v132, v133
    v_cvt_pk_bf16_f32 v131, v134, v135
    v_cvt_pk_bf16_f32 v132, v136, v137
    v_cvt_pk_bf16_f32 v133, v138, v139
    v_cvt_pk_bf16_f32 v134, v140, v141
    v_cvt_pk_bf16_f32 v135, v142, v143
    s_waitcnt lgkmcnt(13)
    v_mfma_f32_32x32x16_bf16 v[224:239], v[208:211], v[128:131], v[224:239]
    v_exp_f32 v144, v144
    v_exp_f32 v145, v145
    v_exp_f32 v146, v146
    v_exp_f32 v147, v147
    v_exp_f32 v148, v148
    v_exp_f32 v149, v149
    v_mfma_f32_32x32x16_bf16 v[224:239], v[212:215], v[132:135], v[224:239]
    s_mov_b64 exec, s[44:45]
    ds_read_b128 v[208:211], v26 offset:25600
    ds_read_b128 v[212:215], v26 offset:26240
    s_mov_b64 exec, -1
    v_exp_f32 v150, v150
    v_exp_f32 v151, v151
    v_exp_f32 v152, v152
    v_exp_f32 v153, v153
    v_exp_f32 v154, v154
    v_exp_f32 v155, v155
    s_waitcnt lgkmcnt(12)
    v_mfma_f32_32x32x16_bf16 v[112:127], v[176:179], v[8:11], 0
    v_exp_f32 v156, v156
    v_exp_f32 v157, v157
    v_exp_f32 v158, v158
    v_exp_f32 v159, v159
    v_max3_f32 v28, v28, v96, v97
    v_max3_f32 v29, v29, v98, v99
    v_max3_f32 v28, v28, v100, v101
    v_max3_f32 v29, v29, v102, v103
    v_mfma_f32_32x32x16_bf16 v[112:127], v[180:183], v[12:15], v[112:127]
    v_max3_f32 v28, v28, v104, v105
    v_max3_f32 v29, v29, v106, v107
    v_max3_f32 v28, v28, v108, v109
    v_max3_f32 v29, v29, v110, v111
    v_cvt_pk_bf16_f32 v144, v144, v145
    v_cvt_pk_bf16_f32 v145, v146, v147
    v_cvt_pk_bf16_f32 v146, v148, v149
    v_cvt_pk_bf16_f32 v147, v150, v151
    v_cvt_pk_bf16_f32 v148, v152, v153
    v_cvt_pk_bf16_f32 v149, v154, v155
    v_cvt_pk_bf16_f32 v150, v156, v157
    v_cvt_pk_bf16_f32 v151, v158, v159
    s_waitcnt lgkmcnt(7)
    v_mfma_f32_32x32x16_bf16 v[128:143], v[184:187], v[8:11], 0
    v_max3_f32 v28, v28, v112, v113
    v_max3_f32 v29, v29, v114, v115
    v_mfma_f32_32x32x16_bf16 v[128:143], v[188:191], v[12:15], v[128:143]
    v_max3_f32 v28, v28, v116, v117
    s_waitcnt lgkmcnt(10)
    v_mfma_f32_32x32x16_bf16 v[224:239], v[216:219], v[144:147], v[224:239]
    v_max3_f32 v29, v29, v118, v119
    v_mfma_f32_32x32x16_bf16 v[224:239], v[220:223], v[148:151], v[224:239]
    s_mov_b64 exec, s[44:45]
    ds_read_b128 v[216:219], v26 offset:26880
    ds_read_b128 v[220:223], v26 offset:27520
    s_mov_b64 exec, -1
    v_max3_f32 v28, v28, v120, v121
    v_max3_f32 v29, v29, v122, v123
    s_waitcnt lgkmcnt(4)
    v_mfma_f32_32x32x16_bf16 v[144:159], v[192:195], v[8:11], 0
    v_max3_f32 v28, v28, v124, v125
    v_mfma_f32_32x32x16_bf16 v[144:159], v[196:199], v[12:15], v[144:159]
    v_max3_f32 v29, v29, v126, v127
    v_max3_f32 v28, v28, v128, v129
    v_max3_f32 v29, v29, v130, v131
    v_max3_f32 v28, v28, v132, v133
    v_max3_f32 v29, v29, v134, v135
    v_max3_f32 v28, v28, v136, v137
    v_max3_f32 v29, v29, v138, v139
    v_max3_f32 v28, v28, v140, v141
    v_max3_f32 v29, v29, v142, v143
    v_rcp_f32 v30, v236
    s_nop 0
    v_mul_f32 v224, v224, v30
    v_mul_f32 v225, v225, v30
    v_mul_f32 v226, v226, v30
    v_mul_f32 v227, v227, v30
    v_mul_f32 v228, v228, v30
    v_mul_f32 v229, v229, v30
    v_mul_f32 v230, v230, v30
    v_mul_f32 v231, v231, v30
    v_mul_f32 v232, v232, v30
    v_mul_f32 v233, v233, v30
    v_mul_f32 v234, v234, v30
    v_mul_f32 v235, v235, v30
    v_cvt_pk_bf16_f32 v16, v224, v225
    v_cvt_pk_bf16_f32 v17, v226, v227
    v_cvt_pk_bf16_f32 v18, v228, v229
    v_cvt_pk_bf16_f32 v19, v230, v231
    v_cvt_pk_bf16_f32 v20, v232, v233
    v_cvt_pk_bf16_f32 v21, v234, v235
    s_cmp_lg_u32 s24, 0
    s_cbranch_scc1 L_sf63
    buffer_store_dwordx4 v[16:19], v3, s[20:23], s40 offen
    buffer_store_dwordx2 v[20:21], v27, s[20:23], s40 offen offset:1024
L_se64:
    v_max3_f32 v28, v28, v144, v145
    v_max3_f32 v29, v29, v146, v147
    v_max3_f32 v28, v28, v148, v149
    v_max3_f32 v29, v29, v150, v151
    v_max3_f32 v28, v28, v152, v153
    v_max3_f32 v29, v29, v154, v155
    v_max3_f32 v28, v28, v156, v157
    v_max3_f32 v29, v29, v158, v159
    s_cmp_lt_u32 s31, 4
    s_cbranch_scc1 L_ab65
L_ae66:
    v_max_f32 v28, v28, v29
    v_mov_b32 v29, v28
    s_nop 1
    v_permlane32_swap_b32 v28, v29
    v_max_f32 v28, v28, v29
    v_and_b32 v29, 0xffff0000, v28
    v_sub_f32 v30, v28, v29
    v_and_b32 v31, 0xffff0000, v30
    v_sub_f32 v30, v30, v31
    v_lshrrev_b32 v29, 16, v29
    v_or_b32 v4, v29, v31
    v_lshrrev_b32 v5, 16, v30
    s_nop 1
    v_mfma_f32_32x32x16_bf16 v[32:47], v[248:251], v[4:7], v[32:47]
    v_mfma_f32_32x32x16_bf16 v[48:63], v[248:251], v[4:7], v[48:63]
    s_nop 10
    v_exp_f32 v32, v32
    v_exp_f32 v33, v33
    v_exp_f32 v34, v34
    v_exp_f32 v35, v35
    v_exp_f32 v36, v36
    v_exp_f32 v37, v37
    v_exp_f32 v38, v38
    v_exp_f32 v39, v39
    v_exp_f32 v40, v40
    v_exp_f32 v41, v41
    v_exp_f32 v42, v42
    v_exp_f32 v43, v43
    v_exp_f32 v44, v44
    v_exp_f32 v45, v45
    v_exp_f32 v46, v46
    v_exp_f32 v47, v47
    v_cvt_pk_bf16_f32 v32, v32, v33
    v_cvt_pk_bf16_f32 v33, v34, v35
    v_cvt_pk_bf16_f32 v34, v36, v37
    v_cvt_pk_bf16_f32 v35, v38, v39
    v_cvt_pk_bf16_f32 v36, v40, v41
    v_cvt_pk_bf16_f32 v37, v42, v43
    v_cvt_pk_bf16_f32 v38, v44, v45
    v_cvt_pk_bf16_f32 v39, v46, v47
    v_and_b32 v160, v240, v32
    v_bfi_b32 v32, v240, 0, v32
    v_and_b32 v161, v241, v33
    v_bfi_b32 v33, v241, 0, v33
    v_and_b32 v162, v242, v34
    v_bfi_b32 v34, v242, 0, v34
    v_and_b32 v163, v243, v35
    v_bfi_b32 v35, v243, 0, v35
    v_and_b32 v164, v244, v36
    v_bfi_b32 v36, v244, 0, v36
    v_and_b32 v165, v245, v37
    v_bfi_b32 v37, v245, 0, v37
    v_and_b32 v166, v246, v38
    v_bfi_b32 v38, v246, 0, v38
    v_and_b32 v167, v247, v39
    v_bfi_b32 v39, v247, 0, v39
    v_mfma_f32_32x32x16_bf16 v[64:79], v[248:251], v[4:7], v[64:79]
    v_exp_f32 v48, v48
    v_exp_f32 v49, v49
    v_exp_f32 v50, v50
    v_exp_f32 v51, v51
    s_waitcnt lgkmcnt(7)
    v_mfma_f32_32x32x16_bf16 v[224:239], v[200:203], v[160:163], 0
    v_exp_f32 v52, v52
    v_exp_f32 v53, v53
    v_exp_f32 v54, v54
    v_exp_f32 v55, v55
    v_mfma_f32_32x32x16_bf16 v[224:239], v[204:207], v[164:167], v[224:239]
    s_mov_b64 exec, s[44:45]
    ds_read_b128 v[200:203], v26 offset:28160
    ds_read_b128 v[204:207], v26 offset:28800
    s_mov_b64 exec, -1
    v_exp_f32 v56, v56
    v_exp_f32 v57, v57
    v_exp_f32 v58, v58
    v_exp_f32 v59, v59
    s_waitcnt lgkmcnt(4)
    v_mfma_f32_32x32x16_bf16 v[224:239], v[208:211], v[32:35], v[224:239]
    v_exp_f32 v60, v60
    v_exp_f32 v61, v61
    v_exp_f32 v62, v62
    v_exp_f32 v63, v63
    v_mfma_f32_32x32x16_bf16 v[224:239], v[212:215], v[36:39], v[224:239]
    s_mov_b64 exec, s[44:45]
    ds_read_b128 v[208:211], v26 offset:29440
    ds_read_b128 v[212:215], v26 offset:30080
    s_mov_b64 exec, -1
    v_cvt_pk_bf16_f32 v48, v48, v49
    v_cvt_pk_bf16_f32 v49, v50, v51
    v_cvt_pk_bf16_f32 v50, v52, v53
    v_cvt_pk_bf16_f32 v51, v54, v55
    v_cvt_pk_bf16_f32 v52, v56, v57
    v_cvt_pk_bf16_f32 v53, v58, v59
    v_cvt_pk_bf16_f32 v54, v60, v61
    v_cvt_pk_bf16_f32 v55, v62, v63
    v_mfma_f32_32x32x16_bf16 v[80:95], v[248:251], v[4:7], v[80:95]
    v_exp_f32 v64, v64
    v_exp_f32 v65, v65
    v_exp_f32 v66, v66
    v_exp_f32 v67, v67
    v_exp_f32 v68, v68
    v_exp_f32 v69, v69
    v_exp_f32 v70, v70
    s_waitcnt lgkmcnt(4)
    v_mfma_f32_32x32x16_bf16 v[224:239], v[216:219], v[48:51], v[224:239]
    v_exp_f32 v71, v71
    v_exp_f32 v72, v72
    v_exp_f32 v73, v73
    v_exp_f32 v74, v74
    v_exp_f32 v75, v75
    v_exp_f32 v76, v76
    v_exp_f32 v77, v77
    v_mfma_f32_32x32x16_bf16 v[224:239], v[220:223], v[52:55], v[224:239]
    s_mov_b64 exec, s[44:45]
    ds_read_b128 v[216:219], v26 offset:30720
    ds_read_b128 v[220:223], v26 offset:31360
    s_mov_b64 exec, -1
    v_exp_f32 v78, v78
    v_exp_f32 v79, v79
    v_cvt_pk_bf16_f32 v64, v64, v65
    v_cvt_pk_bf16_f32 v65, v66, v67
    v_cvt_pk_bf16_f32 v66, v68, v69
    v_cvt_pk_bf16_f32 v67, v70, v71
    v_cvt_pk_bf16_f32 v68, v72, v73
    v_cvt_pk_bf16_f32 v69, v74, v75
    v_cvt_pk_bf16_f32 v70, v76, v77
    v_cvt_pk_bf16_f32 v71, v78, v79
    v_mfma_f32_32x32x16_bf16 v[96:111], v[248:251], v[4:7], v[96:111]
    v_exp_f32 v80, v80
    v_exp_f32 v81, v81
    v_exp_f32 v82, v82
    v_exp_f32 v83, v83
    v_exp_f32 v84, v84
    v_exp_f32 v85, v85
    v_exp_f32 v86, v86
    s_waitcnt lgkmcnt(4)
    v_mfma_f32_32x32x16_bf16 v[224:239], v[200:203], v[64:67], v[224:239]
    v_exp_f32 v87, v87
    v_exp_f32 v88, v88
    v_exp_f32 v89, v89
    v_exp_f32 v90, v90
    v_exp_f32 v91, v91
    v_exp_f32 v92, v92
    v_exp_f32 v93, v93
    v_mfma_f32_32x32x16_bf16 v[224:239], v[204:207], v[68:71], v[224:239]
    s_mov_b64 exec, s[44:45]
    ds_read_b128 v[200:203], v26 offset:32000
    ds_read_b128 v[204:207], v26 offset:32640
    s_mov_b64 exec, -1
    v_exp_f32 v94, v94
    v_exp_f32 v95, v95
    v_cvt_pk_bf16_f32 v80, v80, v81
    v_cvt_pk_bf16_f32 v81, v82, v83
    v_cvt_pk_bf16_f32 v82, v84, v85
    v_cvt_pk_bf16_f32 v83, v86, v87
    v_cvt_pk_bf16_f32 v84, v88, v89
    v_cvt_pk_bf16_f32 v85, v90, v91
    v_cvt_pk_bf16_f32 v86, v92, v93
    v_cvt_pk_bf16_f32 v87, v94, v95
    v_mfma_f32_32x32x16_bf16 v[112:127], v[248:251], v[4:7], v[112:127]
    v_exp_f32 v96, v96
    v_exp_f32 v97, v97
    v_exp_f32 v98, v98
    v_exp_f32 v99, v99
    v_exp_f32 v100, v100
    s_waitcnt lgkmcnt(4)
    v_mfma_f32_32x32x16_bf16 v[224:239], v[208:211], v[80:83], v[224:239]
    v_exp_f32 v101, v101
    v_exp_f32 v102, v102
    v_exp_f32 v103, v103
    v_exp_f32 v104, v104
    v_exp_f32 v105, v105
    v_mfma_f32_32x32x16_bf16 v[224:239], v[212:215], v[84:87], v[224:239]
    s_mov_b64 exec, s[44:45]
    ds_read_b128 v[208:211], v26 offset:33280
    ds_read_b128 v[212:215], v26 offset:33920
    s_mov_b64 exec, -1
    v_exp_f32 v106, v106
    v_exp_f32 v107, v107
    v_exp_f32 v108, v108
    v_exp_f32 v109, v109
    v_exp_f32 v110, v110
    v_mov_b32 v30, 1
    s_waitcnt vmcnt(0)
    s_mov_b64 exec, 1
    s_cmp_lg_u32 s24, 0
    s_cbranch_scc1 L_sf68
    buffer_store_dword v30, v2, s[20:23], s8 offen offset:0
L_se69:
    s_mov_b64 exec, -1
    v_exp_f32 v111, v111
    v_cvt_pk_bf16_f32 v96, v96, v97
    v_cvt_pk_bf16_f32 v97, v98, v99
    v_cvt_pk_bf16_f32 v98, v100, v101
    v_cvt_pk_bf16_f32 v99, v102, v103
    v_cvt_pk_bf16_f32 v100, v104, v105
    v_cvt_pk_bf16_f32 v101, v106, v107
    v_cvt_pk_bf16_f32 v102, v108, v109
    v_cvt_pk_bf16_f32 v103, v110, v111
    v_mfma_f32_32x32x16_bf16 v[128:143], v[248:251], v[4:7], v[128:143]
    v_exp_f32 v112, v112
    v_exp_f32 v113, v113
    v_exp_f32 v114, v114
    v_exp_f32 v115, v115
    v_exp_f32 v116, v116
    v_exp_f32 v117, v117
    v_exp_f32 v118, v118
    s_waitcnt lgkmcnt(4)
    v_mfma_f32_32x32x16_bf16 v[224:239], v[216:219], v[96:99], v[224:239]
    v_exp_f32 v119, v119
    v_exp_f32 v120, v120
    v_exp_f32 v121, v121
    v_exp_f32 v122, v122
    v_exp_f32 v123, v123
    v_exp_f32 v124, v124
    v_exp_f32 v125, v125
    v_mfma_f32_32x32x16_bf16 v[224:239], v[220:223], v[100:103], v[224:239]
    s_mov_b64 exec, s[44:45]
    ds_read_b128 v[216:219], v26 offset:34560
    ds_read_b128 v[220:223], v26 offset:35200
    s_mov_b64 exec, -1
    v_exp_f32 v126, v126
    v_exp_f32 v127, v127
    v_cvt_pk_bf16_f32 v112, v112, v113
    v_cvt_pk_bf16_f32 v113, v114, v115
    v_cvt_pk_bf16_f32 v114, v116, v117
    v_cvt_pk_bf16_f32 v115, v118, v119
    v_cvt_pk_bf16_f32 v116, v120, v121
    v_cvt_pk_bf16_f32 v117, v122, v123
    v_cvt_pk_bf16_f32 v118, v124, v125
    v_cvt_pk_bf16_f32 v119, v126, v127
    v_mfma_f32_32x32x16_bf16 v[144:159], v[248:251], v[4:7], v[144:159]
    v_exp_f32 v128, v128
    v_exp_f32 v129, v129
    v_exp_f32 v130, v130
    v_exp_f32 v131, v131
    v_exp_f32 v132, v132
    v_exp_f32 v133, v133
    v_exp_f32 v134, v134
    s_waitcnt lgkmcnt(4)
    v_mfma_f32_32x32x16_bf16 v[224:239], v[200:203], v[112:115], v[224:239]
    v_exp_f32 v135, v135
    v_exp_f32 v136, v136
    v_exp_f32 v137, v137
    v_exp_f32 v138, v138
    v_exp_f32 v139, v139
    v_exp_f32 v140, v140
    v_exp_f32 v141, v141
    v_mfma_f32_32x32x16_bf16 v[224:239], v[204:207], v[116:119], v[224:239]
    v_exp_f32 v142, v142
    v_exp_f32 v143, v143
    v_cvt_pk_bf16_f32 v128, v128, v129
    v_cvt_pk_bf16_f32 v129, v130, v131
    v_cvt_pk_bf16_f32 v130, v132, v133
    v_cvt_pk_bf16_f32 v131, v134, v135
    v_cvt_pk_bf16_f32 v132, v136, v137
    v_cvt_pk_bf16_f32 v133, v138, v139
    v_cvt_pk_bf16_f32 v134, v140, v141
    v_cvt_pk_bf16_f32 v135, v142, v143
    s_waitcnt lgkmcnt(2)
    v_mfma_f32_32x32x16_bf16 v[224:239], v[208:211], v[128:131], v[224:239]
    v_exp_f32 v144, v144
    v_exp_f32 v145, v145
    v_exp_f32 v146, v146
    v_exp_f32 v147, v147
    v_exp_f32 v148, v148
    v_exp_f32 v149, v149
    v_exp_f32 v150, v150
    v_exp_f32 v151, v151
    v_exp_f32 v152, v152
    v_exp_f32 v153, v153
    v_mfma_f32_32x32x16_bf16 v[224:239], v[212:215], v[132:135], v[224:239]
    v_exp_f32 v154, v154
    v_exp_f32 v155, v155
    v_exp_f32 v156, v156
    v_exp_f32 v157, v157
    v_exp_f32 v158, v158
    v_exp_f32 v159, v159
    v_cvt_pk_bf16_f32 v144, v144, v145
    v_cvt_pk_bf16_f32 v145, v146, v147
    v_cvt_pk_bf16_f32 v146, v148, v149
    v_cvt_pk_bf16_f32 v147, v150, v151
    v_cvt_pk_bf16_f32 v148, v152, v153
    v_cvt_pk_bf16_f32 v149, v154, v155
    v_cvt_pk_bf16_f32 v150, v156, v157
    v_cvt_pk_bf16_f32 v151, v158, v159
    s_waitcnt lgkmcnt(0)
    v_mfma_f32_32x32x16_bf16 v[224:239], v[216:219], v[144:147], v[224:239]
    v_mfma_f32_32x32x16_bf16 v[224:239], v[220:223], v[148:151], v[224:239]
    v_mov_b32 v31, 1
    ds_write_b32 v255, v31 offset:16
    s_nop 9
    v_rcp_f32 v30, v236
    s_nop 0
    v_mul_f32 v224, v224, v30
    v_mul_f32 v225, v225, v30
    v_mul_f32 v226, v226, v30
    v_mul_f32 v227, v227, v30
    v_mul_f32 v228, v228, v30
    v_mul_f32 v229, v229, v30
    v_mul_f32 v230, v230, v30
    v_mul_f32 v231, v231, v30
    v_mul_f32 v232, v232, v30
    v_mul_f32 v233, v233, v30
    v_mul_f32 v234, v234, v30
    v_mul_f32 v235, v235, v30
    v_cvt_pk_bf16_f32 v16, v224, v225
    v_cvt_pk_bf16_f32 v17, v226, v227
    v_cvt_pk_bf16_f32 v18, v228, v229
    v_cvt_pk_bf16_f32 v19, v230, v231
    v_cvt_pk_bf16_f32 v20, v232, v233
    v_cvt_pk_bf16_f32 v21, v234, v235
    s_cmp_lg_u32 s24, 0
    s_cbranch_scc1 L_sf70
    buffer_store_dwordx4 v[16:19], v3, s[20:23], s39 offen
    buffer_store_dwordx2 v[20:21], v27, s[20:23], s39 offen offset:1024
L_se71:
    ds_read_b32 v90, v254
    s_lshr_b32 s43, s29, 1
    s_lshl_b32 s43, s43, 7
    s_add_u32 s45, s43, 18087936
    v_lshrrev_b32 v248, 2, v1
    v_mul_u32_u24 v248, 1280, v248
    v_and_b32 v4, 3, v1
    v_lshl_add_u32 v248, v4, 4, v248
    s_mul_i32 s40, s29, 20480
    s_lshl_b32 s41, s35, 10
    s_add_u32 s41, s41, s40
    s_lshl_b32 s42, s36, 10
    s_add_u32 s42, s42, s40
    s_lshl_b32 s43, s37, 3
    s_add_u32 s42, s42, s43
    v_add_u32 v8, 0x10000, v3
    v_add_u32 v9, 0x20000, v3
    s_mul_i32 s46, s30, 3072
    s_add_u32 s46, s46, 143360
    v_and_b32 v5, 15, v1
    v_lshlrev_b32 v5, 6, v5
    v_lshrrev_b32 v6, 4, v1
    v_lshl_add_u32 v5, v6, 4, v5
    v_add_u32 v5, s46, v5
    s_lshl_b32 s43, s37, 3
    v_add_u32 v6, s43, v5
    v_and_b32 v7, 0x30, v1
    v_add_u32 v7, 155648, v7
    s_lshl_b32 s33, s29, 7
    s_add_u32 s33, s33, 18096128
    s_lshl_b32 s43, s28, 2
    s_add_u32 s34, s33, s43
    v_and_b32 v14, 7, v1
    v_lshlrev_b32 v14, 2, v14
    s_lshl_b32 s46, s29, 11
    s_add_u32 s46, s46, 10485760
    s_lshr_b32 s44, s28, 1
    s_lshl_b32 s44, s44, 8
    s_add_u32 s9, s46, s44
    s_lshl_b32 s44, s37, 3
    s_add_u32 s9, s9, s44
    s_mul_i32 s10, s25, 327680
    s_bfe_u32 s43, s29, 0x30001
    s_mul_i32 s43, s43, 1280
    s_add_u32 s10, s10, s43
    s_and_b32 s43, s29, 1
    s_lshl_b32 s43, s43, 7
    s_add_u32 s11, s10, s43
    s_add_u32 s11, s11, 1024
    s_lshl_b32 s43, s43, 1
    s_add_u32 s10, s10, s43
    s_add_u32 s10, s10, 0
    v_lshrrev_b32 v10, 5, v1
    v_mul_u32_u24 v250, 10240, v10
    v_bfe_u32 v10, v1, 4, 1
    v_lshl_add_u32 v250, v10, 9, v250
    v_and_b32 v10, 15, v1
    v_lshl_add_u32 v250, v10, 4, v250
    v_lshrrev_b32 v11, 4, v1
    v_mul_u32_u24 v251, 20480, v11
    v_lshl_add_u32 v251, v10, 3, v251
    v_mov_b32 v30, 1
    s_waitcnt vmcnt(0)
    s_mov_b64 exec, 1
    s_cmp_lg_u32 s24, 0
    s_cbranch_scc1 L_sf72
    buffer_store_dword v30, v2, s[20:23], s8 offen offset:512
L_se73:
    s_mov_b64 exec, -1
    buffer_load_dword v15, v252, s[20:23], s45 offen sc1
    s_waitcnt lgkmcnt(0)
    v_cmp_gt_u32 vcc, 5, v90
    s_cbranch_vccnz L_ll74
L_ld75:
    ds_read_b128 v[80:83], v5
    ds_read_b128 v[84:87], v5 offset:1024
    ds_read_b64 v[88:89], v6 offset:2048
    s_waitcnt vmcnt(0) lgkmcnt(0)
    v_cmp_gt_u32 vcc, 1, v15
    s_cbranch_vccnz L_pl77
L_pd78:
    s_add_u32 s43, s10, 0
    buffer_load_dwordx4 v[144:147], v250, s[20:23], s43 offen sc1
    s_add_u32 s43, s10, 20480
    buffer_load_dwordx4 v[148:151], v250, s[20:23], s43 offen sc1
    s_add_u32 s43, s10, 40960
    buffer_load_dwordx4 v[152:155], v250, s[20:23], s43 offen sc1
    s_add_u32 s43, s10, 61440
    buffer_load_dwordx4 v[156:159], v250, s[20:23], s43 offen sc1
    s_add_u32 s43, s11, 0
    buffer_load_dwordx2 v[160:161], v251, s[20:23], s43 offen sc1
    s_add_u32 s43, s43, 10240
    buffer_load_dwordx2 v[162:163], v251, s[20:23], s43 offen sc1
    s_add_u32 s43, s10, 81920
    buffer_load_dwordx4 v[164:167], v250, s[20:23], s43 offen sc1
    s_add_u32 s43, s10, 102400
    buffer_load_dwordx4 v[168:171], v250, s[20:23], s43 offen sc1
    s_add_u32 s43, s10, 122880
    buffer_load_dwordx4 v[172:175], v250, s[20:23], s43 offen sc1
    ds_read_b128 v[40:43], v3 offset:0
    ds_read_b128 v[44:47], v3 offset:1024
    ds_read_b128 v[48:51], v3 offset:2048
    ds_read_b128 v[52:55], v3 offset:3072
    ds_read_b128 v[56:59], v3 offset:4096
    ds_read_b128 v[60:63], v3 offset:5120
    v_lshlrev_b32 v16, 16, v80
    v_and_b32 v17, 0xffff0000, v80
    v_lshlrev_b32 v18, 16, v81
    v_and_b32 v19, 0xffff0000, v81
    v_lshlrev_b32 v20, 16, v82
    v_and_b32 v21, 0xffff0000, v82
    v_lshlrev_b32 v22, 16, v83
    v_and_b32 v23, 0xffff0000, v83
    v_lshlrev_b32 v24, 16, v84
    v_and_b32 v25, 0xffff0000, v84
    v_lshlrev_b32 v26, 16, v85
    v_and_b32 v27, 0xffff0000, v85
    v_lshlrev_b32 v28, 16, v86
    v_and_b32 v29, 0xffff0000, v86
    v_lshlrev_b32 v30, 16, v87
    v_and_b32 v31, 0xffff0000, v87
    v_lshlrev_b32 v32, 16, v88
    v_and_b32 v33, 0xffff0000, v88
    v_lshlrev_b32 v34, 16, v89
    v_and_b32 v35, 0xffff0000, v89
    ds_read_b128 v[64:67], v3 offset:6144
    s_add_u32 s43, s10, 143360
    buffer_load_dwordx4 v[176:179], v250, s[20:23], s43 offen sc1
    s_waitcnt vmcnt(9) lgkmcnt(6)
    v_mfma_f32_16x16x32_bf16 v[16:19], v[40:43], v[144:147], v[16:19]
    ds_read_b128 v[40:43], v3 offset:7168
    s_waitcnt lgkmcnt(6)
    v_mfma_f32_16x16x32_bf16 v[20:23], v[44:47], v[144:147], v[20:23]
    ds_read_b128 v[44:47], v3 offset:8192
    s_waitcnt lgkmcnt(6)
    v_mfma_f32_16x16x32_bf16 v[24:27], v[48:51], v[144:147], v[24:27]
    ds_read_b128 v[48:51], v3 offset:9216
    s_waitcnt lgkmcnt(6)
    v_mfma_f32_16x16x32_bf16 v[28:31], v[52:55], v[144:147], v[28:31]
    ds_read_b128 v[52:55], v3 offset:10240
    s_waitcnt lgkmcnt(6)
    v_mfma_f32_16x16x32_bf16 v[32:35], v[56:59], v[144:147], v[32:35]
    ds_read_b128 v[56:59], v3 offset:11264
    s_add_u32 s43, s11, 81920
    buffer_load_dwordx2 v[180:181], v251, s[20:23], s43 offen sc1
    s_add_u32 s43, s43, 10240
    buffer_load_dwordx2 v[182:183], v251, s[20:23], s43 offen sc1
    s_waitcnt vmcnt(10) lgkmcnt(6)
    v_mfma_f32_16x16x32_bf16 v[16:19], v[60:63], v[148:151], v[16:19]
    ds_read_b128 v[60:63], v3 offset:12288
    s_waitcnt lgkmcnt(6)
    v_mfma_f32_16x16x32_bf16 v[20:23], v[64:67], v[148:151], v[20:23]
    ds_read_b128 v[64:67], v3 offset:13312
    s_waitcnt lgkmcnt(6)
    v_mfma_f32_16x16x32_bf16 v[24:27], v[40:43], v[148:151], v[24:27]
    ds_read_b128 v[40:43], v3 offset:14336
    s_waitcnt lgkmcnt(6)
    v_mfma_f32_16x16x32_bf16 v[28:31], v[44:47], v[148:151], v[28:31]
    ds_read_b128 v[44:47], v3 offset:15360
    s_waitcnt lgkmcnt(6)
    v_mfma_f32_16x16x32_bf16 v[32:35], v[48:51], v[148:151], v[32:35]
    ds_read_b128 v[48:51], v3 offset:16384
    s_add_u32 s43, s10, 163840
    buffer_load_dwordx4 v[184:187], v250, s[20:23], s43 offen sc1
    s_waitcnt vmcnt(10) lgkmcnt(6)
    v_mfma_f32_16x16x32_bf16 v[16:19], v[52:55], v[152:155], v[16:19]
    ds_read_b128 v[52:55], v3 offset:17408
    s_waitcnt lgkmcnt(6)
    v_mfma_f32_16x16x32_bf16 v[20:23], v[56:59], v[152:155], v[20:23]
    ds_read_b128 v[56:59], v3 offset:18432
    s_waitcnt lgkmcnt(6)
    v_mfma_f32_16x16x32_bf16 v[24:27], v[60:63], v[152:155], v[24:27]
    ds_read_b128 v[60:63], v3 offset:19456
    s_waitcnt lgkmcnt(6)
    v_mfma_f32_16x16x32_bf16 v[28:31], v[64:67], v[152:155], v[28:31]
    ds_read_b128 v[64:67], v3 offset:20480
    s_waitcnt lgkmcnt(6)
    v_mfma_f32_16x16x32_bf16 v[32:35], v[40:43], v[152:155], v[32:35]
    ds_read_b128 v[40:43], v3 offset:21504
    s_add_u32 s43, s10, 184320
    buffer_load_dwordx4 v[188:191], v250, s[20:23], s43 offen sc1
    s_waitcnt vmcnt(10) lgkmcnt(6)
    v_mfma_f32_16x16x32_bf16 v[16:19], v[44:47], v[156:159], v[16:19]
    ds_read_b128 v[44:47], v3 offset:22528
    s_waitcnt lgkmcnt(6)
    v_mfma_f32_16x16x32_bf16 v[20:23], v[48:51], v[156:159], v[20:23]
    ds_read_b128 v[48:51], v3 offset:23552
    s_waitcnt lgkmcnt(6)
    v_mfma_f32_16x16x32_bf16 v[24:27], v[52:55], v[156:159], v[24:27]
    ds_read_b128 v[52:55], v3 offset:24576
    s_waitcnt lgkmcnt(6)
    v_mfma_f32_16x16x32_bf16 v[28:31], v[56:59], v[156:159], v[28:31]
    ds_read_b128 v[56:59], v3 offset:25600
    s_waitcnt lgkmcnt(6)
    v_mfma_f32_16x16x32_bf16 v[32:35], v[60:63], v[156:159], v[32:35]
    ds_read_b128 v[60:63], v3 offset:26624
    s_add_u32 s43, s10, 204800
    buffer_load_dwordx4 v[192:195], v250, s[20:23], s43 offen sc1
    s_waitcnt vmcnt(9) lgkmcnt(6)
    v_mfma_f32_16x16x32_bf16 v[16:19], v[64:67], v[160:163], v[16:19]
    ds_read_b128 v[64:67], v3 offset:27648
    s_waitcnt lgkmcnt(6)
    v_mfma_f32_16x16x32_bf16 v[20:23], v[40:43], v[160:163], v[20:23]
    ds_read_b128 v[40:43], v3 offset:28672
    s_waitcnt lgkmcnt(6)
    v_mfma_f32_16x16x32_bf16 v[24:27], v[44:47], v[160:163], v[24:27]
    ds_read_b128 v[44:47], v3 offset:29696
    s_waitcnt lgkmcnt(6)
    v_mfma_f32_16x16x32_bf16 v[28:31], v[48:51], v[160:163], v[28:31]
    ds_read_b128 v[48:51], v3 offset:30720
    s_waitcnt lgkmcnt(6)
    v_mfma_f32_16x16x32_bf16 v[32:35], v[52:55], v[160:163], v[32:35]
    ds_read_b128 v[52:55], v3 offset:31744
    s_add_u32 s43, s10, 225280
    buffer_load_dwordx4 v[196:199], v250, s[20:23], s43 offen sc1
    s_waitcnt vmcnt(9) lgkmcnt(6)
    v_mfma_f32_16x16x32_bf16 v[16:19], v[56:59], v[164:167], v[16:19]
    ds_read_b128 v[56:59], v3 offset:32768
    s_waitcnt lgkmcnt(6)
    v_mfma_f32_16x16x32_bf16 v[20:23], v[60:63], v[164:167], v[20:23]
    ds_read_b128 v[60:63], v3 offset:33792
    s_waitcnt lgkmcnt(6)
    v_mfma_f32_16x16x32_bf16 v[24:27], v[64:67], v[164:167], v[24:27]
    ds_read_b128 v[64:67], v3 offset:34816
    s_waitcnt lgkmcnt(6)
    v_mfma_f32_16x16x32_bf16 v[28:31], v[40:43], v[164:167], v[28:31]
    ds_read_b128 v[40:43], v3 offset:35840
    s_waitcnt lgkmcnt(6)
    v_mfma_f32_16x16x32_bf16 v[32:35], v[44:47], v[164:167], v[32:35]
    ds_read_b128 v[44:47], v3 offset:36864
    s_add_u32 s43, s11, 163840
    buffer_load_dwordx2 v[200:201], v251, s[20:23], s43 offen sc1
    s_add_u32 s43, s43, 10240
    buffer_load_dwordx2 v[202:203], v251, s[20:23], s43 offen sc1
    s_waitcnt vmcnt(10) lgkmcnt(6)
    v_mfma_f32_16x16x32_bf16 v[16:19], v[48:51], v[168:171], v[16:19]
    ds_read_b128 v[48:51], v3 offset:37888
    s_waitcnt lgkmcnt(6)
    v_mfma_f32_16x16x32_bf16 v[20:23], v[52:55], v[168:171], v[20:23]
    ds_read_b128 v[52:55], v3 offset:38912
    s_waitcnt lgkmcnt(6)
    v_mfma_f32_16x16x32_bf16 v[24:27], v[56:59], v[168:171], v[24:27]
    ds_read_b128 v[56:59], v3 offset:39936
    s_waitcnt lgkmcnt(6)
    v_mfma_f32_16x16x32_bf16 v[28:31], v[60:63], v[168:171], v[28:31]
    ds_read_b128 v[60:63], v3 offset:40960
    s_waitcnt lgkmcnt(6)
    v_mfma_f32_16x16x32_bf16 v[32:35], v[64:67], v[168:171], v[32:35]
    ds_read_b128 v[64:67], v3 offset:41984
    s_add_u32 s43, s10, 245760
    buffer_load_dwordx4 v[204:207], v250, s[20:23], s43 offen sc1
    s_waitcnt vmcnt(10) lgkmcnt(6)
    v_mfma_f32_16x16x32_bf16 v[16:19], v[40:43], v[172:175], v[16:19]
    ds_read_b128 v[40:43], v3 offset:43008
    s_waitcnt lgkmcnt(6)
    v_mfma_f32_16x16x32_bf16 v[20:23], v[44:47], v[172:175], v[20:23]
    ds_read_b128 v[44:47], v3 offset:44032
    s_waitcnt lgkmcnt(6)
    v_mfma_f32_16x16x32_bf16 v[24:27], v[48:51], v[172:175], v[24:27]
    ds_read_b128 v[48:51], v3 offset:45056
    s_waitcnt lgkmcnt(6)
    v_mfma_f32_16x16x32_bf16 v[28:31], v[52:55], v[172:175], v[28:31]
    ds_read_b128 v[52:55], v3 offset:46080
    s_waitcnt lgkmcnt(6)
    v_mfma_f32_16x16x32_bf16 v[32:35], v[56:59], v[172:175], v[32:35]
    ds_read_b128 v[56:59], v3 offset:47104
    s_add_u32 s43, s10, 266240
    buffer_load_dwordx4 v[208:211], v250, s[20:23], s43 offen sc1
    s_waitcnt vmcnt(10) lgkmcnt(6)
    v_mfma_f32_16x16x32_bf16 v[16:19], v[60:63], v[176:179], v[16:19]
    ds_read_b128 v[60:63], v3 offset:48128
    s_waitcnt lgkmcnt(6)
    v_mfma_f32_16x16x32_bf16 v[20:23], v[64:67], v[176:179], v[20:23]
    ds_read_b128 v[64:67], v3 offset:49152
    s_waitcnt lgkmcnt(6)
    v_mfma_f32_16x16x32_bf16 v[24:27], v[40:43], v[176:179], v[24:27]
    ds_read_b128 v[40:43], v3 offset:50176
    s_waitcnt lgkmcnt(6)
    v_mfma_f32_16x16x32_bf16 v[28:31], v[44:47], v[176:179], v[28:31]
    ds_read_b128 v[44:47], v3 offset:51200
    s_waitcnt lgkmcnt(6)
    v_mfma_f32_16x16x32_bf16 v[32:35], v[48:51], v[176:179], v[32:35]
    ds_read_b128 v[48:51], v3 offset:52224
    s_add_u32 s43, s10, 286720
    buffer_load_dwordx4 v[212:215], v250, s[20:23], s43 offen sc1
    s_waitcnt vmcnt(9) lgkmcnt(6)
    v_mov_b32 v91, 3
    v_mfma_f32_16x16x32_bf16 v[16:19], v[52:55], v[180:183], v[16:19]
    ds_read_b128 v[52:55], v3 offset:53248
    s_waitcnt lgkmcnt(6)
    v_mfma_f32_16x16x32_bf16 v[20:23], v[56:59], v[180:183], v[20:23]
    ds_read_b128 v[56:59], v3 offset:54272
    s_waitcnt lgkmcnt(6)
    v_mfma_f32_16x16x32_bf16 v[24:27], v[60:63], v[180:183], v[24:27]
    ds_read_b128 v[60:63], v3 offset:55296
    s_waitcnt lgkmcnt(6)
    v_mfma_f32_16x16x32_bf16 v[28:31], v[64:67], v[180:183], v[28:31]
    ds_read_b128 v[64:67], v3 offset:56320
    s_waitcnt lgkmcnt(6)
    v_mfma_f32_16x16x32_bf16 v[32:35], v[40:43], v[180:183], v[32:35]
    ds_read_b128 v[40:43], v3 offset:57344
    s_add_u32 s43, s10, 307200
    buffer_load_dwordx4 v[216:219], v250, s[20:23], s43 offen sc1
    s_waitcnt vmcnt(9) lgkmcnt(6)
    v_mfma_f32_16x16x32_bf16 v[16:19], v[44:47], v[184:187], v[16:19]
    ds_read_b128 v[44:47], v3 offset:58368
    s_waitcnt lgkmcnt(6)
    v_mfma_f32_16x16x32_bf16 v[20:23], v[48:51], v[184:187], v[20:23]
    ds_read_b128 v[48:51], v3 offset:59392
    s_waitcnt lgkmcnt(6)
    v_mfma_f32_16x16x32_bf16 v[24:27], v[52:55], v[184:187], v[24:27]
    ds_read_b128 v[52:55], v3 offset:60416
    s_waitcnt lgkmcnt(6)
    v_mfma_f32_16x16x32_bf16 v[28:31], v[56:59], v[184:187], v[28:31]
    ds_write_b32 v255, v91 offset:16
    ds_read_b128 v[56:59], v3 offset:61440
    s_waitcnt lgkmcnt(7)
    v_mfma_f32_16x16x32_bf16 v[32:35], v[60:63], v[184:187], v[32:35]
    ds_read_b128 v[60:63], v3 offset:62464
    s_add_u32 s43, s11, 245760
    buffer_load_dwordx2 v[220:221], v251, s[20:23], s43 offen sc1
    s_add_u32 s43, s43, 10240
    buffer_load_dwordx2 v[222:223], v251, s[20:23], s43 offen sc1
    s_waitcnt vmcnt(10) lgkmcnt(7)
    v_mfma_f32_16x16x32_bf16 v[16:19], v[64:67], v[188:191], v[16:19]
    ds_read_b128 v[64:67], v3 offset:63488
    s_waitcnt lgkmcnt(7)
    v_mfma_f32_16x16x32_bf16 v[20:23], v[40:43], v[188:191], v[20:23]
    ds_read_b128 v[40:43], v3 offset:64512
    s_waitcnt lgkmcnt(7)
    v_mfma_f32_16x16x32_bf16 v[24:27], v[44:47], v[188:191], v[24:27]
    ds_read_b128 v[44:47], v8 offset:0
    s_waitcnt lgkmcnt(7)
    v_mfma_f32_16x16x32_bf16 v[28:31], v[48:51], v[188:191], v[28:31]
    ds_read_b128 v[48:51], v8 offset:1024
    s_waitcnt lgkmcnt(7)
    v_mfma_f32_16x16x32_bf16 v[32:35], v[52:55], v[188:191], v[32:35]
    ds_read_b128 v[52:55], v8 offset:2048
    s_waitcnt vmcnt(9) lgkmcnt(6)
    v_mfma_f32_16x16x32_bf16 v[16:19], v[56:59], v[192:195], v[16:19]
    ds_read_b128 v[56:59], v8 offset:3072
    s_waitcnt lgkmcnt(6)
    v_mfma_f32_16x16x32_bf16 v[20:23], v[60:63], v[192:195], v[20:23]
    ds_read_b128 v[60:63], v8 offset:4096
    s_waitcnt lgkmcnt(6)
    v_mfma_f32_16x16x32_bf16 v[24:27], v[64:67], v[192:195], v[24:27]
    ds_read_b128 v[64:67], v8 offset:5120
    s_waitcnt lgkmcnt(6)
    v_mfma_f32_16x16x32_bf16 v[28:31], v[40:43], v[192:195], v[28:31]
    ds_read_b128 v[40:43], v8 offset:6144
    s_waitcnt lgkmcnt(6)
    v_mfma_f32_16x16x32_bf16 v[32:35], v[44:47], v[192:195], v[32:35]
    ds_read_b128 v[44:47], v8 offset:7168
    s_waitcnt vmcnt(8) lgkmcnt(6)
    v_mfma_f32_16x16x32_bf16 v[16:19], v[48:51], v[196:199], v[16:19]
    ds_read_b128 v[48:51], v8 offset:8192
    s_waitcnt lgkmcnt(6)
    v_mfma_f32_16x16x32_bf16 v[20:23], v[52:55], v[196:199], v[20:23]
    ds_read_b128 v[52:55], v8 offset:9216
    s_waitcnt lgkmcnt(6)
    v_mfma_f32_16x16x32_bf16 v[24:27], v[56:59], v[196:199], v[24:27]
    ds_read_b128 v[56:59], v8 offset:10240
    s_waitcnt lgkmcnt(6)
    v_mfma_f32_16x16x32_bf16 v[28:31], v[60:63], v[196:199], v[28:31]
    ds_read_b128 v[60:63], v8 offset:11264
    s_waitcnt lgkmcnt(6)
    v_mfma_f32_16x16x32_bf16 v[32:35], v[64:67], v[196:199], v[32:35]
    ds_read_b128 v[64:67], v8 offset:12288
    s_waitcnt vmcnt(6) lgkmcnt(6)
    v_mfma_f32_16x16x32_bf16 v[16:19], v[40:43], v[200:203], v[16:19]
    ds_read_b128 v[40:43], v8 offset:13312
    s_waitcnt lgkmcnt(6)
    v_mfma_f32_16x16x32_bf16 v[20:23], v[44:47], v[200:203], v[20:23]
    ds_read_b128 v[44:47], v8 offset:14336
    s_waitcnt lgkmcnt(6)
    v_mfma_f32_16x16x32_bf16 v[24:27], v[48:51], v[200:203], v[24:27]
    ds_read_b128 v[48:51], v8 offset:15360
    s_waitcnt lgkmcnt(6)
    v_mfma_f32_16x16x32_bf16 v[28:31], v[52:55], v[200:203], v[28:31]
    ds_read_b128 v[52:55], v8 offset:16384
    s_waitcnt lgkmcnt(6)
    v_mfma_f32_16x16x32_bf16 v[32:35], v[56:59], v[200:203], v[32:35]
    ds_read_b128 v[56:59], v8 offset:17408
    s_waitcnt vmcnt(5) lgkmcnt(6)
    v_mfma_f32_16x16x32_bf16 v[16:19], v[60:63], v[204:207], v[16:19]
    ds_read_b128 v[60:63], v8 offset:18432
    s_waitcnt lgkmcnt(6)
    v_mfma_f32_16x16x32_bf16 v[20:23], v[64:67], v[204:207], v[20:23]
    ds_read_b128 v[64:67], v8 offset:19456
    s_waitcnt lgkmcnt(6)
    v_mfma_f32_16x16x32_bf16 v[24:27], v[40:43], v[204:207], v[24:27]
    ds_read_b128 v[40:43], v8 offset:20480
    s_waitcnt lgkmcnt(6)
    v_mfma_f32_16x16x32_bf16 v[28:31], v[44:47], v[204:207], v[28:31]
    ds_read_b128 v[44:47], v8 offset:21504
    s_waitcnt lgkmcnt(6)
    v_mfma_f32_16x16x32_bf16 v[32:35], v[48:51], v[204:207], v[32:35]
    ds_read_b128 v[48:51], v8 offset:22528
    s_waitcnt vmcnt(4) lgkmcnt(6)
    v_mfma_f32_16x16x32_bf16 v[16:19], v[52:55], v[208:211], v[16:19]
    ds_read_b128 v[52:55], v8 offset:23552
    s_waitcnt lgkmcnt(6)
    v_mfma_f32_16x16x32_bf16 v[20:23], v[56:59], v[208:211], v[20:23]
    ds_read_b128 v[56:59], v8 offset:24576
    s_waitcnt lgkmcnt(6)
    v_mfma_f32_16x16x32_bf16 v[24:27], v[60:63], v[208:211], v[24:27]
    ds_read_b128 v[60:63], v8 offset:25600
    s_waitcnt lgkmcnt(6)
    v_mfma_f32_16x16x32_bf16 v[28:31], v[64:67], v[208:211], v[28:31]
    ds_read_b128 v[64:67], v8 offset:26624
    s_waitcnt lgkmcnt(6)
    v_mfma_f32_16x16x32_bf16 v[32:35], v[40:43], v[208:211], v[32:35]
    ds_read_b128 v[40:43], v8 offset:27648
    s_waitcnt vmcnt(3) lgkmcnt(6)
    v_mov_b32 v91, 5
    v_mfma_f32_16x16x32_bf16 v[16:19], v[44:47], v[212:215], v[16:19]
    ds_read_b128 v[44:47], v8 offset:28672
    s_waitcnt lgkmcnt(6)
    v_mfma_f32_16x16x32_bf16 v[20:23], v[48:51], v[212:215], v[20:23]
    ds_read_b128 v[48:51], v8 offset:29696
    s_waitcnt lgkmcnt(6)
    v_mfma_f32_16x16x32_bf16 v[24:27], v[52:55], v[212:215], v[24:27]
    ds_read_b128 v[52:55], v8 offset:30720
    s_waitcnt lgkmcnt(6)
    v_mfma_f32_16x16x32_bf16 v[28:31], v[56:59], v[212:215], v[28:31]
    ds_read_b128 v[56:59], v8 offset:31744
    s_waitcnt lgkmcnt(6)
    v_mfma_f32_16x16x32_bf16 v[32:35], v[60:63], v[212:215], v[32:35]
    ds_read_b128 v[60:63], v8 offset:32768
    s_waitcnt vmcnt(2) lgkmcnt(6)
    v_mfma_f32_16x16x32_bf16 v[16:19], v[64:67], v[216:219], v[16:19]
    ds_read_b128 v[64:67], v8 offset:33792
    s_waitcnt lgkmcnt(6)
    v_mfma_f32_16x16x32_bf16 v[20:23], v[40:43], v[216:219], v[20:23]
    ds_read_b128 v[40:43], v8 offset:34816
    s_waitcnt lgkmcnt(6)
    v_mfma_f32_16x16x32_bf16 v[24:27], v[44:47], v[216:219], v[24:27]
    ds_read_b128 v[44:47], v8 offset:35840
    ds_write_b32 v255, v91 offset:16
    ds_read_b32 v90, v254
    s_waitcnt lgkmcnt(8)
    v_mfma_f32_16x16x32_bf16 v[28:31], v[48:51], v[216:219], v[28:31]
    s_waitcnt lgkmcnt(7)
    v_mfma_f32_16x16x32_bf16 v[32:35], v[52:55], v[216:219], v[32:35]
    s_waitcnt vmcnt(0) lgkmcnt(6)
    v_mfma_f32_16x16x32_bf16 v[16:19], v[56:59], v[220:223], v[16:19]
    s_waitcnt lgkmcnt(5)
    v_mfma_f32_16x16x32_bf16 v[20:23], v[60:63], v[220:223], v[20:23]
    s_waitcnt lgkmcnt(4)
    v_mfma_f32_16x16x32_bf16 v[24:27], v[64:67], v[220:223], v[24:27]
    s_waitcnt lgkmcnt(3)
    v_mfma_f32_16x16x32_bf16 v[28:31], v[40:43], v[220:223], v[28:31]
    s_waitcnt lgkmcnt(2)
    v_mfma_f32_16x16x32_bf16 v[32:35], v[44:47], v[220:223], v[32:35]
    s_waitcnt lgkmcnt(0)
    v_cmp_gt_u32 vcc, 6, v90
    s_cbranch_vccnz L_ll80
L_ld81:
    v_cvt_pk_bf16_f32 v80, v16, v17
    v_cvt_pk_bf16_f32 v81, v18, v19
    v_cvt_pk_bf16_f32 v82, v20, v21
    v_cvt_pk_bf16_f32 v83, v22, v23
    v_cvt_pk_bf16_f32 v84, v24, v25
    v_cvt_pk_bf16_f32 v85, v26, v27
    v_cvt_pk_bf16_f32 v86, v28, v29
    v_cvt_pk_bf16_f32 v87, v30, v31
    v_cvt_pk_bf16_f32 v88, v32, v33
    v_cvt_pk_bf16_f32 v89, v34, v35
    s_add_u32 s43, s41, 2621440
    s_add_u32 s44, s42, 2621440
    s_cmp_lg_u32 s24, 0
    s_cbranch_scc1 L_sf83
    buffer_store_dwordx4 v[80:83], v3, s[20:23], s43 offen
    buffer_store_dwordx4 v[84:87], v3, s[20:23], s43 offen offset:1024
    buffer_store_dwordx2 v[88:89], v3, s[20:23], s44 offen
L_se84:
    v_mov_b32 v36, 0
    v_mov_b32 v37, 0
    v_mov_b32 v38, 0x3f803f80
    v_dot2c_f32_bf16 v36, v80, v38
    v_dot2c_f32_bf16 v37, v80, v80
    v_dot2c_f32_bf16 v36, v81, v38
    v_dot2c_f32_bf16 v37, v81, v81
    v_dot2c_f32_bf16 v36, v82, v38
    v_dot2c_f32_bf16 v37, v82, v82
    v_dot2c_f32_bf16 v36, v83, v38
    v_dot2c_f32_bf16 v37, v83, v83
    v_dot2c_f32_bf16 v36, v84, v38
    v_dot2c_f32_bf16 v37, v84, v84
    v_dot2c_f32_bf16 v36, v85, v38
    v_dot2c_f32_bf16 v37, v85, v85
    v_dot2c_f32_bf16 v36, v86, v38
    v_dot2c_f32_bf16 v37, v86, v86
    v_dot2c_f32_bf16 v36, v87, v38
    v_dot2c_f32_bf16 v37, v87, v87
    v_dot2c_f32_bf16 v36, v88, v38
    v_dot2c_f32_bf16 v37, v88, v88
    v_dot2c_f32_bf16 v36, v89, v38
    v_dot2c_f32_bf16 v37, v89, v89
    s_waitcnt vmcnt(0)
    v_mov_b32 v4, 1
    s_mov_b64 exec, 1
    s_cmp_lg_u32 s24, 0
    s_cbranch_scc1 L_sf85
    buffer_store_dword v4, v2, s[20:23], s34 offen
L_se86:
    s_mov_b64 exec, -1
    buffer_load_dword v15, v14, s[20:23], s33 offen sc1
    v_mov_b32 v38, v36
    v_mov_b32 v39, v37
    s_nop 0
    v_permlane16_swap_b32 v36, v38
    v_permlane16_swap_b32 v37, v39
    v_add_f32 v36, v36, v38
    v_add_f32 v37, v37, v39
    v_mov_b32 v38, v36
    v_mov_b32 v39, v37
    s_nop 0
    v_permlane32_swap_b32 v36, v38
    v_permlane32_swap_b32 v37, v39
    v_add_f32 v36, v36, v38
    v_add_f32 v37, v37, v39
L_c1:
    s_lshr_b32 s43, s28, 2
    s_add_u32 s43, s43, 1
    s_sub_u32 s44, 0, s43
    s_bitcmp1_b32 s28, 1
    s_cselect_b32 s43, s44, s43
    s_lshl_b32 s44, s29, 4
    s_add_u32 s44, s44, s43
    v_and_b32 v10, 15, v1
    v_add_u32 v10, s44, v10
    v_ashrrev_i32 v12, 8, v10
    v_cmp_eq_u32 s[12:13], s25, v12
    v_cmp_gt_u32 s[14:15], 8, v12
    v_lshrrev_b32 v11, 4, v10
    v_mul_u32_u24 v11, 20480, v11
    v_and_b32 v10, 15, v10
    v_lshl_add_u32 v11, v10, 4, v11
    v_and_b32 v10, 0x30, v1
    v_lshl_add_u32 v229, v10, 4, v11
    s_and_b32 s43, s29, 15
    s_lshl_b32 s39, s25, 11
    s_add_u32 s39, s39, 18112512
    s_sub_u32 s44, s33, 128
    s_sub_u32 s45, s39, 1024
    s_cmp_eq_u32 s43, 0
    s_cselect_b32 s44, s45, s44
    s_cselect_b32 s27, 5, 0
    s_cmp_eq_u32 s29, 0
    s_cselect_b32 s44, s33, s44
    s_cselect_b32 s27, 0, s27
    v_lshlrev_b32 v12, s27, v14
    v_add_u32 v12, s44, v12
    v_add_u32 v13, s33, v14
    v_bfe_u32 v10, v1, 3, 2
    v_cmp_eq_u32 vcc, 1, v10
    s_add_u32 s44, s33, 128
    s_add_u32 s45, s39, 2048
    v_cndmask_b32 v13, v13, v12, vcc
    s_cmp_eq_u32 s43, 15
    s_cselect_b32 s44, s45, s44
    s_cselect_b32 s27, 5, 0
    s_cmp_eq_u32 s29, 127
    s_cselect_b32 s44, s33, s44
    s_cselect_b32 s27, 0, s27
    v_lshlrev_b32 v12, s27, v14
    v_add_u32 v12, s44, v12
    v_cmp_eq_u32 vcc, 2, v10
    s_and_b32 s44, s29, 1
    s_lshl_b32 s44, s44, 3
    s_add_u32 s44, s44, s28
    s_lshl_b32 s44, s44, 7
    s_add_u32 s39, s39, s44
    v_cndmask_b32 v228, v13, v12, vcc
    s_cmp_eq_u32 s43, 0
    s_cselect_b32 s44, 2621440, 0
    s_cmp_eq_u32 s29, 0
    s_cselect_b32 s44, 0x40000000, s44
    s_cmp_eq_u32 s43, 15
    s_cselect_b32 s45, 2621440, 0
    s_cmp_eq_u32 s29, 127
    s_cselect_b32 s45, 0x40000000, s45
    v_and_b32 v10, 15, v1
    v_add_u32 v11, s44, v3
    v_add_u32 v12, s45, v3
    v_cmp_gt_u32 vcc, 1, v10
    s_nop 1
    v_cndmask_b32 v224, v3, v11, vcc
    v_cmp_lt_u32 vcc, 14, v10
    s_nop 1
    v_cndmask_b32 v225, v3, v12, vcc
    v_cmp_gt_u32 vcc, 2, v10
    s_nop 1
    v_cndmask_b32 v226, v3, v11, vcc
    v_cmp_lt_u32 vcc, 13, v10
    s_nop 1
    v_cndmask_b32 v227, v3, v12, vcc
    s_andn2_b64 s[14:15], s[14:15], s[12:13]
    s_waitcnt vmcnt(0)
    v_cmp_gt_u32 vcc, 1, v15
    s_cbranch_vccnz L_pl87
L_pd88:
    ds_read_b32 v90, v254
    s_add_u32 s43, s40, 2621440
    buffer_load_dwordx4 v[144:147], v3, s[20:23], s43 offen offset:0 sc1
    buffer_load_dwordx4 v[148:151], v3, s[20:23], s43 offen offset:1024 sc1
    buffer_load_dwordx4 v[152:155], v3, s[20:23], s43 offen offset:2048 sc1
    buffer_load_dwordx4 v[156:159], v3, s[20:23], s43 offen offset:3072 sc1
    s_add_u32 s43, s40, 2625536
    buffer_load_dwordx4 v[160:163], v3, s[20:23], s43 offen offset:0 sc1
    buffer_load_dwordx4 v[164:167], v3, s[20:23], s43 offen offset:1024 sc1
    buffer_load_dwordx4 v[168:171], v3, s[20:23], s43 offen offset:2048 sc1
    buffer_load_dwordx4 v[172:175], v3, s[20:23], s43 offen offset:3072 sc1
    s_add_u32 s44, s9, 0
    s_mov_b64 exec, 0xffff
    s_cmp_lg_u32 s24, 0
    s_cbranch_scc1 L_sf90
    buffer_store_dwordx2 v[36:37], v3, s[20:23], s44 offen
L_se91:
    s_mov_b64 exec, -1
    s_waitcnt lgkmcnt(0)
    v_cmp_gt_u32 vcc, 10, v90
    s_cbranch_vccnz L_ll92
L_ld93:
    ds_read_b128 v[48:51], v8 offset:36864
    ds_read_b128 v[52:55], v8 offset:37888
    ds_read_b128 v[56:59], v8 offset:38912
    ds_read_b128 v[60:63], v8 offset:39936
    ds_read_b128 v[64:67], v8 offset:40960
    ds_read_b128 v[40:43], v8 offset:41984
    ds_read_b128 v[112:115], v7 offset:0
    ds_read_b128 v[116:119], v7 offset:64
    ds_read_b128 v[120:123], v7 offset:128
    ds_read_b128 v[124:127], v7 offset:192
    ds_read_b128 v[128:131], v7 offset:256
    v_lshlrev_b32 v92, 16, v80
    v_and_b32 v93, 0xffff0000, v80
    v_lshlrev_b32 v94, 16, v81
    v_and_b32 v95, 0xffff0000, v81
    v_lshlrev_b32 v96, 16, v82
    v_and_b32 v97, 0xffff0000, v82
    v_lshlrev_b32 v98, 16, v83
    v_and_b32 v99, 0xffff0000, v83
    v_lshlrev_b32 v100, 16, v84
    v_and_b32 v101, 0xffff0000, v84
    v_lshlrev_b32 v102, 16, v85
    v_and_b32 v103, 0xffff0000, v85
    v_lshlrev_b32 v104, 16, v86
    v_and_b32 v105, 0xffff0000, v86
    v_lshlrev_b32 v106, 16, v87
    v_and_b32 v107, 0xffff0000, v87
    v_lshlrev_b32 v108, 16, v88
    v_and_b32 v109, 0xffff0000, v88
    v_lshlrev_b32 v110, 16, v89
    v_and_b32 v111, 0xffff0000, v89
    ds_read_b128 v[44:47], v8 offset:43008
    s_add_u32 s43, s40, 2629632
    buffer_load_dwordx4 v[176:179], v3, s[20:23], s43 offen offset:0 sc1
    s_waitcnt vmcnt(9) lgkmcnt(11)
    v_mfma_f32_16x16x32_bf16 v[16:19], v[48:51], v[144:147], 0
    ds_read_b128 v[48:51], v8 offset:44032
    s_waitcnt lgkmcnt(11)
    v_mfma_f32_16x16x32_bf16 v[20:23], v[52:55], v[144:147], 0
    ds_read_b128 v[52:55], v8 offset:45056
    s_waitcnt lgkmcnt(11)
    v_mfma_f32_16x16x32_bf16 v[24:27], v[56:59], v[144:147], 0
    ds_read_b128 v[56:59], v8 offset:46080
    s_waitcnt lgkmcnt(11)
    v_mfma_f32_16x16x32_bf16 v[28:31], v[60:63], v[144:147], 0
    ds_read_b128 v[60:63], v8 offset:47104
    s_waitcnt lgkmcnt(11)
    v_mfma_f32_16x16x32_bf16 v[32:35], v[64:67], v[144:147], 0
    ds_read_b128 v[64:67], v8 offset:48128
    buffer_load_dwordx4 v[180:183], v3, s[20:23], s43 offen offset:1024 sc1
    s_waitcnt vmcnt(9) lgkmcnt(11)
    v_mfma_f32_16x16x32_bf16 v[16:19], v[40:43], v[148:151], v[16:19]
    ds_read_b128 v[40:43], v8 offset:49152
    s_waitcnt lgkmcnt(6)
    v_mfma_f32_16x16x32_bf16 v[20:23], v[44:47], v[148:151], v[20:23]
    ds_read_b128 v[44:47], v8 offset:50176
    s_waitcnt lgkmcnt(6)
    v_mfma_f32_16x16x32_bf16 v[24:27], v[48:51], v[148:151], v[24:27]
    ds_read_b128 v[48:51], v8 offset:51200
    s_waitcnt lgkmcnt(6)
    v_mfma_f32_16x16x32_bf16 v[28:31], v[52:55], v[148:151], v[28:31]
    ds_read_b128 v[52:55], v8 offset:52224
    s_waitcnt lgkmcnt(6)
    v_mfma_f32_16x16x32_bf16 v[32:35], v[56:59], v[148:151], v[32:35]
    ds_read_b128 v[56:59], v8 offset:53248
    buffer_load_dwordx4 v[184:187], v3, s[20:23], s43 offen offset:2048 sc1
    s_waitcnt vmcnt(9) lgkmcnt(6)
    v_mfma_f32_16x16x32_bf16 v[16:19], v[60:63], v[152:155], v[16:19]
    ds_read_b128 v[60:63], v8 offset:54272
    s_waitcnt lgkmcnt(6)
    v_mfma_f32_16x16x32_bf16 v[20:23], v[64:67], v[152:155], v[20:23]
    ds_read_b128 v[64:67], v8 offset:55296
    s_waitcnt lgkmcnt(6)
    v_mfma_f32_16x16x32_bf16 v[24:27], v[40:43], v[152:155], v[24:27]
    ds_read_b128 v[40:43], v8 offset:56320
    s_waitcnt lgkmcnt(6)
    v_mfma_f32_16x16x32_bf16 v[28:31], v[44:47], v[152:155], v[28:31]
    ds_read_b128 v[44:47], v8 offset:57344
    s_waitcnt lgkmcnt(6)
    v_mfma_f32_16x16x32_bf16 v[32:35], v[48:51], v[152:155], v[32:35]
    ds_read_b128 v[48:51], v8 offset:58368
    buffer_load_dwordx4 v[188:191], v3, s[20:23], s43 offen offset:3072 sc1
    s_waitcnt vmcnt(9) lgkmcnt(6)
    v_mfma_f32_16x16x32_bf16 v[16:19], v[52:55], v[156:159], v[16:19]
    ds_read_b128 v[52:55], v8 offset:59392
    s_waitcnt lgkmcnt(6)
    v_mfma_f32_16x16x32_bf16 v[20:23], v[56:59], v[156:159], v[20:23]
    ds_read_b128 v[56:59], v8 offset:60416
    s_waitcnt lgkmcnt(6)
    v_mfma_f32_16x16x32_bf16 v[24:27], v[60:63], v[156:159], v[24:27]
    ds_read_b128 v[60:63], v8 offset:61440
    s_waitcnt lgkmcnt(6)
    v_mfma_f32_16x16x32_bf16 v[28:31], v[64:67], v[156:159], v[28:31]
    ds_read_b128 v[64:67], v8 offset:62464
    s_waitcnt lgkmcnt(6)
    v_mfma_f32_16x16x32_bf16 v[32:35], v[40:43], v[156:159], v[32:35]
    ds_read_b128 v[40:43], v8 offset:63488
    s_waitcnt vmcnt(4)
    v_mov_b32 v4, 2
    s_mov_b64 exec, 1
    s_cmp_lg_u32 s24, 0
    s_cbranch_scc1 L_sf95
    buffer_store_dword v4, v2, s[20:23], s34 offen
L_se96:
    s_mov_b64 exec, -1
    s_add_u32 s43, s40, 2633728
    buffer_load_dwordx4 v[192:195], v3, s[20:23], s43 offen offset:0 sc1
    s_waitcnt vmcnt(10) lgkmcnt(6)
    v_mfma_f32_16x16x32_bf16 v[16:19], v[44:47], v[160:163], v[16:19]
    ds_read_b128 v[44:47], v8 offset:64512
    s_waitcnt lgkmcnt(6)
    v_mfma_f32_16x16x32_bf16 v[20:23], v[48:51], v[160:163], v[20:23]
    ds_read_b128 v[48:51], v9 offset:0
    s_waitcnt lgkmcnt(6)
    v_mfma_f32_16x16x32_bf16 v[24:27], v[52:55], v[160:163], v[24:27]
    ds_read_b128 v[52:55], v9 offset:1024
    s_waitcnt lgkmcnt(6)
    v_mfma_f32_16x16x32_bf16 v[28:31], v[56:59], v[160:163], v[28:31]
    ds_read_b128 v[56:59], v9 offset:2048
    s_waitcnt lgkmcnt(6)
    v_mfma_f32_16x16x32_bf16 v[32:35], v[60:63], v[160:163], v[32:35]
    ds_read_b128 v[60:63], v9 offset:3072
    buffer_load_dwordx4 v[196:199], v3, s[20:23], s43 offen offset:1024 sc1
    s_waitcnt vmcnt(10) lgkmcnt(6)
    v_mfma_f32_16x16x32_bf16 v[16:19], v[64:67], v[164:167], v[16:19]
    ds_read_b128 v[64:67], v9 offset:4096
    s_waitcnt lgkmcnt(6)
    v_mfma_f32_16x16x32_bf16 v[20:23], v[40:43], v[164:167], v[20:23]
    ds_read_b128 v[40:43], v9 offset:5120
    s_waitcnt lgkmcnt(6)
    v_mfma_f32_16x16x32_bf16 v[24:27], v[44:47], v[164:167], v[24:27]
    ds_read_b128 v[44:47], v9 offset:6144
    s_waitcnt lgkmcnt(6)
    v_mfma_f32_16x16x32_bf16 v[28:31], v[48:51], v[164:167], v[28:31]
    ds_read_b128 v[48:51], v9 offset:7168
    s_waitcnt lgkmcnt(6)
    v_mfma_f32_16x16x32_bf16 v[32:35], v[52:55], v[164:167], v[32:35]
    ds_read_b128 v[52:55], v9 offset:8192
    buffer_load_dwordx4 v[200:203], v3, s[20:23], s43 offen offset:2048 sc1
    s_waitcnt vmcnt(10) lgkmcnt(6)
    v_mfma_f32_16x16x32_bf16 v[16:19], v[56:59], v[168:171], v[16:19]
    ds_read_b128 v[56:59], v9 offset:9216
    s_waitcnt lgkmcnt(6)
    v_mfma_f32_16x16x32_bf16 v[20:23], v[60:63], v[168:171], v[20:23]
    ds_read_b128 v[60:63], v9 offset:10240
    s_waitcnt lgkmcnt(6)
    v_mfma_f32_16x16x32_bf16 v[24:27], v[64:67], v[168:171], v[24:27]
    ds_read_b128 v[64:67], v9 offset:11264
    s_waitcnt lgkmcnt(6)
    v_mfma_f32_16x16x32_bf16 v[28:31], v[40:43], v[168:171], v[28:31]
    ds_read_b128 v[40:43], v3 offset:0
    s_waitcnt lgkmcnt(6)
    v_mfma_f32_16x16x32_bf16 v[32:35], v[44:47], v[168:171], v[32:35]
    ds_read_b128 v[44:47], v3 offset:1024
    buffer_load_dwordx4 v[204:207], v3, s[20:23], s43 offen offset:3072 sc1
    s_waitcnt vmcnt(10) lgkmcnt(6)
    v_mfma_f32_16x16x32_bf16 v[16:19], v[48:51], v[172:175], v[16:19]
    ds_read_b128 v[48:51], v3 offset:2048
    s_waitcnt lgkmcnt(6)
    v_mfma_f32_16x16x32_bf16 v[20:23], v[52:55], v[172:175], v[20:23]
    ds_read_b128 v[52:55], v3 offset:3072
    s_waitcnt lgkmcnt(6)
    v_mfma_f32_16x16x32_bf16 v[24:27], v[56:59], v[172:175], v[24:27]
    ds_read_b128 v[56:59], v3 offset:4096
    s_waitcnt lgkmcnt(6)
    v_mfma_f32_16x16x32_bf16 v[28:31], v[60:63], v[172:175], v[28:31]
    ds_read_b128 v[60:63], v3 offset:5120
    s_waitcnt lgkmcnt(6)
    v_mfma_f32_16x16x32_bf16 v[32:35], v[64:67], v[172:175], v[32:35]
    ds_read_b128 v[64:67], v3 offset:6144
    s_add_u32 s43, s40, 2637824
    buffer_load_dwordx4 v[208:211], v3, s[20:23], s43 offen offset:0 sc1
    s_waitcnt vmcnt(9) lgkmcnt(6)
    v_mfma_f32_16x16x32_bf16 v[16:19], v[40:43], v[176:179], v[16:19]
    ds_read_b128 v[40:43], v3 offset:7168
    s_waitcnt lgkmcnt(6)
    v_mfma_f32_16x16x32_bf16 v[20:23], v[44:47], v[176:179], v[20:23]
    ds_read_b128 v[44:47], v3 offset:8192
    s_waitcnt lgkmcnt(6)
    v_mfma_f32_16x16x32_bf16 v[24:27], v[48:51], v[176:179], v[24:27]
    ds_read_b128 v[48:51], v3 offset:9216
    s_waitcnt lgkmcnt(6)
    v_mfma_f32_16x16x32_bf16 v[28:31], v[52:55], v[176:179], v[28:31]
    ds_read_b128 v[52:55], v3 offset:10240
    s_waitcnt lgkmcnt(6)
    v_mfma_f32_16x16x32_bf16 v[32:35], v[56:59], v[176:179], v[32:35]
    ds_read_b128 v[56:59], v3 offset:11264
    buffer_load_dwordx4 v[212:215], v3, s[20:23], s43 offen offset:1024 sc1
    buffer_load_dword v15, v14, s[20:23], s33 offen sc1
    s_waitcnt vmcnt(10) lgkmcnt(6)
    v_mov_b32 v91, 8
    v_mfma_f32_16x16x32_bf16 v[16:19], v[60:63], v[180:183], v[16:19]
    ds_read_b128 v[60:63], v3 offset:12288
    s_waitcnt lgkmcnt(6)
    v_mfma_f32_16x16x32_bf16 v[20:23], v[64:67], v[180:183], v[20:23]
    ds_read_b128 v[64:67], v3 offset:13312
    s_waitcnt lgkmcnt(6)
    v_mfma_f32_16x16x32_bf16 v[24:27], v[40:43], v[180:183], v[24:27]
    ds_read_b128 v[40:43], v3 offset:14336
    s_waitcnt lgkmcnt(6)
    v_mfma_f32_16x16x32_bf16 v[28:31], v[44:47], v[180:183], v[28:31]
    ds_read_b128 v[44:47], v3 offset:15360
    s_waitcnt lgkmcnt(6)
    v_mfma_f32_16x16x32_bf16 v[32:35], v[48:51], v[180:183], v[32:35]
    ds_read_b128 v[48:51], v3 offset:16384
    buffer_load_dwordx4 v[216:219], v3, s[20:23], s43 offen offset:2048 sc1
    s_waitcnt vmcnt(10) lgkmcnt(6)
    v_mfma_f32_16x16x32_bf16 v[16:19], v[52:55], v[184:187], v[16:19]
    ds_read_b128 v[52:55], v3 offset:17408
    s_waitcnt lgkmcnt(6)
    v_mfma_f32_16x16x32_bf16 v[20:23], v[56:59], v[184:187], v[20:23]
    ds_read_b128 v[56:59], v3 offset:18432
    s_waitcnt lgkmcnt(6)
    v_mfma_f32_16x16x32_bf16 v[24:27], v[60:63], v[184:187], v[24:27]
    ds_read_b128 v[60:63], v3 offset:19456
    s_waitcnt lgkmcnt(6)
    v_mfma_f32_16x16x32_bf16 v[28:31], v[64:67], v[184:187], v[28:31]
    ds_write_b32 v255, v91 offset:16
    ds_read_b128 v[64:67], v3 offset:20480
    s_waitcnt lgkmcnt(7)
    v_mfma_f32_16x16x32_bf16 v[32:35], v[40:43], v[184:187], v[32:35]
    ds_read_b128 v[40:43], v3 offset:21504
    buffer_load_dwordx4 v[220:223], v3, s[20:23], s43 offen offset:3072 sc1
    s_waitcnt vmcnt(10) lgkmcnt(7)
    v_mfma_f32_16x16x32_bf16 v[16:19], v[44:47], v[188:191], v[16:19]
    ds_read_b128 v[44:47], v3 offset:22528
    s_waitcnt lgkmcnt(7)
    v_mfma_f32_16x16x32_bf16 v[20:23], v[48:51], v[188:191], v[20:23]
    ds_read_b128 v[48:51], v3 offset:23552
    s_waitcnt lgkmcnt(7)
    v_mfma_f32_16x16x32_bf16 v[24:27], v[52:55], v[188:191], v[24:27]
    ds_read_b128 v[52:55], v3 offset:24576
    s_waitcnt lgkmcnt(7)
    v_mfma_f32_16x16x32_bf16 v[28:31], v[56:59], v[188:191], v[28:31]
    ds_read_b128 v[56:59], v3 offset:25600
    s_waitcnt lgkmcnt(7)
    v_mfma_f32_16x16x32_bf16 v[32:35], v[60:63], v[188:191], v[32:35]
    ds_read_b128 v[60:63], v3 offset:26624
    s_waitcnt vmcnt(8) lgkmcnt(6)
    v_mfma_f32_16x16x32_bf16 v[16:19], v[64:67], v[192:195], v[16:19]
    ds_read_b128 v[64:67], v3 offset:27648
    s_waitcnt lgkmcnt(6)
    v_mfma_f32_16x16x32_bf16 v[20:23], v[40:43], v[192:195], v[20:23]
    ds_read_b128 v[40:43], v3 offset:28672
    s_waitcnt lgkmcnt(6)
    v_mfma_f32_16x16x32_bf16 v[24:27], v[44:47], v[192:195], v[24:27]
    ds_read_b128 v[44:47], v3 offset:29696
    s_waitcnt lgkmcnt(6)
    v_mfma_f32_16x16x32_bf16 v[28:31], v[48:51], v[192:195], v[28:31]
    ds_read_b128 v[48:51], v3 offset:30720
    s_waitcnt lgkmcnt(6)
    v_mfma_f32_16x16x32_bf16 v[32:35], v[52:55], v[192:195], v[32:35]
    ds_read_b128 v[52:55], v3 offset:31744
    s_waitcnt vmcnt(7) lgkmcnt(6)
    v_mfma_f32_16x16x32_bf16 v[16:19], v[56:59], v[196:199], v[16:19]
    ds_read_b128 v[56:59], v3 offset:32768
    s_waitcnt lgkmcnt(6)
    v_mfma_f32_16x16x32_bf16 v[20:23], v[60:63], v[196:199], v[20:23]
    ds_read_b128 v[60:63], v3 offset:33792
    s_waitcnt lgkmcnt(6)
    v_mfma_f32_16x16x32_bf16 v[24:27], v[64:67], v[196:199], v[24:27]
    ds_read_b128 v[64:67], v3 offset:34816
    s_waitcnt lgkmcnt(6)
    v_mfma_f32_16x16x32_bf16 v[28:31], v[40:43], v[196:199], v[28:31]
    ds_read_b128 v[40:43], v3 offset:35840
    s_waitcnt lgkmcnt(6)
    v_mfma_f32_16x16x32_bf16 v[32:35], v[44:47], v[196:199], v[32:35]
    ds_read_b128 v[44:47], v3 offset:36864
    s_waitcnt vmcnt(2)
    v_cmp_gt_u32 vcc, 2, v15
    s_cbranch_vccnz L_pl97
L_pd98:
    s_add_u32 s44, s46, 0
    buffer_load_dwordx4 v[72:75], v3, s[20:23], s44 offen sc1
    s_waitcnt vmcnt(7) lgkmcnt(6)
    v_mfma_f32_16x16x32_bf16 v[16:19], v[48:51], v[200:203], v[16:19]
    ds_read_b128 v[48:51], v3 offset:37888
    s_waitcnt lgkmcnt(6)
    v_mfma_f32_16x16x32_bf16 v[20:23], v[52:55], v[200:203], v[20:23]
    ds_read_b128 v[52:55], v3 offset:38912
    s_waitcnt lgkmcnt(6)
    v_mfma_f32_16x16x32_bf16 v[24:27], v[56:59], v[200:203], v[24:27]
    ds_read_b128 v[56:59], v3 offset:39936
    s_waitcnt lgkmcnt(6)
    v_mfma_f32_16x16x32_bf16 v[28:31], v[60:63], v[200:203], v[28:31]
    ds_read_b128 v[60:63], v3 offset:40960
    s_waitcnt lgkmcnt(6)
    v_mfma_f32_16x16x32_bf16 v[32:35], v[64:67], v[200:203], v[32:35]
    ds_read_b128 v[64:67], v3 offset:41984
    s_waitcnt vmcnt(6) lgkmcnt(6)
    v_mfma_f32_16x16x32_bf16 v[16:19], v[40:43], v[204:207], v[16:19]
    ds_read_b128 v[40:43], v3 offset:43008
    s_waitcnt lgkmcnt(6)
    v_mfma_f32_16x16x32_bf16 v[20:23], v[44:47], v[204:207], v[20:23]
    ds_read_b128 v[44:47], v3 offset:44032
    s_waitcnt lgkmcnt(6)
    v_mfma_f32_16x16x32_bf16 v[24:27], v[48:51], v[204:207], v[24:27]
    ds_read_b128 v[48:51], v3 offset:45056
    s_waitcnt lgkmcnt(6)
    v_mfma_f32_16x16x32_bf16 v[28:31], v[52:55], v[204:207], v[28:31]
    ds_read_b128 v[52:55], v3 offset:46080
    s_waitcnt lgkmcnt(6)
    v_mfma_f32_16x16x32_bf16 v[32:35], v[56:59], v[204:207], v[32:35]
    ds_read_b128 v[56:59], v3 offset:47104
    s_waitcnt vmcnt(5) lgkmcnt(6)
    v_mfma_f32_16x16x32_bf16 v[16:19], v[60:63], v[208:211], v[16:19]
    ds_read_b128 v[60:63], v3 offset:48128
    s_waitcnt lgkmcnt(6)
    v_mfma_f32_16x16x32_bf16 v[20:23], v[64:67], v[208:211], v[20:23]
    ds_read_b128 v[64:67], v3 offset:49152
    s_waitcnt lgkmcnt(6)
    v_mfma_f32_16x16x32_bf16 v[24:27], v[40:43], v[208:211], v[24:27]
    ds_read_b128 v[40:43], v3 offset:50176
    s_waitcnt lgkmcnt(6)
    v_mfma_f32_16x16x32_bf16 v[28:31], v[44:47], v[208:211], v[28:31]
    ds_read_b128 v[44:47], v3 offset:51200
    s_waitcnt lgkmcnt(6)
    v_mfma_f32_16x16x32_bf16 v[32:35], v[48:51], v[208:211], v[32:35]
    ds_read_b128 v[48:51], v3 offset:52224
    s_waitcnt vmcnt(4) lgkmcnt(6)
    v_mov_b32 v91, 10
    v_mfma_f32_16x16x32_bf16 v[16:19], v[52:55], v[212:215], v[16:19]
    ds_read_b128 v[52:55], v3 offset:53248
    s_waitcnt lgkmcnt(6)
    v_mfma_f32_16x16x32_bf16 v[20:23], v[56:59], v[212:215], v[20:23]
    ds_read_b128 v[56:59], v3 offset:54272
    s_waitcnt lgkmcnt(6)
    v_mfma_f32_16x16x32_bf16 v[24:27], v[60:63], v[212:215], v[24:27]
    ds_read_b128 v[60:63], v3 offset:55296
    s_waitcnt lgkmcnt(6)
    v_mfma_f32_16x16x32_bf16 v[28:31], v[64:67], v[212:215], v[28:31]
    ds_read_b128 v[64:67], v3 offset:56320
    s_waitcnt lgkmcnt(6)
    v_mfma_f32_16x16x32_bf16 v[32:35], v[40:43], v[212:215], v[32:35]
    ds_read_b128 v[40:43], v3 offset:57344
    s_waitcnt vmcnt(2) lgkmcnt(6)
    v_mfma_f32_16x16x32_bf16 v[16:19], v[44:47], v[216:219], v[16:19]
    ds_read_b128 v[44:47], v3 offset:58368
    s_waitcnt lgkmcnt(6)
    v_mfma_f32_16x16x32_bf16 v[20:23], v[48:51], v[216:219], v[20:23]
    ds_read_b128 v[48:51], v3 offset:59392
    s_waitcnt lgkmcnt(6)
    v_mfma_f32_16x16x32_bf16 v[24:27], v[52:55], v[216:219], v[24:27]
    ds_read_b128 v[52:55], v3 offset:60416
    ds_write_b32 v255, v91 offset:16
    s_waitcnt lgkmcnt(7)
    v_mfma_f32_16x16x32_bf16 v[28:31], v[56:59], v[216:219], v[28:31]
    s_waitcnt lgkmcnt(6)
    v_mfma_f32_16x16x32_bf16 v[32:35], v[60:63], v[216:219], v[32:35]
    s_waitcnt vmcnt(1) lgkmcnt(5)
    v_mfma_f32_16x16x32_bf16 v[16:19], v[64:67], v[220:223], v[16:19]
    s_waitcnt lgkmcnt(4)
    v_mfma_f32_16x16x32_bf16 v[20:23], v[40:43], v[220:223], v[20:23]
    s_waitcnt lgkmcnt(3)
    v_mfma_f32_16x16x32_bf16 v[24:27], v[44:47], v[220:223], v[24:27]
    s_waitcnt lgkmcnt(2)
    v_mfma_f32_16x16x32_bf16 v[28:31], v[48:51], v[220:223], v[28:31]
    s_waitcnt lgkmcnt(1)
    v_mfma_f32_16x16x32_bf16 v[32:35], v[52:55], v[220:223], v[32:35]
    s_waitcnt vmcnt(0)
    v_add_f32 v72, v72, v74
    v_add_f32 v73, v73, v75
    v_mov_b32 v74, v72
    v_mov_b32 v75, v73
    s_nop 0
    v_permlane16_swap_b32 v72, v74
    v_permlane16_swap_b32 v73, v75
    v_add_f32 v72, v72, v74
    v_add_f32 v73, v73, v75
    v_mov_b32 v74, v72
    v_mov_b32 v75, v73
    s_nop 0
    v_permlane32_swap_b32 v72, v74
    v_permlane32_swap_b32 v73, v75
    v_add_f32 v72, v72, v74
    v_add_f32 v73, v73, v75
    v_mul_f32 v72, 0x3acccccd, v72
    v_mul_f32 v73, 0x3acccccd, v73
    v_fma_f32 v73, -v72, v72, v73
    v_max_f32 v73, 0, v73
    v_add_f32 v74, 0x3727c5ac, v73
    v_rsq_f32 v74, v74
    s_nop 0
    v_mul_f32 v68, v73, v74
    v_mov_b32 v69, 0x3727c5ac
    v_fma_f32 v68, v68, v74, v69
    v_rsq_f32 v68, v68
    s_sub_u32 s43, s41, s40
    s_sub_u32 s44, s42, s40
    s_add_u32 s43, s43, 5242880
    s_add_u32 s44, s44, 5242880
    v_mul_f32 v70, v68, v74
    v_rcp_f32 v79, v70
    v_mul_f32 v12, 0xc0135761, v70
    v_mul_f32 v10, v70, v70
    v_mov_b32 v77, v72
    v_mul_f32 v10, v10, v12
    v_mov_b32 v13, v12
    v_mul_f32 v10, 0x3d372713, v10
    v_mov_b32 v76, v77
    v_mov_b32 v78, v79
    v_mov_b32 v11, v10
    v_pk_fma_f32 v[16:17], v[112:113], v[76:77], v[16:17] neg_lo:[1,0,0] neg_hi:[1,0,0]
    v_pk_fma_f32 v[18:19], v[114:115], v[76:77], v[18:19] neg_lo:[1,0,0] neg_hi:[1,0,0]
    v_pk_fma_f32 v[20:21], v[116:117], v[76:77], v[20:21] neg_lo:[1,0,0] neg_hi:[1,0,0]
    v_pk_fma_f32 v[22:23], v[118:119], v[76:77], v[22:23] neg_lo:[1,0,0] neg_hi:[1,0,0]
    v_pk_fma_f32 v[24:25], v[120:121], v[76:77], v[24:25] neg_lo:[1,0,0] neg_hi:[1,0,0]
    v_pk_fma_f32 v[26:27], v[122:123], v[76:77], v[26:27] neg_lo:[1,0,0] neg_hi:[1,0,0]
    v_pk_fma_f32 v[28:29], v[124:125], v[76:77], v[28:29] neg_lo:[1,0,0] neg_hi:[1,0,0]
    v_pk_fma_f32 v[30:31], v[126:127], v[76:77], v[30:31] neg_lo:[1,0,0] neg_hi:[1,0,0]
    v_pk_fma_f32 v[32:33], v[128:129], v[76:77], v[32:33] neg_lo:[1,0,0] neg_hi:[1,0,0]
    v_pk_fma_f32 v[34:35], v[130:131], v[76:77], v[34:35] neg_lo:[1,0,0] neg_hi:[1,0,0]
    v_pk_mul_f32 v[112:113], v[16:17], v[16:17]
    v_pk_mul_f32 v[114:115], v[18:19], v[18:19]
    v_pk_mul_f32 v[116:117], v[20:21], v[20:21]
    v_pk_mul_f32 v[118:119], v[22:23], v[22:23]
    v_pk_mul_f32 v[120:121], v[24:25], v[24:25]
    v_pk_mul_f32 v[122:123], v[26:27], v[26:27]
    v_pk_mul_f32 v[124:125], v[28:29], v[28:29]
    v_pk_mul_f32 v[126:127], v[30:31], v[30:31]
    v_pk_mul_f32 v[128:129], v[32:33], v[32:33]
    v_pk_mul_f32 v[130:131], v[34:35], v[34:35]
    v_pk_fma_f32 v[112:113], v[112:113], v[10:11], v[12:13]
    v_pk_fma_f32 v[114:115], v[114:115], v[10:11], v[12:13]
    v_pk_fma_f32 v[116:117], v[116:117], v[10:11], v[12:13]
    v_pk_fma_f32 v[118:119], v[118:119], v[10:11], v[12:13]
    v_pk_fma_f32 v[120:121], v[120:121], v[10:11], v[12:13]
    v_pk_fma_f32 v[122:123], v[122:123], v[10:11], v[12:13]
    v_pk_fma_f32 v[124:125], v[124:125], v[10:11], v[12:13]
    v_pk_fma_f32 v[126:127], v[126:127], v[10:11], v[12:13]
    v_pk_fma_f32 v[128:129], v[128:129], v[10:11], v[12:13]
    v_pk_fma_f32 v[130:131], v[130:131], v[10:11], v[12:13]
    v_pk_mul_f32 v[112:113], v[112:113], v[16:17]
    v_pk_mul_f32 v[114:115], v[114:115], v[18:19]
    v_pk_mul_f32 v[116:117], v[116:117], v[20:21]
    v_pk_mul_f32 v[118:119], v[118:119], v[22:23]
    v_pk_mul_f32 v[120:121], v[120:121], v[24:25]
    v_pk_mul_f32 v[122:123], v[122:123], v[26:27]
    v_pk_mul_f32 v[124:125], v[124:125], v[28:29]
    v_pk_mul_f32 v[126:127], v[126:127], v[30:31]
    v_pk_mul_f32 v[128:129], v[128:129], v[32:33]
    v_pk_mul_f32 v[130:131], v[130:131], v[34:35]
    v_exp_f32 v112, v112
    v_exp_f32 v113, v113
    v_exp_f32 v114, v114
    v_exp_f32 v115, v115
    v_exp_f32 v116, v116
    v_exp_f32 v117, v117
    v_exp_f32 v118, v118
    v_exp_f32 v119, v119
    v_exp_f32 v120, v120
    v_exp_f32 v121, v121
    v_exp_f32 v122, v122
    v_exp_f32 v123, v123
    v_exp_f32 v124, v124
    v_exp_f32 v125, v125
    v_exp_f32 v126, v126
    v_exp_f32 v127, v127
    v_exp_f32 v128, v128
    v_exp_f32 v129, v129
    v_exp_f32 v130, v130
    v_exp_f32 v131, v131
    v_pk_fma_f32 v[112:113], v[112:113], v[78:79], v[78:79]
    v_pk_fma_f32 v[114:115], v[114:115], v[78:79], v[78:79]
    v_pk_fma_f32 v[116:117], v[116:117], v[78:79], v[78:79]
    v_pk_fma_f32 v[118:119], v[118:119], v[78:79], v[78:79]
    v_pk_fma_f32 v[120:121], v[120:121], v[78:79], v[78:79]
    v_pk_fma_f32 v[122:123], v[122:123], v[78:79], v[78:79]
    v_pk_fma_f32 v[124:125], v[124:125], v[78:79], v[78:79]
    v_pk_fma_f32 v[126:127], v[126:127], v[78:79], v[78:79]
    v_pk_fma_f32 v[128:129], v[128:129], v[78:79], v[78:79]
    v_pk_fma_f32 v[130:131], v[130:131], v[78:79], v[78:79]
    v_rcp_f32 v112, v112
    v_rcp_f32 v113, v113
    v_rcp_f32 v114, v114
    v_rcp_f32 v115, v115
    v_rcp_f32 v116, v116
    v_rcp_f32 v117, v117
    v_rcp_f32 v118, v118
    v_rcp_f32 v119, v119
    v_rcp_f32 v120, v120
    v_rcp_f32 v121, v121
    v_rcp_f32 v122, v122
    v_rcp_f32 v123, v123
    v_rcp_f32 v124, v124
    v_rcp_f32 v125, v125
    v_rcp_f32 v126, v126
    v_rcp_f32 v127, v127
    v_rcp_f32 v128, v128
    v_rcp_f32 v129, v129
    v_rcp_f32 v130, v130
    v_rcp_f32 v131, v131
    v_pk_mul_f32 v[16:17], v[16:17], v[112:113]
    v_pk_mul_f32 v[18:19], v[18:19], v[114:115]
    v_pk_mul_f32 v[20:21], v[20:21], v[116:117]
    v_pk_mul_f32 v[22:23], v[22:23], v[118:119]
    v_pk_mul_f32 v[24:25], v[24:25], v[120:121]
    v_pk_mul_f32 v[26:27], v[26:27], v[122:123]
    v_pk_mul_f32 v[28:29], v[28:29], v[124:125]
    v_pk_mul_f32 v[30:31], v[30:31], v[126:127]
    v_pk_mul_f32 v[32:33], v[32:33], v[128:129]
    v_pk_mul_f32 v[34:35], v[34:35], v[130:131]
    v_cvt_pk_bf16_f32 v132, v16, v17
    v_cvt_pk_bf16_f32 v133, v18, v19
    v_cvt_pk_bf16_f32 v134, v20, v21
    v_cvt_pk_bf16_f32 v135, v22, v23
    v_cvt_pk_bf16_f32 v136, v24, v25
    v_cvt_pk_bf16_f32 v137, v26, v27
    v_cvt_pk_bf16_f32 v138, v28, v29
    v_cvt_pk_bf16_f32 v139, v30, v31
    v_cvt_pk_bf16_f32 v140, v32, v33
    v_cvt_pk_bf16_f32 v141, v34, v35
    s_mov_b64 exec, s[12:13]
    s_cmp_lg_u32 s24, 0
    s_cbranch_scc1 L_sf100
    buffer_store_dwordx4 v[132:135], v229, s[20:23], s43 offen
    buffer_store_dwordx4 v[136:139], v229, s[20:23], s43 offen offset:1024
    buffer_store_dwordx2 v[140:141], v229, s[20:23], s44 offen
L_se101:
    s_cmp_lg_u64 s[14:15], 0
    s_cbranch_scc1 L_halo
L_haloe:
    s_mov_b64 exec, -1
    v_mul_f32 v72, v72, v74
    v_mov_b32 v75, v74
    v_mov_b32 v73, v72
    v_pk_fma_f32 v[16:17], v[92:93], v[74:75], v[72:73] neg_lo:[0,0,1] neg_hi:[0,0,1]
    v_pk_fma_f32 v[18:19], v[94:95], v[74:75], v[72:73] neg_lo:[0,0,1] neg_hi:[0,0,1]
    v_pk_fma_f32 v[20:21], v[96:97], v[74:75], v[72:73] neg_lo:[0,0,1] neg_hi:[0,0,1]
    v_pk_fma_f32 v[22:23], v[98:99], v[74:75], v[72:73] neg_lo:[0,0,1] neg_hi:[0,0,1]
    v_pk_fma_f32 v[24:25], v[100:101], v[74:75], v[72:73] neg_lo:[0,0,1] neg_hi:[0,0,1]
    v_pk_fma_f32 v[26:27], v[102:103], v[74:75], v[72:73] neg_lo:[0,0,1] neg_hi:[0,0,1]
    v_pk_fma_f32 v[28:29], v[104:105], v[74:75], v[72:73] neg_lo:[0,0,1] neg_hi:[0,0,1]
    v_pk_fma_f32 v[30:31], v[106:107], v[74:75], v[72:73] neg_lo:[0,0,1] neg_hi:[0,0,1]
    v_pk_fma_f32 v[32:33], v[108:109], v[74:75], v[72:73] neg_lo:[0,0,1] neg_hi:[0,0,1]
    v_pk_fma_f32 v[34:35], v[110:111], v[74:75], v[72:73] neg_lo:[0,0,1] neg_hi:[0,0,1]
    s_waitcnt vmcnt(0)
    v_mov_b32 v4, 3
    s_mov_b64 exec, 1
    s_cmp_lg_u32 s24, 0
    s_cbranch_scc1 L_sf102
    buffer_store_dword v4, v2, s[20:23], s34 offen
L_se103:
    s_mov_b64 exec, -1
    s_add_u32 s44, s29, 1
    s_and_b32 s44, s44, 14
    s_cmp_eq_u32 s44, 0
    s_cbranch_scc1 L_hf
L_hfe:
    buffer_load_dword v15, v228, s[20:23], 0 offen sc1
    s_waitcnt vmcnt(0)
    v_cmp_gt_u32 vcc, 3, v15
    s_cbranch_vccnz L_pl104
L_pd105:
    ds_read_b32 v90, v254
    s_add_u32 s43, s40, 5242880
    buffer_load_dwordx4 v[144:147], v224, s[20:23], s43 offen offset:0 sc1
    buffer_load_dwordx4 v[148:151], v224, s[20:23], s43 offen offset:1024 sc1
    buffer_load_dwordx4 v[152:155], v224, s[20:23], s43 offen offset:2048 sc1
    buffer_load_dwordx4 v[156:159], v224, s[20:23], s43 offen offset:3072 sc1
    s_add_u32 s43, s40, 5246976
    buffer_load_dwordx4 v[160:163], v224, s[20:23], s43 offen offset:0 sc1
    buffer_load_dwordx4 v[164:167], v225, s[20:23], s43 offen offset:1024 sc1
    buffer_load_dwordx4 v[168:171], v225, s[20:23], s43 offen offset:2048 sc1
    buffer_load_dwordx4 v[172:175], v225, s[20:23], s43 offen offset:3072 sc1
    s_waitcnt lgkmcnt(0)
    v_cmp_gt_u32 vcc, 15, v90
    s_cbranch_vccnz L_ll107
L_ld108:
    ds_read_b128 v[56:59], v3 offset:61440
    ds_read_b128 v[60:63], v3 offset:62464
    ds_read_b128 v[64:67], v3 offset:63488
    ds_read_b128 v[40:43], v3 offset:64512
    ds_read_b128 v[44:47], v8 offset:0
    ds_read_b128 v[48:51], v8 offset:1024
    s_bfe_u32 s15, s29, 0x10002
    s_xor_b32 s12, s29, 4
    s_mul_i32 s12, s12, 20480
    s_xor_b32 s8, s34, 512
    s_andn2_b32 s33, s33, 512
    v_bfe_u32 v10, v1, 3, 1
    v_lshl_add_u32 v14, v10, 9, v14
    s_lshl_b32 s45, s28, 10
    s_lshl_b32 s38, s15, 12
    s_lshl_b32 s26, s15, 13
    s_add_u32 s27, s26, s45
    s_add_u32 s26, s27, 5242880
    s_add_u32 s27, s27, 0
    s_cmp_ge_u32 s28, 4
    s_mov_b32 s31, 2637824
    s_cmov_b32 s31, 5255168
    s_cmp_eq_u32 s15, 0
    s_cmov_b32 s31, 2621440
    s_mov_b32 s11, 5259264
    s_cmov_b32 s11, 2637824
    s_add_u32 s31, s31, s45
    s_lshl_b32 s32, s15, 3
    s_add_u32 s32, s32, s45
    s_add_u32 s32, s32, 2629632
    s_lshl_b32 s44, s15, 6
    s_add_u32 s44, s44, 1408
    v_add_u32 v251, s44, v7
    s_lshl_b32 s44, s15, 9
    s_add_u32 s44, s44, 1024
    v_add_u32 v7, s44, v7
    s_lshl_b32 s44, s15, 30
    v_add_u32 v250, s44, v3
    ds_read_b128 v[52:55], v8 offset:2048
    s_add_u32 s43, s40, 5251072
    buffer_load_dwordx4 v[176:179], v225, s[20:23], s43 offen offset:0 sc1
    s_waitcnt vmcnt(8) lgkmcnt(6)
    v_mfma_f32_16x16x32_bf16 v[16:19], v[56:59], v[144:147], v[16:19]
    ds_read_b128 v[56:59], v8 offset:3072
    s_waitcnt lgkmcnt(6)
    v_mfma_f32_16x16x32_bf16 v[20:23], v[60:63], v[144:147], v[20:23]
    ds_read_b128 v[60:63], v8 offset:4096
    s_waitcnt lgkmcnt(6)
    v_mfma_f32_16x16x32_bf16 v[24:27], v[64:67], v[144:147], v[24:27]
    ds_read_b128 v[64:67], v8 offset:5120
    s_waitcnt lgkmcnt(6)
    v_mfma_f32_16x16x32_bf16 v[28:31], v[40:43], v[144:147], v[28:31]
    ds_read_b128 v[40:43], v8 offset:6144
    s_waitcnt lgkmcnt(6)
    v_mfma_f32_16x16x32_bf16 v[32:35], v[44:47], v[144:147], v[32:35]
    ds_read_b128 v[44:47], v8 offset:7168
    buffer_load_dwordx4 v[180:183], v225, s[20:23], s43 offen offset:1024 sc1
    s_waitcnt vmcnt(8) lgkmcnt(6)
    v_mfma_f32_16x16x32_bf16 v[16:19], v[48:51], v[148:151], v[16:19]
    ds_read_b128 v[48:51], v8 offset:8192
    s_waitcnt lgkmcnt(6)
    v_mfma_f32_16x16x32_bf16 v[20:23], v[52:55], v[148:151], v[20:23]
    ds_read_b128 v[52:55], v8 offset:9216
    s_waitcnt lgkmcnt(6)
    v_mfma_f32_16x16x32_bf16 v[24:27], v[56:59], v[148:151], v[24:27]
    ds_read_b128 v[56:59], v8 offset:10240
    s_waitcnt lgkmcnt(6)
    v_mfma_f32_16x16x32_bf16 v[28:31], v[60:63], v[148:151], v[28:31]
    ds_read_b128 v[60:63], v8 offset:11264
    s_waitcnt lgkmcnt(6)
    v_mfma_f32_16x16x32_bf16 v[32:35], v[64:67], v[148:151], v[32:35]
    ds_read_b128 v[64:67], v8 offset:12288
    buffer_load_dwordx4 v[184:187], v226, s[20:23], s43 offen offset:2048 sc1
    s_waitcnt vmcnt(8) lgkmcnt(6)
    v_mfma_f32_16x16x32_bf16 v[16:19], v[40:43], v[152:155], v[16:19]
    ds_read_b128 v[40:43], v8 offset:13312
    s_waitcnt lgkmcnt(6)
    v_mfma_f32_16x16x32_bf16 v[20:23], v[44:47], v[152:155], v[20:23]
    ds_read_b128 v[44:47], v8 offset:14336
    s_waitcnt lgkmcnt(6)
    v_mfma_f32_16x16x32_bf16 v[24:27], v[48:51], v[152:155], v[24:27]
    ds_read_b128 v[48:51], v8 offset:15360
    s_waitcnt lgkmcnt(6)
    v_mfma_f32_16x16x32_bf16 v[28:31], v[52:55], v[152:155], v[28:31]
    ds_read_b128 v[52:55], v8 offset:16384
    s_waitcnt lgkmcnt(6)
    v_mfma_f32_16x16x32_bf16 v[32:35], v[56:59], v[152:155], v[32:35]
    ds_read_b128 v[56:59], v8 offset:17408
    buffer_load_dwordx4 v[188:191], v226, s[20:23], s43 offen offset:3072 sc1
    s_waitcnt vmcnt(8) lgkmcnt(6)
    v_mfma_f32_16x16x32_bf16 v[16:19], v[60:63], v[156:159], v[16:19]
    ds_read_b128 v[60:63], v8 offset:18432
    s_waitcnt lgkmcnt(6)
    v_mfma_f32_16x16x32_bf16 v[20:23], v[64:67], v[156:159], v[20:23]
    ds_read_b128 v[64:67], v8 offset:19456
    s_waitcnt lgkmcnt(6)
    v_mfma_f32_16x16x32_bf16 v[24:27], v[40:43], v[156:159], v[24:27]
    ds_read_b128 v[40:43], v8 offset:20480
    s_waitcnt lgkmcnt(6)
    v_mfma_f32_16x16x32_bf16 v[28:31], v[44:47], v[156:159], v[28:31]
    ds_read_b128 v[44:47], v8 offset:21504
    s_waitcnt lgkmcnt(6)
    v_mfma_f32_16x16x32_bf16 v[32:35], v[48:51], v[156:159], v[32:35]
    ds_read_b128 v[48:51], v8 offset:22528
    s_add_u32 s43, s40, 5255168
    buffer_load_dwordx4 v[192:195], v226, s[20:23], s43 offen offset:0 sc1
    s_waitcnt vmcnt(8) lgkmcnt(6)
    v_mfma_f32_16x16x32_bf16 v[16:19], v[52:55], v[160:163], v[16:19]
    ds_read_b128 v[52:55], v8 offset:23552
    s_waitcnt lgkmcnt(6)
    v_mfma_f32_16x16x32_bf16 v[20:23], v[56:59], v[160:163], v[20:23]
    ds_read_b128 v[56:59], v8 offset:24576
    s_waitcnt lgkmcnt(6)
    v_mfma_f32_16x16x32_bf16 v[24:27], v[60:63], v[160:163], v[24:27]
    ds_read_b128 v[60:63], v8 offset:25600
    s_waitcnt lgkmcnt(6)
    v_mfma_f32_16x16x32_bf16 v[28:31], v[64:67], v[160:163], v[28:31]
    ds_read_b128 v[64:67], v8 offset:26624
    s_waitcnt lgkmcnt(6)
    v_mfma_f32_16x16x32_bf16 v[32:35], v[40:43], v[160:163], v[32:35]
    ds_read_b128 v[40:43], v8 offset:27648
    buffer_load_dwordx4 v[196:199], v226, s[20:23], s43 offen offset:1024 sc1
    s_waitcnt vmcnt(8) lgkmcnt(6)
    v_mfma_f32_16x16x32_bf16 v[16:19], v[44:47], v[164:167], v[16:19]
    ds_read_b128 v[44:47], v8 offset:28672
    s_waitcnt lgkmcnt(6)
    v_mfma_f32_16x16x32_bf16 v[20:23], v[48:51], v[164:167], v[20:23]
    ds_read_b128 v[48:51], v8 offset:29696
    s_waitcnt lgkmcnt(6)
    v_mfma_f32_16x16x32_bf16 v[24:27], v[52:55], v[164:167], v[24:27]
    ds_read_b128 v[52:55], v8 offset:30720
    s_waitcnt lgkmcnt(6)
    v_mfma_f32_16x16x32_bf16 v[28:31], v[56:59], v[164:167], v[28:31]
    ds_read_b128 v[56:59], v8 offset:31744
    s_waitcnt lgkmcnt(6)
    v_mfma_f32_16x16x32_bf16 v[32:35], v[60:63], v[164:167], v[32:35]
    ds_read_b128 v[60:63], v8 offset:32768
    buffer_load_dwordx4 v[200:203], v226, s[20:23], s43 offen offset:2048 sc1
    s_waitcnt vmcnt(8) lgkmcnt(6)
    v_mfma_f32_16x16x32_bf16 v[16:19], v[64:67], v[168:171], v[16:19]
    ds_read_b128 v[64:67], v8 offset:33792
    s_waitcnt lgkmcnt(6)
    v_mfma_f32_16x16x32_bf16 v[20:23], v[40:43], v[168:171], v[20:23]
    ds_read_b128 v[40:43], v8 offset:34816
    s_waitcnt lgkmcnt(6)
    v_mfma_f32_16x16x32_bf16 v[24:27], v[44:47], v[168:171], v[24:27]
    ds_read_b128 v[44:47], v8 offset:35840
    s_waitcnt lgkmcnt(6)
    v_mfma_f32_16x16x32_bf16 v[28:31], v[48:51], v[168:171], v[28:31]
    ds_read_b128 v[48:51], v8 offset:36864
    s_waitcnt lgkmcnt(6)
    v_mfma_f32_16x16x32_bf16 v[32:35], v[52:55], v[168:171], v[32:35]
    ds_read_b128 v[52:55], v8 offset:37888
    buffer_load_dwordx4 v[204:207], v227, s[20:23], s43 offen offset:3072 sc1
    s_waitcnt vmcnt(8) lgkmcnt(6)
    v_mfma_f32_16x16x32_bf16 v[16:19], v[56:59], v[172:175], v[16:19]
    ds_read_b128 v[56:59], v8 offset:38912
    s_waitcnt lgkmcnt(6)
    v_mfma_f32_16x16x32_bf16 v[20:23], v[60:63], v[172:175], v[20:23]
    ds_read_b128 v[60:63], v8 offset:39936
    s_waitcnt lgkmcnt(6)
    v_mfma_f32_16x16x32_bf16 v[24:27], v[64:67], v[172:175], v[24:27]
    ds_read_b128 v[64:67], v8 offset:40960
    s_waitcnt lgkmcnt(6)
    v_mfma_f32_16x16x32_bf16 v[28:31], v[40:43], v[172:175], v[28:31]
    ds_read_b128 v[40:43], v8 offset:41984
    s_waitcnt lgkmcnt(6)
    v_mfma_f32_16x16x32_bf16 v[32:35], v[44:47], v[172:175], v[32:35]
    ds_read_b128 v[44:47], v8 offset:43008
    s_add_u32 s43, s40, 5259264
    buffer_load_dwordx4 v[208:211], v227, s[20:23], s43 offen offset:0 sc1
    s_waitcnt vmcnt(8) lgkmcnt(6)
    v_mfma_f32_16x16x32_bf16 v[16:19], v[48:51], v[176:179], v[16:19]
    ds_read_b128 v[48:51], v8 offset:44032
    s_waitcnt lgkmcnt(6)
    v_mfma_f32_16x16x32_bf16 v[20:23], v[52:55], v[176:179], v[20:23]
    ds_read_b128 v[52:55], v8 offset:45056
    s_waitcnt lgkmcnt(6)
    v_mfma_f32_16x16x32_bf16 v[24:27], v[56:59], v[176:179], v[24:27]
    ds_read_b128 v[56:59], v8 offset:46080
    s_waitcnt lgkmcnt(6)
    v_mfma_f32_16x16x32_bf16 v[28:31], v[60:63], v[176:179], v[28:31]
    ds_read_b128 v[60:63], v8 offset:47104
    s_waitcnt lgkmcnt(6)
    v_mfma_f32_16x16x32_bf16 v[32:35], v[64:67], v[176:179], v[32:35]
    ds_read_b128 v[64:67], v8 offset:48128
    buffer_load_dwordx4 v[212:215], v227, s[20:23], s43 offen offset:1024 sc1
    s_waitcnt vmcnt(8) lgkmcnt(6)
    v_mov_b32 v91, 13
    v_mfma_f32_16x16x32_bf16 v[16:19], v[40:43], v[180:183], v[16:19]
    ds_read_b128 v[40:43], v8 offset:49152
    s_waitcnt lgkmcnt(6)
    v_mfma_f32_16x16x32_bf16 v[20:23], v[44:47], v[180:183], v[20:23]
    ds_read_b128 v[44:47], v8 offset:50176
    s_waitcnt lgkmcnt(6)
    v_mfma_f32_16x16x32_bf16 v[24:27], v[48:51], v[180:183], v[24:27]
    ds_read_b128 v[48:51], v8 offset:51200
    s_waitcnt lgkmcnt(6)
    v_mfma_f32_16x16x32_bf16 v[28:31], v[52:55], v[180:183], v[28:31]
    ds_read_b128 v[52:55], v8 offset:52224
    s_waitcnt lgkmcnt(6)
    v_mfma_f32_16x16x32_bf16 v[32:35], v[56:59], v[180:183], v[32:35]
    ds_read_b128 v[56:59], v8 offset:53248
    buffer_load_dwordx4 v[216:219], v227, s[20:23], s43 offen offset:2048 sc1
    s_waitcnt vmcnt(8) lgkmcnt(6)
    v_mfma_f32_16x16x32_bf16 v[16:19], v[60:63], v[184:187], v[16:19]
    ds_read_b128 v[60:63], v8 offset:54272
    s_waitcnt lgkmcnt(6)
    v_mfma_f32_16x16x32_bf16 v[20:23], v[64:67], v[184:187], v[20:23]
    ds_read_b128 v[64:67], v8 offset:55296
    s_waitcnt lgkmcnt(6)
    v_mfma_f32_16x16x32_bf16 v[24:27], v[40:43], v[184:187], v[24:27]
    ds_read_b128 v[40:43], v8 offset:56320
    s_waitcnt lgkmcnt(6)
    v_mfma_f32_16x16x32_bf16 v[28:31], v[44:47], v[184:187], v[28:31]
    ds_write_b32 v255, v91 offset:16
    ds_read_b128 v[44:47], v8 offset:57344
    s_waitcnt lgkmcnt(7)
    v_mfma_f32_16x16x32_bf16 v[32:35], v[48:51], v[184:187], v[32:35]
    ds_read_b128 v[48:51], v8 offset:58368
    buffer_load_dwordx4 v[220:223], v227, s[20:23], s43 offen offset:3072 sc1
    s_waitcnt vmcnt(8) lgkmcnt(7)
    v_mfma_f32_16x16x32_bf16 v[16:19], v[52:55], v[188:191], v[16:19]
    ds_read_b128 v[52:55], v8 offset:59392
    s_waitcnt lgkmcnt(7)
    v_mfma_f32_16x16x32_bf16 v[20:23], v[56:59], v[188:191], v[20:23]
    ds_read_b128 v[56:59], v8 offset:60416
    s_waitcnt lgkmcnt(7)
    v_mfma_f32_16x16x32_bf16 v[24:27], v[60:63], v[188:191], v[24:27]
    ds_read_b128 v[60:63], v8 offset:61440
    s_waitcnt lgkmcnt(7)
    v_mfma_f32_16x16x32_bf16 v[28:31], v[64:67], v[188:191], v[28:31]
    ds_read_b128 v[64:67], v8 offset:62464
    s_waitcnt lgkmcnt(7)
    v_mfma_f32_16x16x32_bf16 v[32:35], v[40:43], v[188:191], v[32:35]
    ds_read_b128 v[40:43], v8 offset:63488
    s_waitcnt vmcnt(7) lgkmcnt(6)
    v_mfma_f32_16x16x32_bf16 v[16:19], v[44:47], v[192:195], v[16:19]
    ds_read_b128 v[44:47], v8 offset:64512
    s_waitcnt lgkmcnt(6)
    v_mfma_f32_16x16x32_bf16 v[20:23], v[48:51], v[192:195], v[20:23]
    ds_read_b128 v[48:51], v9 offset:0
    s_waitcnt lgkmcnt(6)
    v_mfma_f32_16x16x32_bf16 v[24:27], v[52:55], v[192:195], v[24:27]
    ds_read_b128 v[52:55], v9 offset:1024
    s_waitcnt lgkmcnt(6)
    v_mfma_f32_16x16x32_bf16 v[28:31], v[56:59], v[192:195], v[28:31]
    ds_read_b128 v[56:59], v9 offset:2048
    s_waitcnt lgkmcnt(6)
    v_mfma_f32_16x16x32_bf16 v[32:35], v[60:63], v[192:195], v[32:35]
    ds_read_b128 v[60:63], v9 offset:3072
    s_waitcnt vmcnt(6) lgkmcnt(6)
    v_mfma_f32_16x16x32_bf16 v[16:19], v[64:67], v[196:199], v[16:19]
    ds_read_b128 v[64:67], v9 offset:4096
    s_waitcnt lgkmcnt(6)
    v_mfma_f32_16x16x32_bf16 v[20:23], v[40:43], v[196:199], v[20:23]
    ds_read_b128 v[40:43], v9 offset:5120
    s_waitcnt lgkmcnt(6)
    v_mfma_f32_16x16x32_bf16 v[24:27], v[44:47], v[196:199], v[24:27]
    ds_read_b128 v[44:47], v9 offset:6144
    s_waitcnt lgkmcnt(6)
    v_mfma_f32_16x16x32_bf16 v[28:31], v[48:51], v[196:199], v[28:31]
    ds_read_b128 v[48:51], v9 offset:7168
    s_waitcnt lgkmcnt(6)
    v_mfma_f32_16x16x32_bf16 v[32:35], v[52:55], v[196:199], v[32:35]
    ds_read_b128 v[52:55], v9 offset:8192
    s_waitcnt vmcnt(5) lgkmcnt(6)
    v_mfma_f32_16x16x32_bf16 v[16:19], v[56:59], v[200:203], v[16:19]
    ds_read_b128 v[56:59], v9 offset:9216
    s_waitcnt lgkmcnt(6)
    v_mfma_f32_16x16x32_bf16 v[20:23], v[60:63], v[200:203], v[20:23]
    ds_read_b128 v[60:63], v9 offset:10240
    s_waitcnt lgkmcnt(6)
    v_mfma_f32_16x16x32_bf16 v[24:27], v[64:67], v[200:203], v[24:27]
    ds_read_b128 v[64:67], v9 offset:11264
    s_waitcnt lgkmcnt(6)
    v_mfma_f32_16x16x32_bf16 v[28:31], v[40:43], v[200:203], v[28:31]
    ds_read_b128 v[40:43], v3 offset:0
    s_waitcnt lgkmcnt(6)
    v_mfma_f32_16x16x32_bf16 v[32:35], v[44:47], v[200:203], v[32:35]
    ds_read_b128 v[44:47], v3 offset:1024
    s_waitcnt vmcnt(4) lgkmcnt(6)
    v_mfma_f32_16x16x32_bf16 v[16:19], v[48:51], v[204:207], v[16:19]
    ds_read_b128 v[48:51], v3 offset:2048
    s_waitcnt lgkmcnt(6)
    v_mfma_f32_16x16x32_bf16 v[20:23], v[52:55], v[204:207], v[20:23]
    ds_read_b128 v[52:55], v3 offset:3072
    s_waitcnt lgkmcnt(6)
    v_mfma_f32_16x16x32_bf16 v[24:27], v[56:59], v[204:207], v[24:27]
    ds_read_b128 v[56:59], v3 offset:4096
    s_waitcnt lgkmcnt(6)
    v_mfma_f32_16x16x32_bf16 v[28:31], v[60:63], v[204:207], v[28:31]
    ds_read_b128 v[60:63], v3 offset:5120
    s_waitcnt lgkmcnt(6)
    v_mfma_f32_16x16x32_bf16 v[32:35], v[64:67], v[204:207], v[32:35]
    ds_read_b128 v[64:67], v3 offset:6144
    s_waitcnt vmcnt(3) lgkmcnt(6)
    v_mfma_f32_16x16x32_bf16 v[16:19], v[40:43], v[208:211], v[16:19]
    ds_read_b128 v[40:43], v3 offset:7168
    s_waitcnt lgkmcnt(6)
    v_mfma_f32_16x16x32_bf16 v[20:23], v[44:47], v[208:211], v[20:23]
    ds_read_b128 v[44:47], v3 offset:8192
    s_waitcnt lgkmcnt(6)
    v_mfma_f32_16x16x32_bf16 v[24:27], v[48:51], v[208:211], v[24:27]
    ds_read_b128 v[48:51], v3 offset:9216
    s_waitcnt lgkmcnt(6)
    v_mfma_f32_16x16x32_bf16 v[28:31], v[52:55], v[208:211], v[28:31]
    ds_read_b128 v[52:55], v3 offset:10240
    s_waitcnt lgkmcnt(6)
    v_mfma_f32_16x16x32_bf16 v[32:35], v[56:59], v[208:211], v[32:35]
    ds_read_b128 v[56:59], v3 offset:11264
    s_waitcnt vmcnt(2) lgkmcnt(6)
    v_mov_b32 v91, 15
    v_mfma_f32_16x16x32_bf16 v[16:19], v[60:63], v[212:215], v[16:19]
    ds_read_b128 v[60:63], v3 offset:12288
    s_waitcnt lgkmcnt(6)
    v_mfma_f32_16x16x32_bf16 v[20:23], v[64:67], v[212:215], v[20:23]
    ds_read_b128 v[64:67], v3 offset:13312
    s_waitcnt lgkmcnt(6)
    v_mfma_f32_16x16x32_bf16 v[24:27], v[40:43], v[212:215], v[24:27]
    ds_read_b128 v[40:43], v3 offset:14336
    s_waitcnt lgkmcnt(6)
    v_mfma_f32_16x16x32_bf16 v[28:31], v[44:47], v[212:215], v[28:31]
    ds_read_b128 v[44:47], v3 offset:15360
    s_waitcnt lgkmcnt(6)
    v_mfma_f32_16x16x32_bf16 v[32:35], v[48:51], v[212:215], v[32:35]
    ds_read_b128 v[48:51], v3 offset:16384
    s_waitcnt vmcnt(1) lgkmcnt(6)
    v_mfma_f32_16x16x32_bf16 v[16:19], v[52:55], v[216:219], v[16:19]
    ds_read_b128 v[52:55], v3 offset:17408
    s_waitcnt lgkmcnt(6)
    v_mfma_f32_16x16x32_bf16 v[20:23], v[56:59], v[216:219], v[20:23]
    ds_read_b128 v[56:59], v3 offset:18432
    s_waitcnt lgkmcnt(6)
    v_mfma_f32_16x16x32_bf16 v[24:27], v[60:63], v[216:219], v[24:27]
    ds_read_b128 v[60:63], v3 offset:19456
    ds_write_b32 v255, v91 offset:16
    s_waitcnt lgkmcnt(7)
    v_mfma_f32_16x16x32_bf16 v[28:31], v[64:67], v[216:219], v[28:31]
    s_waitcnt lgkmcnt(6)
    v_mfma_f32_16x16x32_bf16 v[32:35], v[40:43], v[216:219], v[32:35]
    s_waitcnt vmcnt(0) lgkmcnt(5)
    v_mfma_f32_16x16x32_bf16 v[16:19], v[44:47], v[220:223], v[16:19]
    s_waitcnt lgkmcnt(4)
    v_mfma_f32_16x16x32_bf16 v[20:23], v[48:51], v[220:223], v[20:23]
    s_waitcnt lgkmcnt(3)
    v_mfma_f32_16x16x32_bf16 v[24:27], v[52:55], v[220:223], v[24:27]
    s_waitcnt lgkmcnt(2)
    v_mfma_f32_16x16x32_bf16 v[28:31], v[56:59], v[220:223], v[28:31]
    s_waitcnt lgkmcnt(1)
    v_mfma_f32_16x16x32_bf16 v[32:35], v[60:63], v[220:223], v[32:35]
    v_cvt_pk_bf16_f32 v132, v16, v17
    v_cvt_pk_bf16_f32 v133, v18, v19
    v_cvt_pk_bf16_f32 v134, v20, v21
    v_cvt_pk_bf16_f32 v135, v22, v23
    v_cvt_pk_bf16_f32 v136, v24, v25
    v_cvt_pk_bf16_f32 v137, v26, v27
    v_cvt_pk_bf16_f32 v138, v28, v29
    v_cvt_pk_bf16_f32 v139, v30, v31
    v_cvt_pk_bf16_f32 v140, v32, v33
    v_cvt_pk_bf16_f32 v141, v34, v35
    s_add_u32 s43, s41, 2621440
    s_add_u32 s44, s42, 2621440
    s_cmp_lg_u32 s24, 0
    s_cbranch_scc1 L_sf110
    buffer_store_dwordx4 v[132:135], v3, s[20:23], s43 offen
    buffer_store_dwordx4 v[136:139], v3, s[20:23], s43 offen offset:1024
    buffer_store_dwordx2 v[140:141], v3, s[20:23], s44 offen
L_se111:
    v_mov_b32 v36, 0
    v_mov_b32 v37, 0
    v_mov_b32 v38, 0x3f803f80
    v_dot2c_f32_bf16 v36, v132, v38
    v_dot2c_f32_bf16 v37, v132, v132
    v_dot2c_f32_bf16 v36, v133, v38
    v_dot2c_f32_bf16 v37, v133, v133
    v_dot2c_f32_bf16 v36, v134, v38
    v_dot2c_f32_bf16 v37, v134, v134
    v_dot2c_f32_bf16 v36, v135, v38
    v_dot2c_f32_bf16 v37, v135, v135
    v_dot2c_f32_bf16 v36, v136, v38
    v_dot2c_f32_bf16 v37, v136, v136
    v_dot2c_f32_bf16 v36, v137, v38
    v_dot2c_f32_bf16 v37, v137, v137
    v_dot2c_f32_bf16 v36, v138, v38
    v_dot2c_f32_bf16 v37, v138, v138
    v_dot2c_f32_bf16 v36, v139, v38
    v_dot2c_f32_bf16 v37, v139, v139
    v_dot2c_f32_bf16 v36, v140, v38
    v_dot2c_f32_bf16 v37, v140, v140
    v_dot2c_f32_bf16 v36, v141, v38
    v_dot2c_f32_bf16 v37, v141, v141
    s_waitcnt vmcnt(0)
    v_mov_b32 v4, 4
    s_mov_b64 exec, 1
    s_cmp_lg_u32 s24, 0
    s_cbranch_scc1 L_sf112
    buffer_store_dword v4, v2, s[20:23], s34 offen
L_se113:
    s_mov_b64 exec, -1
    buffer_load_dword v15, v14, s[20:23], s33 offen sc1
    v_mov_b32 v38, v36
    v_mov_b32 v39, v37
    s_nop 0
    v_permlane16_swap_b32 v36, v38
    v_permlane16_swap_b32 v37, v39
    v_add_f32 v36, v36, v38
    v_add_f32 v37, v37, v39
    v_mov_b32 v38, v36
    v_mov_b32 v39, v37
    s_nop 0
    v_permlane32_swap_b32 v36, v38
    v_permlane32_swap_b32 v37, v39
    v_add_f32 v36, v36, v38
    v_add_f32 v37, v37, v39
L_c3:
    v_lshlrev_b32 v112, 16, v132
    v_and_b32 v113, 0xffff0000, v132
    v_lshlrev_b32 v114, 16, v133
    v_and_b32 v115, 0xffff0000, v133
    v_lshlrev_b32 v116, 16, v134
    v_and_b32 v117, 0xffff0000, v134
    v_lshlrev_b32 v118, 16, v135
    v_and_b32 v119, 0xffff0000, v135
    v_lshlrev_b32 v120, 16, v136
    v_and_b32 v121, 0xffff0000, v136
    v_lshlrev_b32 v122, 16, v137
    v_and_b32 v123, 0xffff0000, v137
    v_lshlrev_b32 v124, 16, v138
    v_and_b32 v125, 0xffff0000, v138
    v_lshlrev_b32 v126, 16, v139
    v_and_b32 v127, 0xffff0000, v139
    v_lshlrev_b32 v128, 16, v140
    v_and_b32 v129, 0xffff0000, v140
    v_lshlrev_b32 v130, 16, v141
    v_and_b32 v131, 0xffff0000, v141
    v_pk_add_f32 v[92:93], v[92:93], v[112:113]
    v_pk_add_f32 v[94:95], v[94:95], v[114:115]
    v_pk_add_f32 v[96:97], v[96:97], v[116:117]
    v_pk_add_f32 v[98:99], v[98:99], v[118:119]
    v_pk_add_f32 v[100:101], v[100:101], v[120:121]
    v_pk_add_f32 v[102:103], v[102:103], v[122:123]
    v_pk_add_f32 v[104:105], v[104:105], v[124:125]
    v_pk_add_f32 v[106:107], v[106:107], v[126:127]
    v_pk_add_f32 v[108:109], v[108:109], v[128:129]
    v_pk_add_f32 v[110:111], v[110:111], v[130:131]
    s_waitcnt vmcnt(0)
    v_cmp_gt_u32 vcc, 4, v15
    s_cbranch_vccnz L_pl114
L_pd115:
    ds_read_b32 v90, v254
    s_add_u32 s4, s40, 2621440
    buffer_load_dwordx4 v[200:203], v3, s[20:23], s4 offen offset:0 sc1
    s_add_u32 s5, s12, 2621440
    buffer_load_dwordx4 v[204:207], v3, s[20:23], s5 offen offset:0 sc1
    buffer_load_dwordx4 v[208:211], v3, s[20:23], s4 offen offset:1024 sc1
    buffer_load_dwordx4 v[212:215], v3, s[20:23], s5 offen offset:1024 sc1
    buffer_load_dwordx4 v[216:219], v3, s[20:23], s4 offen offset:2048 sc1
    buffer_load_dwordx4 v[220:223], v3, s[20:23], s5 offen offset:2048 sc1
    buffer_load_dwordx4 v[224:227], v3, s[20:23], s4 offen offset:3072 sc1
    buffer_load_dwordx4 v[228:231], v3, s[20:23], s5 offen offset:3072 sc1
    s_add_u32 s4, s40, 2625536
    buffer_load_dwordx4 v[232:235], v3, s[20:23], s4 offen offset:0 sc1
    s_add_u32 s5, s12, 2625536
    buffer_load_dwordx4 v[236:239], v3, s[20:23], s5 offen offset:0 sc1
    s_add_u32 s44, s9, 1024
    s_mov_b64 exec, 0xffff
    s_cmp_lg_u32 s24, 0
    s_cbranch_scc1 L_sf117
    buffer_store_dwordx2 v[36:37], v3, s[20:23], s44 offen
L_se118:
    s_mov_b64 exec, -1
    v_mov_b32 v91, 16
    s_waitcnt lgkmcnt(0)
    v_cmp_gt_u32 vcc, 20, v90
    s_cbranch_vccnz L_ll119
L_ld120:
    ds_read_b128 v[64:67], v3 offset:20480
    ds_read_b128 v[40:43], v3 offset:21504
    ds_read_b128 v[44:47], v3 offset:22528
    ds_read_b128 v[48:51], v3 offset:23552
    ds_read_b128 v[52:55], v3 offset:24576
    s_waitcnt vmcnt(9) lgkmcnt(4)
    v_mfma_f32_16x16x32_bf16 v[144:147], v[64:67], v[200:203], 0
    buffer_load_dwordx4 v[240:243], v3, s[20:23], s4 offen offset:1024 sc1
    v_mfma_f32_16x16x32_bf16 v[172:175], v[64:67], v[204:207], 0
    ds_read_b128 v[56:59], v3 offset:25600
    s_waitcnt lgkmcnt(4)
    v_mfma_f32_16x16x32_bf16 v[148:151], v[40:43], v[200:203], 0
    v_mfma_f32_16x16x32_bf16 v[176:179], v[40:43], v[204:207], 0
    ds_read_b128 v[60:63], v3 offset:26624
    s_waitcnt lgkmcnt(4)
    v_mfma_f32_16x16x32_bf16 v[152:155], v[44:47], v[200:203], 0
    buffer_load_dwordx4 v[244:247], v3, s[20:23], s5 offen offset:1024 sc1
    v_mfma_f32_16x16x32_bf16 v[180:183], v[44:47], v[204:207], 0
    ds_read_b128 v[64:67], v3 offset:27648
    s_waitcnt lgkmcnt(4)
    v_mfma_f32_16x16x32_bf16 v[156:159], v[48:51], v[200:203], 0
    v_mfma_f32_16x16x32_bf16 v[184:187], v[48:51], v[204:207], 0
    ds_read_b128 v[40:43], v3 offset:28672
    s_waitcnt lgkmcnt(4)
    v_mfma_f32_16x16x32_bf16 v[160:163], v[52:55], v[200:203], 0
    v_mfma_f32_16x16x32_bf16 v[188:191], v[52:55], v[204:207], 0
    ds_read_b128 v[44:47], v3 offset:29696
    s_waitcnt lgkmcnt(4)
    v_mfma_f32_16x16x32_bf16 v[164:167], v[56:59], v[200:203], 0
    v_mfma_f32_16x16x32_bf16 v[192:195], v[56:59], v[204:207], 0
    ds_read_b128 v[48:51], v3 offset:30720
    s_waitcnt lgkmcnt(4)
    v_mfma_f32_16x16x32_bf16 v[168:171], v[60:63], v[200:203], 0
    v_mov_b32 v91, 16
    v_mfma_f32_16x16x32_bf16 v[196:199], v[60:63], v[204:207], 0
    ds_read_b128 v[52:55], v3 offset:31744
    s_waitcnt vmcnt(9) lgkmcnt(4)
    v_mfma_f32_16x16x32_bf16 v[144:147], v[64:67], v[208:211], v[144:147]
    buffer_load_dwordx4 v[200:203], v3, s[20:23], s4 offen offset:2048 sc1
    v_mfma_f32_16x16x32_bf16 v[172:175], v[64:67], v[212:215], v[172:175]
    ds_read_b128 v[56:59], v3 offset:32768
    s_waitcnt lgkmcnt(4)
    v_mfma_f32_16x16x32_bf16 v[148:151], v[40:43], v[208:211], v[148:151]
    v_mfma_f32_16x16x32_bf16 v[176:179], v[40:43], v[212:215], v[176:179]
    ds_read_b128 v[60:63], v3 offset:33792
    s_waitcnt lgkmcnt(4)
    v_mfma_f32_16x16x32_bf16 v[152:155], v[44:47], v[208:211], v[152:155]
    buffer_load_dwordx4 v[204:207], v3, s[20:23], s5 offen offset:2048 sc1
    v_mfma_f32_16x16x32_bf16 v[180:183], v[44:47], v[212:215], v[180:183]
    ds_read_b128 v[64:67], v3 offset:34816
    s_waitcnt lgkmcnt(4)
    v_mfma_f32_16x16x32_bf16 v[156:159], v[48:51], v[208:211], v[156:159]
    v_mfma_f32_16x16x32_bf16 v[184:187], v[48:51], v[212:215], v[184:187]
    ds_read_b128 v[40:43], v3 offset:35840
    s_waitcnt lgkmcnt(4)
    v_mfma_f32_16x16x32_bf16 v[160:163], v[52:55], v[208:211], v[160:163]
    v_mfma_f32_16x16x32_bf16 v[188:191], v[52:55], v[212:215], v[188:191]
    ds_read_b128 v[44:47], v3 offset:36864
    s_waitcnt lgkmcnt(4)
    v_mfma_f32_16x16x32_bf16 v[164:167], v[56:59], v[208:211], v[164:167]
    v_mfma_f32_16x16x32_bf16 v[192:195], v[56:59], v[212:215], v[192:195]
    ds_read_b128 v[48:51], v3 offset:37888
    s_waitcnt lgkmcnt(4)
    v_mfma_f32_16x16x32_bf16 v[168:171], v[60:63], v[208:211], v[168:171]
    v_mfma_f32_16x16x32_bf16 v[196:199], v[60:63], v[212:215], v[196:199]
    ds_read_b128 v[52:55], v3 offset:38912
    s_waitcnt vmcnt(9) lgkmcnt(4)
    v_mfma_f32_16x16x32_bf16 v[144:147], v[64:67], v[216:219], v[144:147]
    buffer_load_dwordx4 v[208:211], v3, s[20:23], s4 offen offset:3072 sc1
    v_mfma_f32_16x16x32_bf16 v[172:175], v[64:67], v[220:223], v[172:175]
    ds_read_b128 v[56:59], v3 offset:39936
    s_waitcnt lgkmcnt(4)
    v_mfma_f32_16x16x32_bf16 v[148:151], v[40:43], v[216:219], v[148:151]
    v_mfma_f32_16x16x32_bf16 v[176:179], v[40:43], v[220:223], v[176:179]
    ds_write_b32 v255, v91 offset:16
    ds_read_b128 v[60:63], v3 offset:40960
    s_waitcnt lgkmcnt(5)
    v_mfma_f32_16x16x32_bf16 v[152:155], v[44:47], v[216:219], v[152:155]
    buffer_load_dwordx4 v[212:215], v3, s[20:23], s5 offen offset:3072 sc1
    v_mfma_f32_16x16x32_bf16 v[180:183], v[44:47], v[220:223], v[180:183]
    ds_read_b128 v[64:67], v3 offset:41984
    s_waitcnt lgkmcnt(5)
    v_mfma_f32_16x16x32_bf16 v[156:159], v[48:51], v[216:219], v[156:159]
    v_mfma_f32_16x16x32_bf16 v[184:187], v[48:51], v[220:223], v[184:187]
    ds_read_b128 v[40:43], v3 offset:43008
    s_waitcnt lgkmcnt(5)
    v_mfma_f32_16x16x32_bf16 v[160:163], v[52:55], v[216:219], v[160:163]
    s_waitcnt vmcnt(6)
    v_mov_b32 v4, 5
    s_mov_b64 exec, 1
    s_cmp_lg_u32 s24, 0
    s_cbranch_scc1 L_sf122
    buffer_store_dword v4, v2, s[20:23], s34 offen
L_se123:
    s_mov_b64 exec, -1
    v_mfma_f32_16x16x32_bf16 v[188:191], v[52:55], v[220:223], v[188:191]
    ds_read_b128 v[44:47], v3 offset:44032
    s_waitcnt lgkmcnt(5)
    v_mfma_f32_16x16x32_bf16 v[164:167], v[56:59], v[216:219], v[164:167]
    v_mfma_f32_16x16x32_bf16 v[192:195], v[56:59], v[220:223], v[192:195]
    ds_read_b128 v[48:51], v3 offset:45056
    s_waitcnt lgkmcnt(4)
    v_mfma_f32_16x16x32_bf16 v[168:171], v[60:63], v[216:219], v[168:171]
    v_mfma_f32_16x16x32_bf16 v[196:199], v[60:63], v[220:223], v[196:199]
    ds_read_b128 v[52:55], v3 offset:46080
    s_waitcnt vmcnt(10) lgkmcnt(4)
    v_mfma_f32_16x16x32_bf16 v[144:147], v[64:67], v[224:227], v[144:147]
    s_add_u32 s4, s40, 2629632
    buffer_load_dwordx4 v[216:219], v3, s[20:23], s4 offen offset:0 sc1
    v_mfma_f32_16x16x32_bf16 v[172:175], v[64:67], v[228:231], v[172:175]
    ds_read_b128 v[56:59], v3 offset:47104
    s_waitcnt lgkmcnt(4)
    v_mfma_f32_16x16x32_bf16 v[148:151], v[40:43], v[224:227], v[148:151]
    v_mfma_f32_16x16x32_bf16 v[176:179], v[40:43], v[228:231], v[176:179]
    ds_read_b128 v[60:63], v3 offset:48128
    s_waitcnt lgkmcnt(4)
    v_mfma_f32_16x16x32_bf16 v[152:155], v[44:47], v[224:227], v[152:155]
    s_add_u32 s5, s12, 2629632
    buffer_load_dwordx4 v[220:223], v3, s[20:23], s5 offen offset:0 sc1
    v_mfma_f32_16x16x32_bf16 v[180:183], v[44:47], v[228:231], v[180:183]
    ds_read_b128 v[64:67], v3 offset:49152
    s_waitcnt lgkmcnt(4)
    v_mfma_f32_16x16x32_bf16 v[156:159], v[48:51], v[224:227], v[156:159]
    v_mfma_f32_16x16x32_bf16 v[184:187], v[48:51], v[228:231], v[184:187]
    ds_read_b128 v[40:43], v3 offset:50176
    s_waitcnt lgkmcnt(4)
    v_mfma_f32_16x16x32_bf16 v[160:163], v[52:55], v[224:227], v[160:163]
    v_mfma_f32_16x16x32_bf16 v[188:191], v[52:55], v[228:231], v[188:191]
    ds_read_b128 v[44:47], v3 offset:51200
    s_waitcnt lgkmcnt(4)
    v_mfma_f32_16x16x32_bf16 v[164:167], v[56:59], v[224:227], v[164:167]
    v_mov_b32 v91, 17
    v_mfma_f32_16x16x32_bf16 v[192:195], v[56:59], v[228:231], v[192:195]
    ds_read_b128 v[48:51], v3 offset:52224
    s_waitcnt lgkmcnt(4)
    v_mfma_f32_16x16x32_bf16 v[168:171], v[60:63], v[224:227], v[168:171]
    v_mfma_f32_16x16x32_bf16 v[196:199], v[60:63], v[228:231], v[196:199]
    ds_read_b128 v[52:55], v3 offset:53248
    s_waitcnt vmcnt(10) lgkmcnt(4)
    v_mfma_f32_16x16x32_bf16 v[144:147], v[64:67], v[232:235], v[144:147]
    buffer_load_dwordx4 v[224:227], v3, s[20:23], s4 offen offset:1024 sc1
    v_mfma_f32_16x16x32_bf16 v[172:175], v[64:67], v[236:239], v[172:175]
    ds_read_b128 v[56:59], v3 offset:54272
    s_waitcnt lgkmcnt(4)
    v_mfma_f32_16x16x32_bf16 v[148:151], v[40:43], v[232:235], v[148:151]
    v_mfma_f32_16x16x32_bf16 v[176:179], v[40:43], v[236:239], v[176:179]
    ds_read_b128 v[60:63], v3 offset:55296
    s_waitcnt lgkmcnt(4)
    v_mfma_f32_16x16x32_bf16 v[152:155], v[44:47], v[232:235], v[152:155]
    buffer_load_dwordx4 v[228:231], v3, s[20:23], s5 offen offset:1024 sc1
    v_mfma_f32_16x16x32_bf16 v[180:183], v[44:47], v[236:239], v[180:183]
    ds_read_b128 v[64:67], v3 offset:56320
    s_waitcnt lgkmcnt(4)
    v_mfma_f32_16x16x32_bf16 v[156:159], v[48:51], v[232:235], v[156:159]
    v_mfma_f32_16x16x32_bf16 v[184:187], v[48:51], v[236:239], v[184:187]
    ds_read_b128 v[40:43], v3 offset:57344
    s_waitcnt lgkmcnt(4)
    v_mfma_f32_16x16x32_bf16 v[160:163], v[52:55], v[232:235], v[160:163]
    v_mfma_f32_16x16x32_bf16 v[188:191], v[52:55], v[236:239], v[188:191]
    ds_read_b128 v[44:47], v3 offset:58368
    s_waitcnt lgkmcnt(4)
    v_mfma_f32_16x16x32_bf16 v[164:167], v[56:59], v[232:235], v[164:167]
    v_mfma_f32_16x16x32_bf16 v[192:195], v[56:59], v[236:239], v[192:195]
    ds_read_b128 v[48:51], v3 offset:59392
    s_waitcnt lgkmcnt(4)
    v_mfma_f32_16x16x32_bf16 v[168:171], v[60:63], v[232:235], v[168:171]
    v_mfma_f32_16x16x32_bf16 v[196:199], v[60:63], v[236:239], v[196:199]
    ds_read_b128 v[52:55], v3 offset:60416
    s_waitcnt vmcnt(9) lgkmcnt(4)
    v_mfma_f32_16x16x32_bf16 v[144:147], v[64:67], v[240:243], v[144:147]
    buffer_load_dwordx4 v[232:235], v3, s[20:23], s4 offen offset:2048 sc1
    v_mfma_f32_16x16x32_bf16 v[172:175], v[64:67], v[244:247], v[172:175]
    ds_write_b32 v255, v91 offset:16
    ds_read_b128 v[56:59], v3 offset:61440
    s_waitcnt lgkmcnt(5)
    v_mfma_f32_16x16x32_bf16 v[148:151], v[40:43], v[240:243], v[148:151]
    v_mfma_f32_16x16x32_bf16 v[176:179], v[40:43], v[244:247], v[176:179]
    ds_read_b128 v[60:63], v3 offset:62464
    s_waitcnt lgkmcnt(5)
    v_mfma_f32_16x16x32_bf16 v[152:155], v[44:47], v[240:243], v[152:155]
    buffer_load_dwordx4 v[236:239], v3, s[20:23], s5 offen offset:2048 sc1
    v_mfma_f32_16x16x32_bf16 v[180:183], v[44:47], v[244:247], v[180:183]
    ds_read_b128 v[64:67], v3 offset:63488
    s_waitcnt lgkmcnt(5)
    v_mfma_f32_16x16x32_bf16 v[156:159], v[48:51], v[240:243], v[156:159]
    v_mfma_f32_16x16x32_bf16 v[184:187], v[48:51], v[244:247], v[184:187]
    ds_read_b128 v[40:43], v3 offset:64512
    s_waitcnt lgkmcnt(5)
    v_mfma_f32_16x16x32_bf16 v[160:163], v[52:55], v[240:243], v[160:163]
    v_mfma_f32_16x16x32_bf16 v[188:191], v[52:55], v[244:247], v[188:191]
    ds_read_b128 v[44:47], v8 offset:0
    s_waitcnt lgkmcnt(4)
    v_mfma_f32_16x16x32_bf16 v[164:167], v[56:59], v[240:243], v[164:167]
    v_mfma_f32_16x16x32_bf16 v[192:195], v[56:59], v[244:247], v[192:195]
    ds_read_b128 v[48:51], v8 offset:1024
    s_waitcnt lgkmcnt(4)
    v_mfma_f32_16x16x32_bf16 v[168:171], v[60:63], v[240:243], v[168:171]
    v_mfma_f32_16x16x32_bf16 v[196:199], v[60:63], v[244:247], v[196:199]
    ds_read_b128 v[52:55], v8 offset:2048
    s_waitcnt vmcnt(9) lgkmcnt(4)
    v_mfma_f32_16x16x32_bf16 v[144:147], v[64:67], v[200:203], v[144:147]
    buffer_load_dwordx4 v[240:243], v3, s[20:23], s4 offen offset:3072 sc1
    v_mfma_f32_16x16x32_bf16 v[172:175], v[64:67], v[204:207], v[172:175]
    ds_read_b128 v[56:59], v8 offset:3072
    s_waitcnt lgkmcnt(4)
    v_mfma_f32_16x16x32_bf16 v[148:151], v[40:43], v[200:203], v[148:151]
    v_mfma_f32_16x16x32_bf16 v[176:179], v[40:43], v[204:207], v[176:179]
    ds_read_b128 v[60:63], v8 offset:4096
    s_waitcnt lgkmcnt(4)
    v_mfma_f32_16x16x32_bf16 v[152:155], v[44:47], v[200:203], v[152:155]
    buffer_load_dwordx4 v[244:247], v3, s[20:23], s5 offen offset:3072 sc1
    v_mfma_f32_16x16x32_bf16 v[180:183], v[44:47], v[204:207], v[180:183]
    ds_read_b128 v[64:67], v8 offset:5120
    s_waitcnt lgkmcnt(4)
    v_mfma_f32_16x16x32_bf16 v[156:159], v[48:51], v[200:203], v[156:159]
    v_mfma_f32_16x16x32_bf16 v[184:187], v[48:51], v[204:207], v[184:187]
    ds_read_b128 v[40:43], v8 offset:6144
    s_waitcnt lgkmcnt(4)
    v_mfma_f32_16x16x32_bf16 v[160:163], v[52:55], v[200:203], v[160:163]
    v_mov_b32 v91, 18
    buffer_load_dword v15, v14, s[20:23], s33 offen sc1
    v_mfma_f32_16x16x32_bf16 v[188:191], v[52:55], v[204:207], v[188:191]
    ds_read_b128 v[44:47], v8 offset:7168
    s_waitcnt lgkmcnt(4)
    v_mfma_f32_16x16x32_bf16 v[164:167], v[56:59], v[200:203], v[164:167]
    v_mfma_f32_16x16x32_bf16 v[192:195], v[56:59], v[204:207], v[192:195]
    ds_read_b128 v[48:51], v8 offset:8192
    s_waitcnt lgkmcnt(4)
    v_mfma_f32_16x16x32_bf16 v[168:171], v[60:63], v[200:203], v[168:171]
    v_mfma_f32_16x16x32_bf16 v[196:199], v[60:63], v[204:207], v[196:199]
    ds_read_b128 v[52:55], v8 offset:9216
    s_waitcnt vmcnt(10) lgkmcnt(4)
    v_mfma_f32_16x16x32_bf16 v[144:147], v[64:67], v[208:211], v[144:147]
    s_add_u32 s4, s40, 2633728
    buffer_load_dwordx4 v[200:203], v3, s[20:23], s4 offen offset:0 sc1
    v_mfma_f32_16x16x32_bf16 v[172:175], v[64:67], v[212:215], v[172:175]
    ds_read_b128 v[56:59], v8 offset:10240
    s_waitcnt lgkmcnt(4)
    v_mfma_f32_16x16x32_bf16 v[148:151], v[40:43], v[208:211], v[148:151]
    v_mfma_f32_16x16x32_bf16 v[176:179], v[40:43], v[212:215], v[176:179]
    ds_read_b128 v[60:63], v8 offset:11264
    s_waitcnt lgkmcnt(4)
    v_mfma_f32_16x16x32_bf16 v[152:155], v[44:47], v[208:211], v[152:155]
    s_add_u32 s5, s12, 2633728
    buffer_load_dwordx4 v[204:207], v3, s[20:23], s5 offen offset:0 sc1
    v_mfma_f32_16x16x32_bf16 v[180:183], v[44:47], v[212:215], v[180:183]
    ds_read_b128 v[64:67], v8 offset:12288
    s_waitcnt lgkmcnt(4)
    v_mfma_f32_16x16x32_bf16 v[156:159], v[48:51], v[208:211], v[156:159]
    v_mfma_f32_16x16x32_bf16 v[184:187], v[48:51], v[212:215], v[184:187]
    ds_read_b128 v[40:43], v8 offset:13312
    s_waitcnt lgkmcnt(4)
    v_mfma_f32_16x16x32_bf16 v[160:163], v[52:55], v[208:211], v[160:163]
    v_mfma_f32_16x16x32_bf16 v[188:191], v[52:55], v[212:215], v[188:191]
    ds_read_b128 v[44:47], v8 offset:14336
    s_waitcnt lgkmcnt(4)
    v_mfma_f32_16x16x32_bf16 v[164:167], v[56:59], v[208:211], v[164:167]
    v_mfma_f32_16x16x32_bf16 v[192:195], v[56:59], v[212:215], v[192:195]
    ds_read_b128 v[48:51], v8 offset:15360
    s_waitcnt lgkmcnt(4)
    v_mfma_f32_16x16x32_bf16 v[168:171], v[60:63], v[208:211], v[168:171]
    v_mfma_f32_16x16x32_bf16 v[196:199], v[60:63], v[212:215], v[196:199]
    ds_write_b32 v255, v91 offset:16
    ds_read_b128 v[52:55], v8 offset:16384
    s_waitcnt vmcnt(9) lgkmcnt(5)
    v_mfma_f32_16x16x32_bf16 v[144:147], v[64:67], v[216:219], v[144:147]
    buffer_load_dwordx4 v[208:211], v3, s[20:23], s4 offen offset:1024 sc1
    v_mfma_f32_16x16x32_bf16 v[172:175], v[64:67], v[220:223], v[172:175]
    ds_read_b128 v[56:59], v8 offset:17408
    s_waitcnt lgkmcnt(5)
    v_mfma_f32_16x16x32_bf16 v[148:151], v[40:43], v[216:219], v[148:151]
    v_mfma_f32_16x16x32_bf16 v[176:179], v[40:43], v[220:223], v[176:179]
    ds_read_b128 v[60:63], v8 offset:18432
    s_waitcnt lgkmcnt(5)
    v_mfma_f32_16x16x32_bf16 v[152:155], v[44:47], v[216:219], v[152:155]
    buffer_load_dwordx4 v[212:215], v3, s[20:23], s5 offen offset:1024 sc1
    v_mfma_f32_16x16x32_bf16 v[180:183], v[44:47], v[220:223], v[180:183]
    ds_read_b128 v[64:67], v8 offset:19456
    s_waitcnt lgkmcnt(5)
    v_mfma_f32_16x16x32_bf16 v[156:159], v[48:51], v[216:219], v[156:159]
    v_mfma_f32_16x16x32_bf16 v[184:187], v[48:51], v[220:223], v[184:187]
    ds_read_b128 v[40:43], v8 offset:20480
    s_waitcnt lgkmcnt(4)
    v_mfma_f32_16x16x32_bf16 v[160:163], v[52:55], v[216:219], v[160:163]
    v_mfma_f32_16x16x32_bf16 v[188:191], v[52:55], v[220:223], v[188:191]
    ds_read_b128 v[44:47], v8 offset:21504
    s_waitcnt lgkmcnt(4)
    v_mfma_f32_16x16x32_bf16 v[164:167], v[56:59], v[216:219], v[164:167]
    v_mfma_f32_16x16x32_bf16 v[192:195], v[56:59], v[220:223], v[192:195]
    ds_read_b128 v[48:51], v8 offset:22528
    s_waitcnt lgkmcnt(4)
    v_mfma_f32_16x16x32_bf16 v[168:171], v[60:63], v[216:219], v[168:171]
    v_mfma_f32_16x16x32_bf16 v[196:199], v[60:63], v[220:223], v[196:199]
    ds_read_b128 v[52:55], v8 offset:23552
    s_waitcnt vmcnt(9) lgkmcnt(4)
    v_mfma_f32_16x16x32_bf16 v[144:147], v[64:67], v[224:227], v[144:147]
    buffer_load_dwordx4 v[216:219], v3, s[20:23], s4 offen offset:2048 sc1
    v_mfma_f32_16x16x32_bf16 v[172:175], v[64:67], v[228:231], v[172:175]
    ds_read_b128 v[56:59], v8 offset:24576
    s_waitcnt lgkmcnt(4)
    v_mfma_f32_16x16x32_bf16 v[148:151], v[40:43], v[224:227], v[148:151]
    v_mfma_f32_16x16x32_bf16 v[176:179], v[40:43], v[228:231], v[176:179]
    ds_read_b128 v[60:63], v8 offset:25600
    s_waitcnt lgkmcnt(4)
    v_mfma_f32_16x16x32_bf16 v[152:155], v[44:47], v[224:227], v[152:155]
    buffer_load_dwordx4 v[220:223], v3, s[20:23], s5 offen offset:2048 sc1
    v_mfma_f32_16x16x32_bf16 v[180:183], v[44:47], v[228:231], v[180:183]
    ds_read_b128 v[64:67], v8 offset:26624
    s_waitcnt lgkmcnt(4)
    v_mfma_f32_16x16x32_bf16 v[156:159], v[48:51], v[224:227], v[156:159]
    v_mov_b32 v91, 19
    v_mfma_f32_16x16x32_bf16 v[184:187], v[48:51], v[228:231], v[184:187]
    ds_read_b128 v[40:43], v8 offset:27648
    s_waitcnt lgkmcnt(4)
    v_mfma_f32_16x16x32_bf16 v[160:163], v[52:55], v[224:227], v[160:163]
    s_waitcnt vmcnt(6)
    v_cmp_gt_u32 vcc, 5, v15
    s_cbranch_vccnz L_pl124
L_pd125:
    v_mfma_f32_16x16x32_bf16 v[188:191], v[52:55], v[228:231], v[188:191]
    ds_read_b128 v[44:47], v8 offset:28672
    s_waitcnt lgkmcnt(4)
    v_mfma_f32_16x16x32_bf16 v[164:167], v[56:59], v[224:227], v[164:167]
    s_add_u32 s44, s46, 1024
    s_xor_b32 s44, s44, 0
    buffer_load_dwordx4 v[16:19], v3, s[20:23], s44 offen sc1
    v_mfma_f32_16x16x32_bf16 v[192:195], v[56:59], v[228:231], v[192:195]
    ds_read_b128 v[48:51], v8 offset:29696
    s_waitcnt lgkmcnt(4)
    v_mfma_f32_16x16x32_bf16 v[168:171], v[60:63], v[224:227], v[168:171]
    s_add_u32 s44, s46, 1024
    s_xor_b32 s44, s44, 8192
    buffer_load_dwordx4 v[20:23], v3, s[20:23], s44 offen sc1
    v_mfma_f32_16x16x32_bf16 v[196:199], v[60:63], v[228:231], v[196:199]
    ds_read_b128 v[52:55], v8 offset:30720
    s_waitcnt vmcnt(11) lgkmcnt(4)
    v_mfma_f32_16x16x32_bf16 v[144:147], v[64:67], v[232:235], v[144:147]
    buffer_load_dwordx4 v[224:227], v3, s[20:23], s4 offen offset:3072 sc1
    v_mfma_f32_16x16x32_bf16 v[172:175], v[64:67], v[236:239], v[172:175]
    ds_read_b128 v[56:59], v8 offset:31744
    s_waitcnt lgkmcnt(4)
    v_mfma_f32_16x16x32_bf16 v[148:151], v[40:43], v[232:235], v[148:151]
    v_mfma_f32_16x16x32_bf16 v[176:179], v[40:43], v[236:239], v[176:179]
    ds_read_b128 v[60:63], v8 offset:32768
    s_waitcnt lgkmcnt(4)
    v_mfma_f32_16x16x32_bf16 v[152:155], v[44:47], v[232:235], v[152:155]
    buffer_load_dwordx4 v[228:231], v3, s[20:23], s5 offen offset:3072 sc1
    v_mfma_f32_16x16x32_bf16 v[180:183], v[44:47], v[236:239], v[180:183]
    ds_read_b128 v[64:67], v8 offset:33792
    s_waitcnt lgkmcnt(4)
    v_mfma_f32_16x16x32_bf16 v[156:159], v[48:51], v[232:235], v[156:159]
    v_mfma_f32_16x16x32_bf16 v[184:187], v[48:51], v[236:239], v[184:187]
    ds_read_b128 v[40:43], v8 offset:34816
    s_waitcnt lgkmcnt(4)
    v_mfma_f32_16x16x32_bf16 v[160:163], v[52:55], v[232:235], v[160:163]
    v_mfma_f32_16x16x32_bf16 v[188:191], v[52:55], v[236:239], v[188:191]
    ds_read_b128 v[44:47], v8 offset:35840
    s_waitcnt lgkmcnt(4)
    v_mfma_f32_16x16x32_bf16 v[164:167], v[56:59], v[232:235], v[164:167]
    v_mfma_f32_16x16x32_bf16 v[192:195], v[56:59], v[236:239], v[192:195]
    ds_write_b32 v255, v91 offset:16
    ds_read_b128 v[48:51], v8 offset:36864
    s_waitcnt lgkmcnt(5)
    v_mfma_f32_16x16x32_bf16 v[168:171], v[60:63], v[232:235], v[168:171]
    v_mfma_f32_16x16x32_bf16 v[196:199], v[60:63], v[236:239], v[196:199]
    ds_read_b128 v[52:55], v8 offset:37888
    s_waitcnt vmcnt(11) lgkmcnt(5)
    v_mfma_f32_16x16x32_bf16 v[144:147], v[64:67], v[240:243], v[144:147]
    s_add_u32 s4, s40, 2637824
    buffer_load_dwordx4 v[232:235], v3, s[20:23], s4 offen offset:0 sc1
    v_mfma_f32_16x16x32_bf16 v[172:175], v[64:67], v[244:247], v[172:175]
    ds_read_b128 v[56:59], v8 offset:38912
    s_waitcnt lgkmcnt(5)
    v_mfma_f32_16x16x32_bf16 v[148:151], v[40:43], v[240:243], v[148:151]
    v_mfma_f32_16x16x32_bf16 v[176:179], v[40:43], v[244:247], v[176:179]
    ds_read_b128 v[60:63], v8 offset:39936
    s_waitcnt lgkmcnt(5)
    v_mfma_f32_16x16x32_bf16 v[152:155], v[44:47], v[240:243], v[152:155]
    s_add_u32 s5, s12, 2637824
    buffer_load_dwordx4 v[236:239], v3, s[20:23], s5 offen offset:0 sc1
    v_mfma_f32_16x16x32_bf16 v[180:183], v[44:47], v[244:247], v[180:183]
    ds_read_b128 v[64:67], v8 offset:40960
    s_waitcnt lgkmcnt(4)
    v_mfma_f32_16x16x32_bf16 v[156:159], v[48:51], v[240:243], v[156:159]
    v_mfma_f32_16x16x32_bf16 v[184:187], v[48:51], v[244:247], v[184:187]
    ds_read_b128 v[40:43], v8 offset:41984
    s_waitcnt lgkmcnt(4)
    v_mfma_f32_16x16x32_bf16 v[160:163], v[52:55], v[240:243], v[160:163]
    v_mfma_f32_16x16x32_bf16 v[188:191], v[52:55], v[244:247], v[188:191]
    ds_read_b128 v[44:47], v8 offset:43008
    s_waitcnt lgkmcnt(4)
    v_mfma_f32_16x16x32_bf16 v[164:167], v[56:59], v[240:243], v[164:167]
    v_mfma_f32_16x16x32_bf16 v[192:195], v[56:59], v[244:247], v[192:195]
    ds_read_b128 v[48:51], v8 offset:44032
    s_waitcnt lgkmcnt(4)
    v_mfma_f32_16x16x32_bf16 v[168:171], v[60:63], v[240:243], v[168:171]
    v_mfma_f32_16x16x32_bf16 v[196:199], v[60:63], v[244:247], v[196:199]
    ds_read_b128 v[52:55], v8 offset:45056
    s_waitcnt vmcnt(10) lgkmcnt(4)
    v_mfma_f32_16x16x32_bf16 v[144:147], v[64:67], v[200:203], v[144:147]
    buffer_load_dwordx4 v[240:243], v3, s[20:23], s4 offen offset:1024 sc1
    v_mfma_f32_16x16x32_bf16 v[172:175], v[64:67], v[204:207], v[172:175]
    ds_read_b128 v[56:59], v8 offset:46080
    s_waitcnt lgkmcnt(4)
    v_mfma_f32_16x16x32_bf16 v[148:151], v[40:43], v[200:203], v[148:151]
    v_mfma_f32_16x16x32_bf16 v[176:179], v[40:43], v[204:207], v[176:179]
    ds_read_b128 v[60:63], v8 offset:47104
    s_waitcnt lgkmcnt(4)
    v_mfma_f32_16x16x32_bf16 v[152:155], v[44:47], v[200:203], v[152:155]
    v_mov_b32 v91, 20
    buffer_load_dwordx4 v[244:247], v3, s[20:23], s5 offen offset:1024 sc1
    v_mfma_f32_16x16x32_bf16 v[180:183], v[44:47], v[204:207], v[180:183]
    ds_read_b128 v[64:67], v8 offset:48128
    s_waitcnt lgkmcnt(4)
    v_mfma_f32_16x16x32_bf16 v[156:159], v[48:51], v[200:203], v[156:159]
    v_mfma_f32_16x16x32_bf16 v[184:187], v[48:51], v[204:207], v[184:187]
    ds_read_b128 v[40:43], v8 offset:49152
    s_waitcnt lgkmcnt(4)
    v_mfma_f32_16x16x32_bf16 v[160:163], v[52:55], v[200:203], v[160:163]
    v_mfma_f32_16x16x32_bf16 v[188:191], v[52:55], v[204:207], v[188:191]
    ds_read_b128 v[44:47], v8 offset:50176
    s_waitcnt lgkmcnt(4)
    v_mfma_f32_16x16x32_bf16 v[164:167], v[56:59], v[200:203], v[164:167]
    v_mfma_f32_16x16x32_bf16 v[192:195], v[56:59], v[204:207], v[192:195]
    ds_read_b32 v90, v254
    ds_read_b128 v[48:51], v8 offset:51200
    s_waitcnt lgkmcnt(5)
    v_mfma_f32_16x16x32_bf16 v[168:171], v[60:63], v[200:203], v[168:171]
    v_mfma_f32_16x16x32_bf16 v[196:199], v[60:63], v[204:207], v[196:199]
    ds_read_b128 v[52:55], v8 offset:52224
    s_waitcnt vmcnt(10) lgkmcnt(5)
    v_mfma_f32_16x16x32_bf16 v[144:147], v[64:67], v[208:211], v[144:147]
    buffer_load_dwordx4 v[200:203], v3, s[20:23], s4 offen offset:2048 sc1
    v_mfma_f32_16x16x32_bf16 v[172:175], v[64:67], v[212:215], v[172:175]
    ds_read_b128 v[56:59], v8 offset:53248
    s_waitcnt lgkmcnt(5)
    v_mfma_f32_16x16x32_bf16 v[148:151], v[40:43], v[208:211], v[148:151]
    v_mfma_f32_16x16x32_bf16 v[176:179], v[40:43], v[212:215], v[176:179]
    ds_read_b128 v[60:63], v8 offset:54272
    s_waitcnt lgkmcnt(5)
    v_mfma_f32_16x16x32_bf16 v[152:155], v[44:47], v[208:211], v[152:155]
    buffer_load_dwordx4 v[204:207], v3, s[20:23], s5 offen offset:2048 sc1
    v_mfma_f32_16x16x32_bf16 v[180:183], v[44:47], v[212:215], v[180:183]
    ds_read_b128 v[64:67], v8 offset:55296
    s_waitcnt lgkmcnt(4)
    v_mfma_f32_16x16x32_bf16 v[156:159], v[48:51], v[208:211], v[156:159]
    v_mfma_f32_16x16x32_bf16 v[184:187], v[48:51], v[212:215], v[184:187]
    ds_read_b128 v[40:43], v8 offset:56320
    s_waitcnt lgkmcnt(4)
    v_mfma_f32_16x16x32_bf16 v[160:163], v[52:55], v[208:211], v[160:163]
    v_mfma_f32_16x16x32_bf16 v[188:191], v[52:55], v[212:215], v[188:191]
    ds_write_b32 v255, v91 offset:16
    s_waitcnt lgkmcnt(7)
    v_cmp_gt_u32 vcc, 21, v90
    s_cbranch_vccnz L_ll127
L_ld128:
    ds_read_b128 v[44:47], v8 offset:57344
    s_waitcnt lgkmcnt(5)
    v_mfma_f32_16x16x32_bf16 v[164:167], v[56:59], v[208:211], v[164:167]
    v_mfma_f32_16x16x32_bf16 v[192:195], v[56:59], v[212:215], v[192:195]
    ds_read_b128 v[48:51], v8 offset:58368
    s_waitcnt lgkmcnt(5)
    v_mfma_f32_16x16x32_bf16 v[168:171], v[60:63], v[208:211], v[168:171]
    s_waitcnt vmcnt(8)
    v_mfma_f32_16x16x32_bf16 v[196:199], v[60:63], v[212:215], v[196:199]
    ds_read_b128 v[52:55], v8 offset:59392
    s_waitcnt vmcnt(10) lgkmcnt(5)
    v_mfma_f32_16x16x32_bf16 v[144:147], v[64:67], v[216:219], v[144:147]
    buffer_load_dwordx4 v[208:211], v3, s[20:23], s4 offen offset:3072 sc1
    v_add_f32 v16, v16, v18
    v_add_f32 v20, v20, v22
    v_mfma_f32_16x16x32_bf16 v[172:175], v[64:67], v[220:223], v[172:175]
    ds_read_b128 v[56:59], v8 offset:60416
    s_waitcnt lgkmcnt(5)
    v_mfma_f32_16x16x32_bf16 v[148:151], v[40:43], v[216:219], v[148:151]
    v_add_f32 v17, v17, v19
    v_add_f32 v21, v21, v23
    v_mfma_f32_16x16x32_bf16 v[176:179], v[40:43], v[220:223], v[176:179]
    ds_read_b128 v[60:63], v8 offset:61440
    s_waitcnt lgkmcnt(4)
    v_mfma_f32_16x16x32_bf16 v[152:155], v[44:47], v[216:219], v[152:155]
    buffer_load_dwordx4 v[212:215], v3, s[20:23], s5 offen offset:3072 sc1
    v_mov_b32 v18, v16
    v_mov_b32 v22, v20
    v_mfma_f32_16x16x32_bf16 v[180:183], v[44:47], v[220:223], v[180:183]
    ds_read_b128 v[64:67], v8 offset:62464
    s_waitcnt lgkmcnt(4)
    v_mfma_f32_16x16x32_bf16 v[156:159], v[48:51], v[216:219], v[156:159]
    v_mov_b32 v19, v17
    v_mov_b32 v23, v21
    v_mfma_f32_16x16x32_bf16 v[184:187], v[48:51], v[220:223], v[184:187]
    ds_read_b128 v[40:43], v8 offset:63488
    s_waitcnt lgkmcnt(4)
    v_mfma_f32_16x16x32_bf16 v[160:163], v[52:55], v[216:219], v[160:163]
    v_permlane16_swap_b32 v16, v18
    v_permlane16_swap_b32 v20, v22
    v_mfma_f32_16x16x32_bf16 v[188:191], v[52:55], v[220:223], v[188:191]
    ds_read_b128 v[44:47], v8 offset:64512
    s_waitcnt lgkmcnt(4)
    v_mfma_f32_16x16x32_bf16 v[164:167], v[56:59], v[216:219], v[164:167]
    v_permlane16_swap_b32 v17, v19
    v_permlane16_swap_b32 v21, v23
    v_mfma_f32_16x16x32_bf16 v[192:195], v[56:59], v[220:223], v[192:195]
    ds_read_b128 v[48:51], v9 offset:0
    s_waitcnt lgkmcnt(4)
    v_mfma_f32_16x16x32_bf16 v[168:171], v[60:63], v[216:219], v[168:171]
    v_add_f32 v16, v16, v18
    v_add_f32 v20, v20, v22
    v_mfma_f32_16x16x32_bf16 v[196:199], v[60:63], v[220:223], v[196:199]
    ds_read_b128 v[52:55], v9 offset:1024
    s_waitcnt vmcnt(8) lgkmcnt(4)
    v_mfma_f32_16x16x32_bf16 v[144:147], v[64:67], v[224:227], v[144:147]
    v_add_f32 v17, v17, v19
    v_add_f32 v21, v21, v23
    v_mfma_f32_16x16x32_bf16 v[172:175], v[64:67], v[228:231], v[172:175]
    ds_read_b128 v[56:59], v9 offset:2048
    s_waitcnt lgkmcnt(4)
    v_mfma_f32_16x16x32_bf16 v[148:151], v[40:43], v[224:227], v[148:151]
    v_mov_b32 v91, 21
    v_mov_b32 v18, v16
    v_mov_b32 v22, v20
    v_mfma_f32_16x16x32_bf16 v[176:179], v[40:43], v[228:231], v[176:179]
    ds_read_b128 v[60:63], v9 offset:3072
    s_waitcnt lgkmcnt(4)
    v_mfma_f32_16x16x32_bf16 v[152:155], v[44:47], v[224:227], v[152:155]
    v_mov_b32 v19, v17
    v_mov_b32 v23, v21
    v_mfma_f32_16x16x32_bf16 v[180:183], v[44:47], v[228:231], v[180:183]
    ds_read_b128 v[64:67], v9 offset:4096
    s_waitcnt lgkmcnt(4)
    v_mfma_f32_16x16x32_bf16 v[156:159], v[48:51], v[224:227], v[156:159]
    v_permlane32_swap_b32 v16, v18
    v_permlane32_swap_b32 v20, v22
    v_mfma_f32_16x16x32_bf16 v[184:187], v[48:51], v[228:231], v[184:187]
    ds_read_b128 v[40:43], v9 offset:5120
    s_waitcnt lgkmcnt(4)
    v_mfma_f32_16x16x32_bf16 v[160:163], v[52:55], v[224:227], v[160:163]
    v_permlane32_swap_b32 v17, v19
    v_permlane32_swap_b32 v21, v23
    v_mfma_f32_16x16x32_bf16 v[188:191], v[52:55], v[228:231], v[188:191]
    ds_read_b32 v90, v254
    ds_read_b128 v[44:47], v9 offset:6144
    s_waitcnt lgkmcnt(5)
    v_mfma_f32_16x16x32_bf16 v[164:167], v[56:59], v[224:227], v[164:167]
    v_add_f32 v16, v16, v18
    v_add_f32 v20, v20, v22
    v_mfma_f32_16x16x32_bf16 v[192:195], v[56:59], v[228:231], v[192:195]
    ds_read_b128 v[48:51], v9 offset:7168
    s_waitcnt lgkmcnt(5)
    v_mfma_f32_16x16x32_bf16 v[168:171], v[60:63], v[224:227], v[168:171]
    v_add_f32 v17, v17, v19
    v_add_f32 v21, v21, v23
    v_mfma_f32_16x16x32_bf16 v[196:199], v[60:63], v[228:231], v[196:199]
    ds_read_b128 v[52:55], v9 offset:8192
    s_waitcnt vmcnt(6) lgkmcnt(5)
    v_mfma_f32_16x16x32_bf16 v[144:147], v[64:67], v[232:235], v[144:147]
    v_mul_f32 v16, 0x3acccccd, v16
    v_mul_f32 v20, 0x3acccccd, v20
    v_mfma_f32_16x16x32_bf16 v[172:175], v[64:67], v[236:239], v[172:175]
    ds_read_b128 v[56:59], v9 offset:9216
    s_waitcnt lgkmcnt(5)
    v_mfma_f32_16x16x32_bf16 v[148:151], v[40:43], v[232:235], v[148:151]
    v_mul_f32 v17, 0x3acccccd, v17
    v_mul_f32 v21, 0x3acccccd, v21
    v_mfma_f32_16x16x32_bf16 v[176:179], v[40:43], v[236:239], v[176:179]
    ds_read_b128 v[60:63], v9 offset:10240
    s_waitcnt lgkmcnt(4)
    v_mfma_f32_16x16x32_bf16 v[152:155], v[44:47], v[232:235], v[152:155]
    v_fma_f32 v17, -v16, v16, v17
    v_fma_f32 v21, -v20, v20, v21
    v_mfma_f32_16x16x32_bf16 v[180:183], v[44:47], v[236:239], v[180:183]
    ds_read_b128 v[64:67], v9 offset:11264
    s_waitcnt lgkmcnt(4)
    v_mfma_f32_16x16x32_bf16 v[156:159], v[48:51], v[232:235], v[156:159]
    v_max_f32 v17, 0, v17
    v_max_f32 v21, 0, v21
    v_mfma_f32_16x16x32_bf16 v[184:187], v[48:51], v[236:239], v[184:187]
    ds_write_b32 v255, v91 offset:16
    s_waitcnt lgkmcnt(7)
    v_cmp_gt_u32 vcc, 22, v90
    s_cbranch_vccnz L_ll130
L_ld131:
    ds_read_b128 v[40:43], v3 offset:0
    s_waitcnt lgkmcnt(5)
    v_mfma_f32_16x16x32_bf16 v[160:163], v[52:55], v[232:235], v[160:163]
    v_add_f32 v18, 0x3727c5ac, v17
    v_add_f32 v22, 0x3727c5ac, v21
    v_mfma_f32_16x16x32_bf16 v[188:191], v[52:55], v[236:239], v[188:191]
    ds_read_b128 v[44:47], v3 offset:1024
    s_waitcnt lgkmcnt(5)
    v_mfma_f32_16x16x32_bf16 v[164:167], v[56:59], v[232:235], v[164:167]
    v_rsq_f32 v18, v18
    v_rsq_f32 v22, v22
    v_mfma_f32_16x16x32_bf16 v[192:195], v[56:59], v[236:239], v[192:195]
    ds_read_b128 v[48:51], v3 offset:2048
    s_waitcnt lgkmcnt(5)
    v_mfma_f32_16x16x32_bf16 v[168:171], v[60:63], v[232:235], v[168:171]
    v_rcp_f32 v79, v18
    v_rcp_f32 v71, v22
    v_mfma_f32_16x16x32_bf16 v[196:199], v[60:63], v[236:239], v[196:199]
    ds_read_b128 v[52:55], v3 offset:3072
    s_waitcnt vmcnt(4) lgkmcnt(5)
    v_mfma_f32_16x16x32_bf16 v[144:147], v[64:67], v[240:243], v[144:147]
    v_mul_f32 v12, 0xc0135761, v18
    v_mul_f32 v74, 0xc0135761, v22
    v_mfma_f32_16x16x32_bf16 v[172:175], v[64:67], v[244:247], v[172:175]
    ds_read_b128 v[56:59], v3 offset:4096
    s_waitcnt lgkmcnt(4)
    v_mfma_f32_16x16x32_bf16 v[148:151], v[40:43], v[240:243], v[148:151]
    v_mul_f32 v10, v18, v18
    v_mul_f32 v72, v22, v22
    v_mfma_f32_16x16x32_bf16 v[176:179], v[40:43], v[244:247], v[176:179]
    ds_read_b128 v[60:63], v3 offset:5120
    s_waitcnt lgkmcnt(4)
    v_mfma_f32_16x16x32_bf16 v[152:155], v[44:47], v[240:243], v[152:155]
    v_mov_b32 v77, v16
    v_mov_b32 v69, v20
    v_mfma_f32_16x16x32_bf16 v[180:183], v[44:47], v[244:247], v[180:183]
    ds_read_b128 v[64:67], v3 offset:6144
    s_waitcnt lgkmcnt(4)
    v_mfma_f32_16x16x32_bf16 v[156:159], v[48:51], v[240:243], v[156:159]
    v_mul_f32 v10, v10, v12
    v_mul_f32 v72, v72, v74
    v_mfma_f32_16x16x32_bf16 v[184:187], v[48:51], v[244:247], v[184:187]
    ds_read_b128 v[40:43], v3 offset:7168
    s_waitcnt lgkmcnt(4)
    v_mfma_f32_16x16x32_bf16 v[160:163], v[52:55], v[240:243], v[160:163]
    ds_read_b128 v[112:115], v7 offset:0
    ds_read_b128 v[116:119], v7 offset:64
    v_mov_b32 v13, v12
    v_mov_b32 v75, v74
    v_mfma_f32_16x16x32_bf16 v[188:191], v[52:55], v[244:247], v[188:191]
    ds_read_b128 v[44:47], v3 offset:8192
    s_waitcnt lgkmcnt(6)
    v_mfma_f32_16x16x32_bf16 v[164:167], v[56:59], v[240:243], v[164:167]
    v_mul_f32 v10, 0x3d372713, v10
    v_mul_f32 v72, 0x3d372713, v72
    v_mfma_f32_16x16x32_bf16 v[192:195], v[56:59], v[244:247], v[192:195]
    ds_read_b128 v[48:51], v3 offset:9216
    s_waitcnt lgkmcnt(6)
    v_mfma_f32_16x16x32_bf16 v[168:171], v[60:63], v[240:243], v[168:171]
    v_mov_b32 v76, v77
    v_mov_b32 v68, v69
    v_mfma_f32_16x16x32_bf16 v[196:199], v[60:63], v[244:247], v[196:199]
    ds_read_b128 v[52:55], v3 offset:10240
    s_waitcnt vmcnt(2) lgkmcnt(6)
    v_mfma_f32_16x16x32_bf16 v[144:147], v[64:67], v[200:203], v[144:147]
    v_mov_b32 v91, 22
    v_mov_b32 v78, v79
    v_mov_b32 v70, v71
    v_mfma_f32_16x16x32_bf16 v[172:175], v[64:67], v[204:207], v[172:175]
    ds_read_b128 v[56:59], v3 offset:11264
    s_waitcnt lgkmcnt(6)
    v_mfma_f32_16x16x32_bf16 v[148:151], v[40:43], v[200:203], v[148:151]
    v_mov_b32 v11, v10
    v_mov_b32 v73, v72
    v_mfma_f32_16x16x32_bf16 v[176:179], v[40:43], v[204:207], v[176:179]
    ds_read_b128 v[60:63], v3 offset:12288
    s_waitcnt lgkmcnt(4)
    v_mfma_f32_16x16x32_bf16 v[152:155], v[44:47], v[200:203], v[152:155]
    v_mfma_f32_16x16x32_bf16 v[180:183], v[44:47], v[204:207], v[180:183]
    ds_read_b128 v[64:67], v3 offset:13312
    s_waitcnt lgkmcnt(4)
    v_mfma_f32_16x16x32_bf16 v[156:159], v[48:51], v[200:203], v[156:159]
    v_mfma_f32_16x16x32_bf16 v[184:187], v[48:51], v[204:207], v[184:187]
    ds_read_b128 v[40:43], v3 offset:14336
    s_waitcnt lgkmcnt(4)
    v_mfma_f32_16x16x32_bf16 v[160:163], v[52:55], v[200:203], v[160:163]
    v_mfma_f32_16x16x32_bf16 v[188:191], v[52:55], v[204:207], v[188:191]
    ds_read_b128 v[44:47], v3 offset:15360
    s_waitcnt lgkmcnt(4)
    v_mfma_f32_16x16x32_bf16 v[164:167], v[56:59], v[200:203], v[164:167]
    v_mfma_f32_16x16x32_bf16 v[192:195], v[56:59], v[204:207], v[192:195]
    ds_read_b128 v[48:51], v3 offset:16384
    s_waitcnt lgkmcnt(4)
    v_mfma_f32_16x16x32_bf16 v[168:171], v[60:63], v[200:203], v[168:171]
    v_mfma_f32_16x16x32_bf16 v[196:199], v[60:63], v[204:207], v[196:199]
    ds_read_b128 v[52:55], v3 offset:17408
    s_waitcnt vmcnt(0) lgkmcnt(4)
    v_mfma_f32_16x16x32_bf16 v[144:147], v[64:67], v[208:211], v[144:147]
    v_mfma_f32_16x16x32_bf16 v[172:175], v[64:67], v[212:215], v[172:175]
    ds_read_b128 v[56:59], v3 offset:18432
    s_waitcnt lgkmcnt(4)
    v_mfma_f32_16x16x32_bf16 v[148:151], v[40:43], v[208:211], v[148:151]
    v_mfma_f32_16x16x32_bf16 v[176:179], v[40:43], v[212:215], v[176:179]
    ds_read_b128 v[60:63], v3 offset:19456
    ds_write_b32 v255, v91 offset:16
    s_waitcnt lgkmcnt(5)
    v_mfma_f32_16x16x32_bf16 v[152:155], v[44:47], v[208:211], v[152:155]
    v_mfma_f32_16x16x32_bf16 v[180:183], v[44:47], v[212:215], v[180:183]
    s_waitcnt lgkmcnt(4)
    v_mfma_f32_16x16x32_bf16 v[156:159], v[48:51], v[208:211], v[156:159]
    v_mfma_f32_16x16x32_bf16 v[184:187], v[48:51], v[212:215], v[184:187]
    s_waitcnt lgkmcnt(3)
    v_mfma_f32_16x16x32_bf16 v[160:163], v[52:55], v[208:211], v[160:163]
    v_mov_b32 v4, 6
    s_mov_b64 exec, 1
    s_cmp_lg_u32 s24, 0
    s_cbranch_scc1 L_sf133
    buffer_store_dword v4, v2, s[20:23], s34 offen
L_se134:
    s_mov_b64 exec, -1
    v_mfma_f32_16x16x32_bf16 v[188:191], v[52:55], v[212:215], v[188:191]
    s_waitcnt lgkmcnt(2)
    v_mfma_f32_16x16x32_bf16 v[164:167], v[56:59], v[208:211], v[164:167]
    v_mfma_f32_16x16x32_bf16 v[192:195], v[56:59], v[212:215], v[192:195]
    s_waitcnt lgkmcnt(1)
    v_mfma_f32_16x16x32_bf16 v[168:171], v[60:63], v[208:211], v[168:171]
    v_mfma_f32_16x16x32_bf16 v[196:199], v[60:63], v[212:215], v[196:199]
L_c4:
    ds_read_b128 v[120:123], v7 offset:128
    ds_read_b128 v[124:127], v7 offset:192
    s_waitcnt lgkmcnt(2)
    v_pk_fma_f32 v[144:145], v[112:113], v[76:77], v[144:145] neg_lo:[1,0,0] neg_hi:[1,0,0]
    v_pk_fma_f32 v[146:147], v[114:115], v[76:77], v[146:147] neg_lo:[1,0,0] neg_hi:[1,0,0]
    v_pk_fma_f32 v[148:149], v[116:117], v[76:77], v[148:149] neg_lo:[1,0,0] neg_hi:[1,0,0]
    v_pk_fma_f32 v[150:151], v[118:119], v[76:77], v[150:151] neg_lo:[1,0,0] neg_hi:[1,0,0]
    v_pk_fma_f32 v[172:173], v[112:113], v[68:69], v[172:173] neg_lo:[1,0,0] neg_hi:[1,0,0]
    v_pk_fma_f32 v[174:175], v[114:115], v[68:69], v[174:175] neg_lo:[1,0,0] neg_hi:[1,0,0]
    v_pk_fma_f32 v[176:177], v[116:117], v[68:69], v[176:177] neg_lo:[1,0,0] neg_hi:[1,0,0]
    v_pk_fma_f32 v[178:179], v[118:119], v[68:69], v[178:179] neg_lo:[1,0,0] neg_hi:[1,0,0]
    v_pk_mul_f32 v[16:17], v[144:145], v[144:145]
    v_pk_mul_f32 v[18:19], v[146:147], v[146:147]
    v_pk_mul_f32 v[20:21], v[148:149], v[148:149]
    v_pk_mul_f32 v[22:23], v[150:151], v[150:151]
    v_pk_mul_f32 v[24:25], v[172:173], v[172:173]
    v_pk_mul_f32 v[26:27], v[174:175], v[174:175]
    v_pk_mul_f32 v[28:29], v[176:177], v[176:177]
    v_pk_mul_f32 v[30:31], v[178:179], v[178:179]
    v_pk_fma_f32 v[16:17], v[16:17], v[10:11], v[12:13]
    v_pk_fma_f32 v[18:19], v[18:19], v[10:11], v[12:13]
    v_pk_fma_f32 v[20:21], v[20:21], v[10:11], v[12:13]
    v_pk_fma_f32 v[22:23], v[22:23], v[10:11], v[12:13]
    v_pk_fma_f32 v[24:25], v[24:25], v[72:73], v[74:75]
    v_pk_fma_f32 v[26:27], v[26:27], v[72:73], v[74:75]
    v_pk_fma_f32 v[28:29], v[28:29], v[72:73], v[74:75]
    v_pk_fma_f32 v[30:31], v[30:31], v[72:73], v[74:75]
    v_pk_mul_f32 v[16:17], v[16:17], v[144:145]
    v_pk_mul_f32 v[18:19], v[18:19], v[146:147]
    v_pk_mul_f32 v[20:21], v[20:21], v[148:149]
    v_pk_mul_f32 v[22:23], v[22:23], v[150:151]
    v_pk_mul_f32 v[24:25], v[24:25], v[172:173]
    v_pk_mul_f32 v[26:27], v[26:27], v[174:175]
    v_pk_mul_f32 v[28:29], v[28:29], v[176:177]
    v_pk_mul_f32 v[30:31], v[30:31], v[178:179]
    v_exp_f32 v16, v16
    v_exp_f32 v17, v17
    v_exp_f32 v18, v18
    v_exp_f32 v19, v19
    v_exp_f32 v20, v20
    v_exp_f32 v21, v21
    v_exp_f32 v22, v22
    v_exp_f32 v23, v23
    v_exp_f32 v24, v24
    v_exp_f32 v25, v25
    v_exp_f32 v26, v26
    v_exp_f32 v27, v27
    v_exp_f32 v28, v28
    v_exp_f32 v29, v29
    v_exp_f32 v30, v30
    v_exp_f32 v31, v31
    v_pk_fma_f32 v[16:17], v[16:17], v[78:79], v[78:79]
    v_pk_fma_f32 v[18:19], v[18:19], v[78:79], v[78:79]
    v_pk_fma_f32 v[20:21], v[20:21], v[78:79], v[78:79]
    v_pk_fma_f32 v[22:23], v[22:23], v[78:79], v[78:79]
    v_pk_fma_f32 v[24:25], v[24:25], v[70:71], v[70:71]
    v_pk_fma_f32 v[26:27], v[26:27], v[70:71], v[70:71]
    v_pk_fma_f32 v[28:29], v[28:29], v[70:71], v[70:71]
    v_pk_fma_f32 v[30:31], v[30:31], v[70:71], v[70:71]
    v_rcp_f32 v16, v16
    v_rcp_f32 v17, v17
    v_rcp_f32 v18, v18
    v_rcp_f32 v19, v19
    v_rcp_f32 v20, v20
    v_rcp_f32 v21, v21
    v_rcp_f32 v22, v22
    v_rcp_f32 v23, v23
    v_rcp_f32 v24, v24
    v_rcp_f32 v25, v25
    v_rcp_f32 v26, v26
    v_rcp_f32 v27, v27
    v_rcp_f32 v28, v28
    v_rcp_f32 v29, v29
    v_rcp_f32 v30, v30
    v_rcp_f32 v31, v31
    v_pk_mul_f32 v[144:145], v[144:145], v[16:17]
    v_pk_mul_f32 v[146:147], v[146:147], v[18:19]
    v_pk_mul_f32 v[148:149], v[148:149], v[20:21]
    v_pk_mul_f32 v[150:151], v[150:151], v[22:23]
    v_pk_mul_f32 v[172:173], v[172:173], v[24:25]
    v_pk_mul_f32 v[174:175], v[174:175], v[26:27]
    v_pk_mul_f32 v[176:177], v[176:177], v[28:29]
    v_pk_mul_f32 v[178:179], v[178:179], v[30:31]
    v_cvt_pk_bf16_f32 v132, v144, v145
    v_cvt_pk_bf16_f32 v133, v146, v147
    v_cvt_pk_bf16_f32 v134, v148, v149
    v_cvt_pk_bf16_f32 v135, v150, v151
    v_cvt_pk_bf16_f32 v136, v172, v173
    v_cvt_pk_bf16_f32 v137, v174, v175
    v_cvt_pk_bf16_f32 v138, v176, v177
    v_cvt_pk_bf16_f32 v139, v178, v179
    s_add_u32 s43, s40, s26
    s_add_u32 s44, s12, s26
    s_cmp_lg_u32 s24, 0
    s_cbranch_scc1 L_sf135
    buffer_store_dwordx4 v[132:135], v3, s[20:23], s43 offen
    buffer_store_dwordx4 v[136:139], v3, s[20:23], s44 offen
L_se136:
    ds_read_b128 v[112:115], v7 offset:256
    ds_read_b128 v[116:119], v7 offset:320
    s_waitcnt lgkmcnt(2)
    v_pk_fma_f32 v[152:153], v[120:121], v[76:77], v[152:153] neg_lo:[1,0,0] neg_hi:[1,0,0]
    v_pk_fma_f32 v[154:155], v[122:123], v[76:77], v[154:155] neg_lo:[1,0,0] neg_hi:[1,0,0]
    v_pk_fma_f32 v[156:157], v[124:125], v[76:77], v[156:157] neg_lo:[1,0,0] neg_hi:[1,0,0]
    v_pk_fma_f32 v[158:159], v[126:127], v[76:77], v[158:159] neg_lo:[1,0,0] neg_hi:[1,0,0]
    v_pk_fma_f32 v[180:181], v[120:121], v[68:69], v[180:181] neg_lo:[1,0,0] neg_hi:[1,0,0]
    v_pk_fma_f32 v[182:183], v[122:123], v[68:69], v[182:183] neg_lo:[1,0,0] neg_hi:[1,0,0]
    v_pk_fma_f32 v[184:185], v[124:125], v[68:69], v[184:185] neg_lo:[1,0,0] neg_hi:[1,0,0]
    v_pk_fma_f32 v[186:187], v[126:127], v[68:69], v[186:187] neg_lo:[1,0,0] neg_hi:[1,0,0]
    v_pk_mul_f32 v[16:17], v[152:153], v[152:153]
    v_pk_mul_f32 v[18:19], v[154:155], v[154:155]
    v_pk_mul_f32 v[20:21], v[156:157], v[156:157]
    v_pk_mul_f32 v[22:23], v[158:159], v[158:159]
    v_pk_mul_f32 v[24:25], v[180:181], v[180:181]
    v_pk_mul_f32 v[26:27], v[182:183], v[182:183]
    v_pk_mul_f32 v[28:29], v[184:185], v[184:185]
    v_pk_mul_f32 v[30:31], v[186:187], v[186:187]
    v_pk_fma_f32 v[16:17], v[16:17], v[10:11], v[12:13]
    v_pk_fma_f32 v[18:19], v[18:19], v[10:11], v[12:13]
    v_pk_fma_f32 v[20:21], v[20:21], v[10:11], v[12:13]
    v_pk_fma_f32 v[22:23], v[22:23], v[10:11], v[12:13]
    v_pk_fma_f32 v[24:25], v[24:25], v[72:73], v[74:75]
    v_pk_fma_f32 v[26:27], v[26:27], v[72:73], v[74:75]
    v_pk_fma_f32 v[28:29], v[28:29], v[72:73], v[74:75]
    v_pk_fma_f32 v[30:31], v[30:31], v[72:73], v[74:75]
    v_pk_mul_f32 v[16:17], v[16:17], v[152:153]
    v_pk_mul_f32 v[18:19], v[18:19], v[154:155]
    v_pk_mul_f32 v[20:21], v[20:21], v[156:157]
    v_pk_mul_f32 v[22:23], v[22:23], v[158:159]
    v_pk_mul_f32 v[24:25], v[24:25], v[180:181]
    v_pk_mul_f32 v[26:27], v[26:27], v[182:183]
    v_pk_mul_f32 v[28:29], v[28:29], v[184:185]
    v_pk_mul_f32 v[30:31], v[30:31], v[186:187]
    v_exp_f32 v16, v16
    v_exp_f32 v17, v17
    v_exp_f32 v18, v18
    v_exp_f32 v19, v19
    v_exp_f32 v20, v20
    v_exp_f32 v21, v21
    v_exp_f32 v22, v22
    v_exp_f32 v23, v23
    v_exp_f32 v24, v24
    v_exp_f32 v25, v25
    v_exp_f32 v26, v26
    v_exp_f32 v27, v27
    v_exp_f32 v28, v28
    v_exp_f32 v29, v29
    v_exp_f32 v30, v30
    v_exp_f32 v31, v31
    v_pk_fma_f32 v[16:17], v[16:17], v[78:79], v[78:79]
    v_pk_fma_f32 v[18:19], v[18:19], v[78:79], v[78:79]
    v_pk_fma_f32 v[20:21], v[20:21], v[78:79], v[78:79]
    v_pk_fma_f32 v[22:23], v[22:23], v[78:79], v[78:79]
    v_pk_fma_f32 v[24:25], v[24:25], v[70:71], v[70:71]
    v_pk_fma_f32 v[26:27], v[26:27], v[70:71], v[70:71]
    v_pk_fma_f32 v[28:29], v[28:29], v[70:71], v[70:71]
    v_pk_fma_f32 v[30:31], v[30:31], v[70:71], v[70:71]
    v_rcp_f32 v16, v16
    v_rcp_f32 v17, v17
    v_rcp_f32 v18, v18
    v_rcp_f32 v19, v19
    v_rcp_f32 v20, v20
    v_rcp_f32 v21, v21
    v_rcp_f32 v22, v22
    v_rcp_f32 v23, v23
    v_rcp_f32 v24, v24
    v_rcp_f32 v25, v25
    v_rcp_f32 v26, v26
    v_rcp_f32 v27, v27
    v_rcp_f32 v28, v28
    v_rcp_f32 v29, v29
    v_rcp_f32 v30, v30
    v_rcp_f32 v31, v31
    s_waitcnt vmcnt(0)
    v_mov_b32 v4, 7
    s_mov_b64 exec, 1
    s_cmp_lg_u32 s24, 0
    s_cbranch_scc1 L_sf137
    buffer_store_dword v4, v2, s[20:23], s34 offen
L_se138:
    s_mov_b64 exec, -1
    v_pk_mul_f32 v[152:153], v[152:153], v[16:17]
    v_pk_mul_f32 v[154:155], v[154:155], v[18:19]
    v_pk_mul_f32 v[156:157], v[156:157], v[20:21]
    v_pk_mul_f32 v[158:159], v[158:159], v[22:23]
    v_pk_mul_f32 v[180:181], v[180:181], v[24:25]
    v_pk_mul_f32 v[182:183], v[182:183], v[26:27]
    v_pk_mul_f32 v[184:185], v[184:185], v[28:29]
    v_pk_mul_f32 v[186:187], v[186:187], v[30:31]
    v_cvt_pk_bf16_f32 v80, v152, v153
    v_cvt_pk_bf16_f32 v81, v154, v155
    v_cvt_pk_bf16_f32 v82, v156, v157
    v_cvt_pk_bf16_f32 v83, v158, v159
    v_cvt_pk_bf16_f32 v84, v180, v181
    v_cvt_pk_bf16_f32 v85, v182, v183
    v_cvt_pk_bf16_f32 v86, v184, v185
    v_cvt_pk_bf16_f32 v87, v186, v187
    s_add_u32 s43, s40, s27
    s_add_u32 s44, s12, s27
    s_cmp_lg_u32 s24, 0
    s_cbranch_scc1 L_sf139
    buffer_store_dwordx4 v[80:83], v3, s[20:23], s43 offen
    buffer_store_dwordx4 v[84:87], v3, s[20:23], s44 offen
L_se140:
    ds_read_b128 v[120:123], v251
    s_waitcnt lgkmcnt(1)
    v_pk_fma_f32 v[160:161], v[112:113], v[76:77], v[160:161] neg_lo:[1,0,0] neg_hi:[1,0,0]
    v_pk_fma_f32 v[162:163], v[114:115], v[76:77], v[162:163] neg_lo:[1,0,0] neg_hi:[1,0,0]
    v_pk_fma_f32 v[164:165], v[116:117], v[76:77], v[164:165] neg_lo:[1,0,0] neg_hi:[1,0,0]
    v_pk_fma_f32 v[166:167], v[118:119], v[76:77], v[166:167] neg_lo:[1,0,0] neg_hi:[1,0,0]
    v_pk_fma_f32 v[188:189], v[112:113], v[68:69], v[188:189] neg_lo:[1,0,0] neg_hi:[1,0,0]
    v_pk_fma_f32 v[190:191], v[114:115], v[68:69], v[190:191] neg_lo:[1,0,0] neg_hi:[1,0,0]
    v_pk_fma_f32 v[192:193], v[116:117], v[68:69], v[192:193] neg_lo:[1,0,0] neg_hi:[1,0,0]
    v_pk_fma_f32 v[194:195], v[118:119], v[68:69], v[194:195] neg_lo:[1,0,0] neg_hi:[1,0,0]
    v_pk_mul_f32 v[16:17], v[160:161], v[160:161]
    v_pk_mul_f32 v[18:19], v[162:163], v[162:163]
    v_pk_mul_f32 v[20:21], v[164:165], v[164:165]
    v_pk_mul_f32 v[22:23], v[166:167], v[166:167]
    v_pk_mul_f32 v[24:25], v[188:189], v[188:189]
    v_pk_mul_f32 v[26:27], v[190:191], v[190:191]
    v_pk_mul_f32 v[28:29], v[192:193], v[192:193]
    v_pk_mul_f32 v[30:31], v[194:195], v[194:195]
    v_pk_fma_f32 v[16:17], v[16:17], v[10:11], v[12:13]
    v_pk_fma_f32 v[18:19], v[18:19], v[10:11], v[12:13]
    v_pk_fma_f32 v[20:21], v[20:21], v[10:11], v[12:13]
    v_pk_fma_f32 v[22:23], v[22:23], v[10:11], v[12:13]
    v_pk_fma_f32 v[24:25], v[24:25], v[72:73], v[74:75]
    v_pk_fma_f32 v[26:27], v[26:27], v[72:73], v[74:75]
    v_pk_fma_f32 v[28:29], v[28:29], v[72:73], v[74:75]
    v_pk_fma_f32 v[30:31], v[30:31], v[72:73], v[74:75]
    buffer_load_dword v15, v14, s[20:23], s33 offen sc1
    v_pk_mul_f32 v[16:17], v[16:17], v[160:161]
    v_pk_mul_f32 v[18:19], v[18:19], v[162:163]
    v_pk_mul_f32 v[20:21], v[20:21], v[164:165]
    v_pk_mul_f32 v[22:23], v[22:23], v[166:167]
    v_pk_mul_f32 v[24:25], v[24:25], v[188:189]
    v_pk_mul_f32 v[26:27], v[26:27], v[190:191]
    v_pk_mul_f32 v[28:29], v[28:29], v[192:193]
    v_pk_mul_f32 v[30:31], v[30:31], v[194:195]
    v_exp_f32 v16, v16
    v_exp_f32 v17, v17
    v_exp_f32 v18, v18
    v_exp_f32 v19, v19
    v_exp_f32 v20, v20
    v_exp_f32 v21, v21
    v_exp_f32 v22, v22
    v_exp_f32 v23, v23
    v_exp_f32 v24, v24
    v_exp_f32 v25, v25
    v_exp_f32 v26, v26
    v_exp_f32 v27, v27
    v_exp_f32 v28, v28
    v_exp_f32 v29, v29
    v_exp_f32 v30, v30
    v_exp_f32 v31, v31
    v_pk_fma_f32 v[16:17], v[16:17], v[78:79], v[78:79]
    v_pk_fma_f32 v[18:19], v[18:19], v[78:79], v[78:79]
    v_pk_fma_f32 v[20:21], v[20:21], v[78:79], v[78:79]
    v_pk_fma_f32 v[22:23], v[22:23], v[78:79], v[78:79]
    v_pk_fma_f32 v[24:25], v[24:25], v[70:71], v[70:71]
    v_pk_fma_f32 v[26:27], v[26:27], v[70:71], v[70:71]
    v_pk_fma_f32 v[28:29], v[28:29], v[70:71], v[70:71]
    v_pk_fma_f32 v[30:31], v[30:31], v[70:71], v[70:71]
    v_rcp_f32 v16, v16
    v_rcp_f32 v17, v17
    v_rcp_f32 v18, v18
    v_rcp_f32 v19, v19
    v_rcp_f32 v20, v20
    v_rcp_f32 v21, v21
    v_rcp_f32 v22, v22
    v_rcp_f32 v23, v23
    v_rcp_f32 v24, v24
    v_rcp_f32 v25, v25
    v_rcp_f32 v26, v26
    v_rcp_f32 v27, v27
    v_rcp_f32 v28, v28
    v_rcp_f32 v29, v29
    v_rcp_f32 v30, v30
    v_rcp_f32 v31, v31
    s_waitcnt vmcnt(1)
    v_mov_b32 v4, 8
    s_mov_b64 exec, 1
    s_cmp_lg_u32 s24, 0
    s_cbranch_scc1 L_sf141
    buffer_store_dword v4, v2, s[20:23], s34 offen
L_se142:
    s_mov_b64 exec, -1
    v_pk_mul_f32 v[160:161], v[160:161], v[16:17]
    v_pk_mul_f32 v[162:163], v[162:163], v[18:19]
    v_pk_mul_f32 v[164:165], v[164:165], v[20:21]
    v_pk_mul_f32 v[166:167], v[166:167], v[22:23]
    v_pk_mul_f32 v[188:189], v[188:189], v[24:25]
    v_pk_mul_f32 v[190:191], v[190:191], v[26:27]
    v_pk_mul_f32 v[192:193], v[192:193], v[28:29]
    v_pk_mul_f32 v[194:195], v[194:195], v[30:31]
    v_cvt_pk_bf16_f32 v132, v160, v161
    v_cvt_pk_bf16_f32 v133, v162, v163
    v_cvt_pk_bf16_f32 v134, v164, v165
    v_cvt_pk_bf16_f32 v135, v166, v167
    v_cvt_pk_bf16_f32 v136, v188, v189
    v_cvt_pk_bf16_f32 v137, v190, v191
    v_cvt_pk_bf16_f32 v138, v192, v193
    v_cvt_pk_bf16_f32 v139, v194, v195
    s_waitcnt vmcnt(1)
    v_cmp_gt_u32 vcc, 7, v15
    s_cbranch_vccnz L_pl143
L_pd144:
    s_add_u32 s43, s40, s31
    s_add_u32 s44, s12, s31
    s_cmp_lg_u32 s24, 0
    s_cbranch_scc1 L_sf146
    buffer_store_dwordx4 v[132:135], v3, s[20:23], s43 offen
    buffer_store_dwordx4 v[136:139], v3, s[20:23], s44 offen
L_se147:
    s_add_u32 s4, s40, s38
    s_add_u32 s4, s4, 5242880
    buffer_load_dwordx4 v[200:203], v3, s[20:23], s4 offen offset:0 sc1
    s_add_u32 s5, s12, s38
    s_add_u32 s5, s5, 5242880
    buffer_load_dwordx4 v[204:207], v3, s[20:23], s5 offen offset:0 sc1
    buffer_load_dwordx4 v[208:211], v3, s[20:23], s4 offen offset:1024 sc1
    buffer_load_dwordx4 v[212:215], v3, s[20:23], s5 offen offset:1024 sc1
    buffer_load_dwordx4 v[216:219], v3, s[20:23], s4 offen offset:2048 sc1
    buffer_load_dwordx4 v[220:223], v3, s[20:23], s5 offen offset:2048 sc1
    ds_read_b32 v90, v254
    s_waitcnt lgkmcnt(1)
    v_pk_fma_f32 v[168:169], v[120:121], v[76:77], v[168:169] neg_lo:[1,0,0] neg_hi:[1,0,0]
    v_pk_fma_f32 v[170:171], v[122:123], v[76:77], v[170:171] neg_lo:[1,0,0] neg_hi:[1,0,0]
    v_pk_fma_f32 v[196:197], v[120:121], v[68:69], v[196:197] neg_lo:[1,0,0] neg_hi:[1,0,0]
    v_pk_fma_f32 v[198:199], v[122:123], v[68:69], v[198:199] neg_lo:[1,0,0] neg_hi:[1,0,0]
    v_pk_mul_f32 v[16:17], v[168:169], v[168:169]
    v_pk_mul_f32 v[18:19], v[170:171], v[170:171]
    v_pk_mul_f32 v[24:25], v[196:197], v[196:197]
    v_pk_mul_f32 v[26:27], v[198:199], v[198:199]
    v_pk_fma_f32 v[16:17], v[16:17], v[10:11], v[12:13]
    v_pk_fma_f32 v[18:19], v[18:19], v[10:11], v[12:13]
    v_pk_fma_f32 v[24:25], v[24:25], v[72:73], v[74:75]
    v_pk_fma_f32 v[26:27], v[26:27], v[72:73], v[74:75]
    v_pk_mul_f32 v[16:17], v[16:17], v[168:169]
    v_pk_mul_f32 v[18:19], v[18:19], v[170:171]
    v_pk_mul_f32 v[24:25], v[24:25], v[196:197]
    v_pk_mul_f32 v[26:27], v[26:27], v[198:199]
    v_exp_f32 v16, v16
    v_exp_f32 v17, v17
    v_exp_f32 v18, v18
    v_exp_f32 v19, v19
    v_exp_f32 v24, v24
    v_exp_f32 v25, v25
    v_exp_f32 v26, v26
    v_exp_f32 v27, v27
    v_pk_fma_f32 v[16:17], v[16:17], v[78:79], v[78:79]
    v_pk_fma_f32 v[18:19], v[18:19], v[78:79], v[78:79]
    v_pk_fma_f32 v[24:25], v[24:25], v[70:71], v[70:71]
    v_pk_fma_f32 v[26:27], v[26:27], v[70:71], v[70:71]
    v_rcp_f32 v16, v16
    v_rcp_f32 v17, v17
    v_rcp_f32 v18, v18
    v_rcp_f32 v19, v19
    v_rcp_f32 v24, v24
    v_rcp_f32 v25, v25
    v_rcp_f32 v26, v26
    v_rcp_f32 v27, v27
    v_pk_mul_f32 v[168:169], v[168:169], v[16:17]
    v_pk_mul_f32 v[170:171], v[170:171], v[18:19]
    v_pk_mul_f32 v[196:197], v[196:197], v[24:25]
    v_pk_mul_f32 v[198:199], v[198:199], v[26:27]
    v_cvt_pk_bf16_f32 v80, v168, v169
    v_cvt_pk_bf16_f32 v81, v170, v171
    v_cvt_pk_bf16_f32 v84, v196, v197
    v_cvt_pk_bf16_f32 v85, v198, v199
    s_add_u32 s43, s40, s32
    s_add_u32 s44, s12, s32
    s_cmp_lg_u32 s24, 0
    s_cbranch_scc1 L_sf148
    buffer_store_dwordx2 v[80:81], v3, s[20:23], s43 offen
    buffer_store_dwordx2 v[84:85], v3, s[20:23], s44 offen
L_se149:
    s_waitcnt lgkmcnt(0)
    v_cmp_gt_u32 vcc, 23, v90
    s_cbranch_vccnz L_ll150
L_ld151:
    buffer_load_dwordx4 v[224:227], v3, s[20:23], s4 offen offset:3072 sc1
    buffer_load_dwordx4 v[228:231], v3, s[20:23], s5 offen offset:3072 sc1
    ds_read_b128 v[64:67], v3 offset:20480
    ds_read_b128 v[40:43], v3 offset:21504
    ds_read_b128 v[44:47], v3 offset:22528
    ds_read_b128 v[48:51], v3 offset:23552
    ds_read_b128 v[52:55], v3 offset:24576
    s_waitcnt vmcnt(8) lgkmcnt(4)
    v_mfma_f32_16x16x32_bf16 v[16:19], v[64:67], v[204:207], 0
    v_mfma_f32_16x16x32_bf16 v[92:95], v[64:67], v[200:203], v[92:95]
    ds_read_b128 v[56:59], v3 offset:25600
    s_waitcnt lgkmcnt(4)
    v_mfma_f32_16x16x32_bf16 v[20:23], v[40:43], v[204:207], 0
    s_add_u32 s4, s40, s38
    s_add_u32 s4, s4, 5251072
    buffer_load_dwordx4 v[232:235], v3, s[20:23], s4 offen offset:0 sc1
    v_mfma_f32_16x16x32_bf16 v[96:99], v[40:43], v[200:203], v[96:99]
    ds_read_b128 v[60:63], v3 offset:26624
    s_waitcnt lgkmcnt(4)
    v_mfma_f32_16x16x32_bf16 v[24:27], v[44:47], v[204:207], 0
    v_mfma_f32_16x16x32_bf16 v[100:103], v[44:47], v[200:203], v[100:103]
    ds_read_b128 v[64:67], v3 offset:27648
    s_waitcnt lgkmcnt(4)
    v_mfma_f32_16x16x32_bf16 v[28:31], v[48:51], v[204:207], 0
    s_add_u32 s5, s12, s38
    s_add_u32 s5, s5, 5251072
    buffer_load_dwordx4 v[236:239], v3, s[20:23], s5 offen offset:0 sc1
    v_mfma_f32_16x16x32_bf16 v[104:107], v[48:51], v[200:203], v[104:107]
    ds_read_b128 v[40:43], v3 offset:28672
    s_waitcnt lgkmcnt(4)
    v_mfma_f32_16x16x32_bf16 v[32:35], v[52:55], v[204:207], 0
    buffer_load_dword v15, v14, s[20:23], s33 offen sc1
    v_mfma_f32_16x16x32_bf16 v[108:111], v[52:55], v[200:203], v[108:111]
    ds_read_b128 v[44:47], v3 offset:29696
    s_waitcnt vmcnt(9) lgkmcnt(4)
    v_mfma_f32_16x16x32_bf16 v[16:19], v[56:59], v[212:215], v[16:19]
    v_mfma_f32_16x16x32_bf16 v[92:95], v[56:59], v[208:211], v[92:95]
    ds_read_b128 v[48:51], v3 offset:30720
    s_waitcnt lgkmcnt(4)
    v_mfma_f32_16x16x32_bf16 v[20:23], v[60:63], v[212:215], v[20:23]
    buffer_load_dwordx4 v[240:243], v3, s[20:23], s4 offen offset:1024 sc1
    v_mfma_f32_16x16x32_bf16 v[96:99], v[60:63], v[208:211], v[96:99]
    ds_read_b128 v[52:55], v3 offset:31744
    s_waitcnt lgkmcnt(4)
    v_mfma_f32_16x16x32_bf16 v[24:27], v[64:67], v[212:215], v[24:27]
    v_mfma_f32_16x16x32_bf16 v[100:103], v[64:67], v[208:211], v[100:103]
    ds_read_b128 v[56:59], v3 offset:32768
    s_waitcnt lgkmcnt(4)
    v_mfma_f32_16x16x32_bf16 v[28:31], v[40:43], v[212:215], v[28:31]
    buffer_load_dwordx4 v[244:247], v3, s[20:23], s5 offen offset:1024 sc1
    v_mfma_f32_16x16x32_bf16 v[104:107], v[40:43], v[208:211], v[104:107]
    ds_read_b128 v[60:63], v3 offset:33792
    s_waitcnt lgkmcnt(4)
    v_mfma_f32_16x16x32_bf16 v[32:35], v[44:47], v[212:215], v[32:35]
    v_mov_b32 v91, 23
    v_mfma_f32_16x16x32_bf16 v[108:111], v[44:47], v[208:211], v[108:111]
    ds_read_b32 v90, v254
    ds_read_b128 v[64:67], v3 offset:34816
    s_waitcnt vmcnt(9) lgkmcnt(5)
    v_mfma_f32_16x16x32_bf16 v[16:19], v[48:51], v[220:223], v[16:19]
    v_mfma_f32_16x16x32_bf16 v[92:95], v[48:51], v[216:219], v[92:95]
    ds_read_b128 v[40:43], v3 offset:35840
    s_waitcnt lgkmcnt(5)
    v_mfma_f32_16x16x32_bf16 v[20:23], v[52:55], v[220:223], v[20:23]
    buffer_load_dwordx4 v[144:147], v3, s[20:23], s4 offen offset:2048 sc1
    v_mfma_f32_16x16x32_bf16 v[96:99], v[52:55], v[216:219], v[96:99]
    ds_read_b128 v[44:47], v3 offset:36864
    s_waitcnt lgkmcnt(5)
    v_mfma_f32_16x16x32_bf16 v[24:27], v[56:59], v[220:223], v[24:27]
    v_mfma_f32_16x16x32_bf16 v[100:103], v[56:59], v[216:219], v[100:103]
    ds_read_b128 v[48:51], v3 offset:37888
    s_waitcnt lgkmcnt(5)
    v_mfma_f32_16x16x32_bf16 v[28:31], v[60:63], v[220:223], v[28:31]
    buffer_load_dwordx4 v[148:151], v3, s[20:23], s5 offen offset:2048 sc1
    v_mfma_f32_16x16x32_bf16 v[104:107], v[60:63], v[216:219], v[104:107]
    ds_read_b128 v[52:55], v3 offset:38912
    s_waitcnt lgkmcnt(4)
    v_mfma_f32_16x16x32_bf16 v[32:35], v[64:67], v[220:223], v[32:35]
    s_waitcnt vmcnt(9)
    v_mov_b32 v4, 9
    s_mov_b64 exec, 1
    s_cmp_lg_u32 s24, 0
    s_cbranch_scc1 L_sf153
    buffer_store_dword v4, v2, s[20:23], s34 offen
L_se154:
    s_mov_b64 exec, -1
    ds_write_b32 v255, v91 offset:16
    v_mfma_f32_16x16x32_bf16 v[108:111], v[64:67], v[216:219], v[108:111]
    ds_read_b128 v[56:59], v3 offset:39936
    s_waitcnt vmcnt(8) lgkmcnt(5)
    v_mfma_f32_16x16x32_bf16 v[16:19], v[40:43], v[228:231], v[16:19]
    v_mfma_f32_16x16x32_bf16 v[92:95], v[40:43], v[224:227], v[92:95]
    s_waitcnt lgkmcnt(7)
    v_cmp_gt_u32 vcc, 24, v90
    s_cbranch_vccnz L_ll155
L_ld156:
    ds_read_b128 v[60:63], v3 offset:40960
    s_waitcnt lgkmcnt(5)
    v_mfma_f32_16x16x32_bf16 v[20:23], v[44:47], v[228:231], v[20:23]
    buffer_load_dwordx4 v[152:155], v3, s[20:23], s4 offen offset:3072 sc1
    v_mfma_f32_16x16x32_bf16 v[96:99], v[44:47], v[224:227], v[96:99]
    ds_read_b128 v[64:67], v3 offset:41984
    s_waitcnt lgkmcnt(5)
    v_mfma_f32_16x16x32_bf16 v[24:27], v[48:51], v[228:231], v[24:27]
    v_mfma_f32_16x16x32_bf16 v[100:103], v[48:51], v[224:227], v[100:103]
    ds_read_b128 v[40:43], v3 offset:43008
    s_waitcnt lgkmcnt(5)
    v_mfma_f32_16x16x32_bf16 v[28:31], v[52:55], v[228:231], v[28:31]
    buffer_load_dwordx4 v[156:159], v3, s[20:23], s5 offen offset:3072 sc1
    v_mfma_f32_16x16x32_bf16 v[104:107], v[52:55], v[224:227], v[104:107]
    ds_read_b128 v[44:47], v3 offset:44032
    s_waitcnt lgkmcnt(4)
    v_mfma_f32_16x16x32_bf16 v[32:35], v[56:59], v[228:231], v[32:35]
    v_mfma_f32_16x16x32_bf16 v[108:111], v[56:59], v[224:227], v[108:111]
    ds_read_b128 v[48:51], v3 offset:45056
    s_waitcnt vmcnt(8) lgkmcnt(4)
    v_mfma_f32_16x16x32_bf16 v[16:19], v[60:63], v[236:239], v[16:19]
    v_mfma_f32_16x16x32_bf16 v[92:95], v[60:63], v[232:235], v[92:95]
    ds_read_b128 v[52:55], v3 offset:46080
    s_waitcnt lgkmcnt(4)
    v_mfma_f32_16x16x32_bf16 v[20:23], v[64:67], v[236:239], v[20:23]
    s_waitcnt vmcnt(7)
    v_cmp_gt_u32 vcc, 8, v15
    s_cbranch_vccnz L_pl158
L_pd159:
    s_add_u32 s4, s40, s38
    s_add_u32 s4, s4, 0
    buffer_load_dwordx4 v[160:163], v3, s[20:23], s4 offen offset:0 sc1
    v_mfma_f32_16x16x32_bf16 v[96:99], v[64:67], v[232:235], v[96:99]
    ds_read_b128 v[56:59], v3 offset:47104
    s_waitcnt lgkmcnt(4)
    v_mfma_f32_16x16x32_bf16 v[24:27], v[40:43], v[236:239], v[24:27]
    v_mfma_f32_16x16x32_bf16 v[100:103], v[40:43], v[232:235], v[100:103]
    ds_read_b128 v[60:63], v3 offset:48128
    s_waitcnt lgkmcnt(4)
    v_mfma_f32_16x16x32_bf16 v[28:31], v[44:47], v[236:239], v[28:31]
    s_add_u32 s5, s12, s38
    s_add_u32 s5, s5, 0
    buffer_load_dwordx4 v[164:167], v3, s[20:23], s5 offen offset:0 sc1
    v_mfma_f32_16x16x32_bf16 v[104:107], v[44:47], v[232:235], v[104:107]
    ds_read_b128 v[64:67], v3 offset:49152
    s_waitcnt lgkmcnt(4)
    v_mfma_f32_16x16x32_bf16 v[32:35], v[48:51], v[236:239], v[32:35]
    v_mfma_f32_16x16x32_bf16 v[108:111], v[48:51], v[232:235], v[108:111]
    ds_read_b128 v[40:43], v3 offset:50176
    s_waitcnt vmcnt(7) lgkmcnt(4)
    v_mfma_f32_16x16x32_bf16 v[16:19], v[52:55], v[244:247], v[16:19]
    v_mfma_f32_16x16x32_bf16 v[92:95], v[52:55], v[240:243], v[92:95]
    ds_read_b128 v[44:47], v3 offset:51200
    s_waitcnt lgkmcnt(4)
    v_mfma_f32_16x16x32_bf16 v[20:23], v[56:59], v[244:247], v[20:23]
    buffer_load_dwordx4 v[168:171], v3, s[20:23], s4 offen offset:1024 sc1
    v_mfma_f32_16x16x32_bf16 v[96:99], v[56:59], v[240:243], v[96:99]
    ds_read_b128 v[48:51], v3 offset:52224
    s_waitcnt lgkmcnt(4)
    v_mfma_f32_16x16x32_bf16 v[24:27], v[60:63], v[244:247], v[24:27]
    v_mfma_f32_16x16x32_bf16 v[100:103], v[60:63], v[240:243], v[100:103]
    ds_read_b128 v[52:55], v3 offset:53248
    s_waitcnt lgkmcnt(4)
    v_mfma_f32_16x16x32_bf16 v[28:31], v[64:67], v[244:247], v[28:31]
    buffer_load_dwordx4 v[172:175], v3, s[20:23], s5 offen offset:1024 sc1
    v_mfma_f32_16x16x32_bf16 v[104:107], v[64:67], v[240:243], v[104:107]
    ds_read_b128 v[56:59], v3 offset:54272
    s_waitcnt lgkmcnt(4)
    v_mfma_f32_16x16x32_bf16 v[32:35], v[40:43], v[244:247], v[32:35]
    v_mfma_f32_16x16x32_bf16 v[108:111], v[40:43], v[240:243], v[108:111]
    ds_read_b32 v90, v254
    ds_read_b128 v[60:63], v3 offset:55296
    s_waitcnt vmcnt(7) lgkmcnt(5)
    v_mfma_f32_16x16x32_bf16 v[16:19], v[44:47], v[148:151], v[16:19]
    v_mfma_f32_16x16x32_bf16 v[92:95], v[44:47], v[144:147], v[92:95]
    ds_read_b128 v[64:67], v3 offset:56320
    s_waitcnt lgkmcnt(5)
    v_mfma_f32_16x16x32_bf16 v[20:23], v[48:51], v[148:151], v[20:23]
    buffer_load_dwordx4 v[176:179], v3, s[20:23], s4 offen offset:2048 sc1
    v_mfma_f32_16x16x32_bf16 v[96:99], v[48:51], v[144:147], v[96:99]
    ds_read_b128 v[40:43], v3 offset:57344
    s_waitcnt lgkmcnt(5)
    v_mfma_f32_16x16x32_bf16 v[24:27], v[52:55], v[148:151], v[24:27]
    v_mfma_f32_16x16x32_bf16 v[100:103], v[52:55], v[144:147], v[100:103]
    ds_read_b128 v[44:47], v3 offset:58368
    s_waitcnt lgkmcnt(5)
    v_mfma_f32_16x16x32_bf16 v[28:31], v[56:59], v[148:151], v[28:31]
    buffer_load_dwordx4 v[180:183], v3, s[20:23], s5 offen offset:2048 sc1
    v_mfma_f32_16x16x32_bf16 v[104:107], v[56:59], v[144:147], v[104:107]
    ds_read_b128 v[48:51], v3 offset:59392
    s_waitcnt lgkmcnt(4)
    v_mfma_f32_16x16x32_bf16 v[32:35], v[60:63], v[148:151], v[32:35]
    v_mfma_f32_16x16x32_bf16 v[108:111], v[60:63], v[144:147], v[108:111]
    ds_read_b128 v[52:55], v3 offset:60416
    s_waitcnt vmcnt(6) lgkmcnt(4)
    v_mfma_f32_16x16x32_bf16 v[16:19], v[64:67], v[156:159], v[16:19]
    v_mfma_f32_16x16x32_bf16 v[92:95], v[64:67], v[152:155], v[92:95]
    s_waitcnt lgkmcnt(6)
    v_cmp_gt_u32 vcc, 25, v90
    s_cbranch_vccnz L_ll161
L_ld162:
    ds_read_b128 v[56:59], v3 offset:61440
    s_waitcnt lgkmcnt(4)
    v_mfma_f32_16x16x32_bf16 v[20:23], v[40:43], v[156:159], v[20:23]
    buffer_load_dwordx4 v[184:187], v3, s[20:23], s4 offen offset:3072 sc1
    v_mfma_f32_16x16x32_bf16 v[96:99], v[40:43], v[152:155], v[96:99]
    ds_read_b128 v[60:63], v3 offset:62464
    s_waitcnt lgkmcnt(4)
    v_mfma_f32_16x16x32_bf16 v[24:27], v[44:47], v[156:159], v[24:27]
    v_mfma_f32_16x16x32_bf16 v[100:103], v[44:47], v[152:155], v[100:103]
    ds_read_b128 v[64:67], v3 offset:63488
    s_waitcnt lgkmcnt(4)
    v_mfma_f32_16x16x32_bf16 v[28:31], v[48:51], v[156:159], v[28:31]
    buffer_load_dwordx4 v[188:191], v3, s[20:23], s5 offen offset:3072 sc1
    v_mfma_f32_16x16x32_bf16 v[104:107], v[48:51], v[152:155], v[104:107]
    ds_read_b128 v[40:43], v3 offset:64512
    s_waitcnt lgkmcnt(4)
    v_mfma_f32_16x16x32_bf16 v[32:35], v[52:55], v[156:159], v[32:35]
    buffer_load_dword v15, v14, s[20:23], s33 offen sc1
    v_mfma_f32_16x16x32_bf16 v[108:111], v[52:55], v[152:155], v[108:111]
    ds_read_b128 v[44:47], v8 offset:0
    s_waitcnt vmcnt(7) lgkmcnt(4)
    v_mfma_f32_16x16x32_bf16 v[16:19], v[56:59], v[164:167], v[16:19]
    v_mfma_f32_16x16x32_bf16 v[92:95], v[56:59], v[160:163], v[92:95]
    ds_read_b128 v[48:51], v8 offset:1024
    s_waitcnt lgkmcnt(4)
    v_mfma_f32_16x16x32_bf16 v[20:23], v[60:63], v[164:167], v[20:23]
    s_add_u32 s4, s40, s38
    s_add_u32 s4, s4, 8192
    buffer_load_dwordx4 v[192:195], v3, s[20:23], s4 offen offset:0 sc1
    v_mfma_f32_16x16x32_bf16 v[96:99], v[60:63], v[160:163], v[96:99]
    ds_read_b128 v[52:55], v8 offset:2048
    s_waitcnt lgkmcnt(4)
    v_mfma_f32_16x16x32_bf16 v[24:27], v[64:67], v[164:167], v[24:27]
    v_mfma_f32_16x16x32_bf16 v[100:103], v[64:67], v[160:163], v[100:103]
    ds_read_b128 v[56:59], v8 offset:3072
    s_waitcnt lgkmcnt(4)
    v_mfma_f32_16x16x32_bf16 v[28:31], v[40:43], v[164:167], v[28:31]
    s_add_u32 s5, s12, s38
    s_add_u32 s5, s5, 8192
    buffer_load_dwordx4 v[196:199], v3, s[20:23], s5 offen offset:0 sc1
    v_mfma_f32_16x16x32_bf16 v[104:107], v[40:43], v[160:163], v[104:107]
    ds_read_b128 v[60:63], v8 offset:4096
    s_waitcnt lgkmcnt(4)
    v_mfma_f32_16x16x32_bf16 v[32:35], v[44:47], v[164:167], v[32:35]
    v_mfma_f32_16x16x32_bf16 v[108:111], v[44:47], v[160:163], v[108:111]
    ds_read_b128 v[64:67], v8 offset:5120
    s_waitcnt vmcnt(7) lgkmcnt(4)
    v_mfma_f32_16x16x32_bf16 v[16:19], v[48:51], v[172:175], v[16:19]
    v_mfma_f32_16x16x32_bf16 v[92:95], v[48:51], v[168:171], v[92:95]
    ds_read_b128 v[40:43], v8 offset:6144
    s_waitcnt lgkmcnt(4)
    v_mfma_f32_16x16x32_bf16 v[20:23], v[52:55], v[172:175], v[20:23]
    buffer_load_dwordx4 v[200:203], v3, s[20:23], s4 offen offset:1024 sc1
    v_mfma_f32_16x16x32_bf16 v[96:99], v[52:55], v[168:171], v[96:99]
    ds_read_b128 v[44:47], v8 offset:7168
    s_waitcnt lgkmcnt(4)
    v_mfma_f32_16x16x32_bf16 v[24:27], v[56:59], v[172:175], v[24:27]
    v_mfma_f32_16x16x32_bf16 v[100:103], v[56:59], v[168:171], v[100:103]
    ds_read_b128 v[48:51], v8 offset:8192
    s_waitcnt lgkmcnt(4)
    v_mfma_f32_16x16x32_bf16 v[28:31], v[60:63], v[172:175], v[28:31]
    buffer_load_dwordx4 v[204:207], v3, s[20:23], s5 offen offset:1024 sc1
    v_mfma_f32_16x16x32_bf16 v[104:107], v[60:63], v[168:171], v[104:107]
    ds_read_b128 v[52:55], v8 offset:9216
    s_waitcnt lgkmcnt(4)
    v_mfma_f32_16x16x32_bf16 v[32:35], v[64:67], v[172:175], v[32:35]
    v_mfma_f32_16x16x32_bf16 v[108:111], v[64:67], v[168:171], v[108:111]
    ds_read_b32 v90, v254
    ds_read_b128 v[56:59], v8 offset:10240
    s_waitcnt vmcnt(7) lgkmcnt(5)
    v_mfma_f32_16x16x32_bf16 v[16:19], v[40:43], v[180:183], v[16:19]
    v_mfma_f32_16x16x32_bf16 v[92:95], v[40:43], v[176:179], v[92:95]
    ds_read_b128 v[60:63], v8 offset:11264
    s_waitcnt lgkmcnt(5)
    v_mfma_f32_16x16x32_bf16 v[20:23], v[44:47], v[180:183], v[20:23]
    buffer_load_dwordx4 v[208:211], v3, s[20:23], s4 offen offset:2048 sc1
    v_mfma_f32_16x16x32_bf16 v[96:99], v[44:47], v[176:179], v[96:99]
    ds_read_b128 v[64:67], v8 offset:12288
    s_waitcnt lgkmcnt(5)
    v_mfma_f32_16x16x32_bf16 v[24:27], v[48:51], v[180:183], v[24:27]
    v_mfma_f32_16x16x32_bf16 v[100:103], v[48:51], v[176:179], v[100:103]
    ds_read_b128 v[40:43], v8 offset:13312
    s_waitcnt lgkmcnt(5)
    v_mfma_f32_16x16x32_bf16 v[28:31], v[52:55], v[180:183], v[28:31]
    buffer_load_dwordx4 v[212:215], v3, s[20:23], s5 offen offset:2048 sc1
    v_mfma_f32_16x16x32_bf16 v[104:107], v[52:55], v[176:179], v[104:107]
    ds_read_b128 v[44:47], v8 offset:14336
    s_waitcnt lgkmcnt(4)
    v_mfma_f32_16x16x32_bf16 v[32:35], v[56:59], v[180:183], v[32:35]
    v_mfma_f32_16x16x32_bf16 v[108:111], v[56:59], v[176:179], v[108:111]
    ds_read_b128 v[48:51], v8 offset:15360
    s_waitcnt vmcnt(7) lgkmcnt(4)
    v_mfma_f32_16x16x32_bf16 v[16:19], v[60:63], v[188:191], v[16:19]
    v_mfma_f32_16x16x32_bf16 v[92:95], v[60:63], v[184:187], v[92:95]
    s_waitcnt lgkmcnt(6)
    v_cmp_gt_u32 vcc, 26, v90
    s_cbranch_vccnz L_ll164
L_ld165:
    ds_read_b128 v[52:55], v8 offset:16384
    s_waitcnt lgkmcnt(4)
    v_mfma_f32_16x16x32_bf16 v[20:23], v[64:67], v[188:191], v[20:23]
    buffer_load_dwordx4 v[216:219], v3, s[20:23], s4 offen offset:3072 sc1
    v_mfma_f32_16x16x32_bf16 v[96:99], v[64:67], v[184:187], v[96:99]
    ds_read_b128 v[56:59], v8 offset:17408
    s_waitcnt lgkmcnt(4)
    v_mfma_f32_16x16x32_bf16 v[24:27], v[40:43], v[188:191], v[24:27]
    v_mfma_f32_16x16x32_bf16 v[100:103], v[40:43], v[184:187], v[100:103]
    ds_read_b128 v[60:63], v8 offset:18432
    s_waitcnt lgkmcnt(4)
    v_mfma_f32_16x16x32_bf16 v[28:31], v[44:47], v[188:191], v[28:31]
    buffer_load_dwordx4 v[220:223], v3, s[20:23], s5 offen offset:3072 sc1
    v_mfma_f32_16x16x32_bf16 v[104:107], v[44:47], v[184:187], v[104:107]
    ds_read_b128 v[64:67], v8 offset:19456
    s_waitcnt lgkmcnt(4)
    v_mfma_f32_16x16x32_bf16 v[32:35], v[48:51], v[188:191], v[32:35]
    v_mfma_f32_16x16x32_bf16 v[108:111], v[48:51], v[184:187], v[108:111]
    ds_read_b128 v[40:43], v8 offset:20480
    s_waitcnt vmcnt(6) lgkmcnt(4)
    v_mfma_f32_16x16x32_bf16 v[16:19], v[52:55], v[196:199], v[16:19]
    v_mfma_f32_16x16x32_bf16 v[92:95], v[52:55], v[192:195], v[92:95]
    ds_read_b128 v[44:47], v8 offset:21504
    s_waitcnt lgkmcnt(4)
    v_mfma_f32_16x16x32_bf16 v[20:23], v[56:59], v[196:199], v[20:23]
    s_waitcnt vmcnt(8)
    v_cmp_gt_u32 vcc, 9, v15
    s_cbranch_vccnz L_pl167
L_pd168:
    s_add_u32 s4, s40, s38
    s_add_u32 s4, s4, 2621440
    buffer_load_dwordx4 v[224:227], v3, s[20:23], s4 offen offset:0 sc1
    v_mfma_f32_16x16x32_bf16 v[96:99], v[56:59], v[192:195], v[96:99]
    ds_read_b128 v[48:51], v8 offset:22528
    s_waitcnt lgkmcnt(4)
    v_mfma_f32_16x16x32_bf16 v[24:27], v[60:63], v[196:199], v[24:27]
    v_mfma_f32_16x16x32_bf16 v[100:103], v[60:63], v[192:195], v[100:103]
    ds_read_b128 v[52:55], v8 offset:23552
    s_waitcnt lgkmcnt(4)
    v_mfma_f32_16x16x32_bf16 v[28:31], v[64:67], v[196:199], v[28:31]
    s_add_u32 s5, s12, s38
    s_add_u32 s5, s5, 2621440
    buffer_load_dwordx4 v[228:231], v3, s[20:23], s5 offen offset:0 sc1
    v_mfma_f32_16x16x32_bf16 v[104:107], v[64:67], v[192:195], v[104:107]
    ds_read_b128 v[56:59], v8 offset:24576
    s_waitcnt lgkmcnt(4)
    v_mfma_f32_16x16x32_bf16 v[32:35], v[40:43], v[196:199], v[32:35]
    v_mfma_f32_16x16x32_bf16 v[108:111], v[40:43], v[192:195], v[108:111]
    ds_read_b128 v[60:63], v8 offset:25600
    s_waitcnt vmcnt(6) lgkmcnt(4)
    v_mfma_f32_16x16x32_bf16 v[16:19], v[44:47], v[204:207], v[16:19]
    v_mfma_f32_16x16x32_bf16 v[92:95], v[44:47], v[200:203], v[92:95]
    ds_read_b128 v[64:67], v8 offset:26624
    s_waitcnt lgkmcnt(4)
    v_mfma_f32_16x16x32_bf16 v[20:23], v[48:51], v[204:207], v[20:23]
    buffer_load_dwordx4 v[232:235], v3, s[20:23], s4 offen offset:1024 sc1
    v_mfma_f32_16x16x32_bf16 v[96:99], v[48:51], v[200:203], v[96:99]
    ds_read_b128 v[40:43], v8 offset:27648
    s_waitcnt lgkmcnt(4)
    v_mfma_f32_16x16x32_bf16 v[24:27], v[52:55], v[204:207], v[24:27]
    v_mfma_f32_16x16x32_bf16 v[100:103], v[52:55], v[200:203], v[100:103]
    ds_read_b128 v[44:47], v8 offset:28672
    s_waitcnt lgkmcnt(4)
    v_mfma_f32_16x16x32_bf16 v[28:31], v[56:59], v[204:207], v[28:31]
    buffer_load_dwordx4 v[236:239], v3, s[20:23], s5 offen offset:1024 sc1
    v_mfma_f32_16x16x32_bf16 v[104:107], v[56:59], v[200:203], v[104:107]
    ds_read_b128 v[48:51], v8 offset:29696
    s_waitcnt lgkmcnt(4)
    v_mfma_f32_16x16x32_bf16 v[32:35], v[60:63], v[204:207], v[32:35]
    v_mfma_f32_16x16x32_bf16 v[108:111], v[60:63], v[200:203], v[108:111]
    ds_read_b32 v90, v254
    ds_read_b128 v[52:55], v8 offset:30720
    s_waitcnt vmcnt(6) lgkmcnt(5)
    v_mfma_f32_16x16x32_bf16 v[16:19], v[64:67], v[212:215], v[16:19]
    v_mfma_f32_16x16x32_bf16 v[92:95], v[64:67], v[208:211], v[92:95]
    ds_read_b128 v[56:59], v8 offset:31744
    s_waitcnt lgkmcnt(5)
    v_mfma_f32_16x16x32_bf16 v[20:23], v[40:43], v[212:215], v[20:23]
    buffer_load_dwordx4 v[240:243], v3, s[20:23], s4 offen offset:2048 sc1
    v_mfma_f32_16x16x32_bf16 v[96:99], v[40:43], v[208:211], v[96:99]
    ds_read_b128 v[60:63], v8 offset:32768
    s_waitcnt lgkmcnt(5)
    v_mfma_f32_16x16x32_bf16 v[24:27], v[44:47], v[212:215], v[24:27]
    v_mfma_f32_16x16x32_bf16 v[100:103], v[44:47], v[208:211], v[100:103]
    ds_read_b128 v[64:67], v8 offset:33792
    s_waitcnt lgkmcnt(5)
    v_mfma_f32_16x16x32_bf16 v[28:31], v[48:51], v[212:215], v[28:31]
    buffer_load_dwordx4 v[244:247], v3, s[20:23], s5 offen offset:2048 sc1
    v_mfma_f32_16x16x32_bf16 v[104:107], v[48:51], v[208:211], v[104:107]
    ds_read_b128 v[40:43], v8 offset:34816
    s_waitcnt lgkmcnt(4)
    v_mfma_f32_16x16x32_bf16 v[32:35], v[52:55], v[212:215], v[32:35]
    v_mfma_f32_16x16x32_bf16 v[108:111], v[52:55], v[208:211], v[108:111]
    ds_read_b128 v[44:47], v8 offset:35840
    s_waitcnt vmcnt(6) lgkmcnt(4)
    v_mfma_f32_16x16x32_bf16 v[16:19], v[56:59], v[220:223], v[16:19]
    v_mfma_f32_16x16x32_bf16 v[92:95], v[56:59], v[216:219], v[92:95]
    s_waitcnt lgkmcnt(6)
    v_cmp_gt_u32 vcc, 27, v90
    s_cbranch_vccnz L_ll170
L_ld171:
    ds_read_b128 v[48:51], v8 offset:36864
    s_waitcnt lgkmcnt(4)
    v_mfma_f32_16x16x32_bf16 v[20:23], v[60:63], v[220:223], v[20:23]
    buffer_load_dwordx4 v[144:147], v3, s[20:23], s4 offen offset:3072 sc1
    v_mfma_f32_16x16x32_bf16 v[96:99], v[60:63], v[216:219], v[96:99]
    ds_read_b128 v[52:55], v8 offset:37888
    s_waitcnt lgkmcnt(4)
    v_mfma_f32_16x16x32_bf16 v[24:27], v[64:67], v[220:223], v[24:27]
    v_mfma_f32_16x16x32_bf16 v[100:103], v[64:67], v[216:219], v[100:103]
    ds_read_b128 v[56:59], v8 offset:38912
    s_waitcnt lgkmcnt(4)
    v_mfma_f32_16x16x32_bf16 v[28:31], v[40:43], v[220:223], v[28:31]
    buffer_load_dwordx4 v[148:151], v3, s[20:23], s5 offen offset:3072 sc1
    v_mfma_f32_16x16x32_bf16 v[104:107], v[40:43], v[216:219], v[104:107]
    ds_read_b128 v[60:63], v8 offset:39936
    s_waitcnt lgkmcnt(4)
    v_mfma_f32_16x16x32_bf16 v[32:35], v[44:47], v[220:223], v[32:35]
    v_mfma_f32_16x16x32_bf16 v[108:111], v[44:47], v[216:219], v[108:111]
    ds_read_b128 v[64:67], v8 offset:40960
    s_waitcnt vmcnt(6) lgkmcnt(4)
    v_mfma_f32_16x16x32_bf16 v[16:19], v[48:51], v[228:231], v[16:19]
    v_mfma_f32_16x16x32_bf16 v[92:95], v[48:51], v[224:227], v[92:95]
    ds_read_b128 v[40:43], v8 offset:41984
    s_waitcnt lgkmcnt(4)
    v_mfma_f32_16x16x32_bf16 v[20:23], v[52:55], v[228:231], v[20:23]
    s_add_u32 s5, s12, s38
    s_add_u32 s5, s5, 2629632
    buffer_load_dwordx4 v[156:159], v3, s[20:23], s5 offen offset:0 sc1
    v_mfma_f32_16x16x32_bf16 v[96:99], v[52:55], v[224:227], v[96:99]
    ds_read_b128 v[44:47], v8 offset:43008
    s_waitcnt lgkmcnt(4)
    v_mfma_f32_16x16x32_bf16 v[24:27], v[56:59], v[228:231], v[24:27]
    v_mfma_f32_16x16x32_bf16 v[100:103], v[56:59], v[224:227], v[100:103]
    ds_read_b128 v[48:51], v8 offset:44032
    s_waitcnt lgkmcnt(4)
    v_mfma_f32_16x16x32_bf16 v[28:31], v[60:63], v[228:231], v[28:31]
    buffer_load_dwordx4 v[164:167], v3, s[20:23], s5 offen offset:1024 sc1
    v_mfma_f32_16x16x32_bf16 v[104:107], v[60:63], v[224:227], v[104:107]
    ds_read_b128 v[52:55], v8 offset:45056
    s_waitcnt lgkmcnt(4)
    v_mfma_f32_16x16x32_bf16 v[32:35], v[64:67], v[228:231], v[32:35]
    v_mfma_f32_16x16x32_bf16 v[108:111], v[64:67], v[224:227], v[108:111]
    ds_read_b128 v[56:59], v8 offset:46080
    s_waitcnt vmcnt(6) lgkmcnt(4)
    v_mfma_f32_16x16x32_bf16 v[16:19], v[40:43], v[236:239], v[16:19]
    v_mfma_f32_16x16x32_bf16 v[92:95], v[40:43], v[232:235], v[92:95]
    ds_read_b128 v[60:63], v8 offset:47104
    s_waitcnt lgkmcnt(4)
    v_mfma_f32_16x16x32_bf16 v[20:23], v[44:47], v[236:239], v[20:23]
    buffer_load_dwordx4 v[172:175], v3, s[20:23], s5 offen offset:2048 sc1
    v_mfma_f32_16x16x32_bf16 v[96:99], v[44:47], v[232:235], v[96:99]
    ds_read_b128 v[64:67], v8 offset:48128
    s_waitcnt lgkmcnt(4)
    v_mfma_f32_16x16x32_bf16 v[24:27], v[48:51], v[236:239], v[24:27]
    v_mfma_f32_16x16x32_bf16 v[100:103], v[48:51], v[232:235], v[100:103]
    ds_read_b128 v[40:43], v8 offset:49152
    s_waitcnt lgkmcnt(4)
    v_mfma_f32_16x16x32_bf16 v[28:31], v[52:55], v[236:239], v[28:31]
    buffer_load_dwordx4 v[180:183], v3, s[20:23], s5 offen offset:3072 sc1
    v_mfma_f32_16x16x32_bf16 v[104:107], v[52:55], v[232:235], v[104:107]
    ds_read_b128 v[44:47], v8 offset:50176
    s_waitcnt lgkmcnt(4)
    v_mfma_f32_16x16x32_bf16 v[32:35], v[56:59], v[236:239], v[32:35]
    s_waitcnt vmcnt(4)
    v_mov_b32 v4, 10
    s_mov_b64 exec, 1
    s_cmp_lg_u32 s24, 0
    s_cbranch_scc1 L_sf173
    buffer_store_dword v4, v2, s[20:23], s34 offen
L_se174:
    s_mov_b64 exec, -1
    v_mfma_f32_16x16x32_bf16 v[108:111], v[56:59], v[232:235], v[108:111]
    ds_read_b32 v90, v254
    ds_read_b128 v[48:51], v8 offset:51200
    s_waitcnt vmcnt(7) lgkmcnt(5)
    v_mfma_f32_16x16x32_bf16 v[16:19], v[60:63], v[244:247], v[16:19]
    v_mfma_f32_16x16x32_bf16 v[92:95], v[60:63], v[240:243], v[92:95]
    ds_read_b128 v[52:55], v8 offset:52224
    s_waitcnt lgkmcnt(5)
    v_mfma_f32_16x16x32_bf16 v[20:23], v[64:67], v[244:247], v[20:23]
    s_add_u32 s5, s12, s11
    buffer_load_dwordx4 v[188:191], v3, s[20:23], s5 offen offset:0 sc1
    v_mfma_f32_16x16x32_bf16 v[96:99], v[64:67], v[240:243], v[96:99]
    ds_read_b128 v[56:59], v8 offset:53248
    s_waitcnt lgkmcnt(5)
    v_mfma_f32_16x16x32_bf16 v[24:27], v[40:43], v[244:247], v[24:27]
    v_mfma_f32_16x16x32_bf16 v[100:103], v[40:43], v[240:243], v[100:103]
    ds_read_b128 v[60:63], v8 offset:54272
    s_waitcnt lgkmcnt(5)
    v_mfma_f32_16x16x32_bf16 v[28:31], v[44:47], v[244:247], v[28:31]
    buffer_load_dwordx4 v[196:199], v3, s[20:23], s5 offen offset:1024 sc1
    v_mfma_f32_16x16x32_bf16 v[104:107], v[44:47], v[240:243], v[104:107]
    ds_read_b128 v[64:67], v8 offset:55296
    s_waitcnt lgkmcnt(4)
    v_mfma_f32_16x16x32_bf16 v[32:35], v[48:51], v[244:247], v[32:35]
    v_mfma_f32_16x16x32_bf16 v[108:111], v[48:51], v[240:243], v[108:111]
    ds_read_b128 v[40:43], v8 offset:56320
    s_waitcnt vmcnt(7) lgkmcnt(4)
    v_mfma_f32_16x16x32_bf16 v[16:19], v[52:55], v[148:151], v[16:19]
    v_mfma_f32_16x16x32_bf16 v[92:95], v[52:55], v[144:147], v[92:95]
    s_waitcnt lgkmcnt(6)
    v_cmp_gt_u32 vcc, 28, v90
    s_cbranch_vccnz L_ll175
L_ld176:
    ds_read_b128 v[44:47], v8 offset:57344
    ds_read_b128 v[48:51], v8 offset:58368
    s_waitcnt lgkmcnt(5)
    v_mfma_f32_16x16x32_bf16 v[20:23], v[56:59], v[148:151], v[20:23]
    buffer_load_dwordx4 v[204:207], v250, s[20:23], s5 offen offset:2048 sc1
    v_mfma_f32_16x16x32_bf16 v[96:99], v[56:59], v[144:147], v[96:99]
    ds_read_b128 v[52:55], v8 offset:59392
    s_waitcnt lgkmcnt(5)
    v_mfma_f32_16x16x32_bf16 v[24:27], v[60:63], v[148:151], v[24:27]
    v_mfma_f32_16x16x32_bf16 v[100:103], v[60:63], v[144:147], v[100:103]
    ds_read_b128 v[56:59], v8 offset:60416
    ds_read_b128 v[60:63], v8 offset:61440
    s_waitcnt lgkmcnt(6)
    v_mfma_f32_16x16x32_bf16 v[28:31], v[64:67], v[148:151], v[28:31]
    buffer_load_dwordx4 v[212:215], v250, s[20:23], s5 offen offset:3072 sc1
    v_mfma_f32_16x16x32_bf16 v[104:107], v[64:67], v[144:147], v[104:107]
    ds_read_b128 v[64:67], v8 offset:62464
    s_waitcnt lgkmcnt(6)
    v_mfma_f32_16x16x32_bf16 v[32:35], v[40:43], v[148:151], v[32:35]
    v_mfma_f32_16x16x32_bf16 v[108:111], v[40:43], v[144:147], v[108:111]
    ds_read_b128 v[40:43], v8 offset:63488
    s_waitcnt vmcnt(8) lgkmcnt(6)
    v_mfma_f32_16x16x32_bf16 v[16:19], v[44:47], v[156:159], v[16:19]
    ds_read_b128 v[44:47], v8 offset:64512
    s_waitcnt lgkmcnt(6)
    v_mfma_f32_16x16x32_bf16 v[20:23], v[48:51], v[156:159], v[20:23]
    s_add_u32 s4, s40, s38
    s_add_u32 s4, s4, 2629632
    buffer_load_dwordx4 v[152:155], v3, s[20:23], s4 offen offset:0 sc1
    ds_read_b128 v[48:51], v9 offset:0
    s_waitcnt lgkmcnt(6)
    v_mfma_f32_16x16x32_bf16 v[24:27], v[52:55], v[156:159], v[24:27]
    ds_read_b128 v[52:55], v9 offset:1024
    s_waitcnt lgkmcnt(6)
    v_mfma_f32_16x16x32_bf16 v[28:31], v[56:59], v[156:159], v[28:31]
    ds_read_b128 v[56:59], v9 offset:2048
    s_waitcnt lgkmcnt(6)
    v_mfma_f32_16x16x32_bf16 v[32:35], v[60:63], v[156:159], v[32:35]
    ds_read_b128 v[60:63], v9 offset:3072
    s_waitcnt vmcnt(8) lgkmcnt(6)
    v_mfma_f32_16x16x32_bf16 v[16:19], v[64:67], v[164:167], v[16:19]
    ds_read_b128 v[64:67], v9 offset:4096
    s_waitcnt lgkmcnt(6)
    v_mfma_f32_16x16x32_bf16 v[20:23], v[40:43], v[164:167], v[20:23]
    buffer_load_dwordx4 v[160:163], v3, s[20:23], s4 offen offset:1024 sc1
    ds_read_b128 v[40:43], v9 offset:5120
    s_waitcnt lgkmcnt(6)
    v_mfma_f32_16x16x32_bf16 v[24:27], v[44:47], v[164:167], v[24:27]
    ds_read_b32 v90, v254
    ds_read_b128 v[44:47], v9 offset:6144
    s_waitcnt lgkmcnt(7)
    v_mfma_f32_16x16x32_bf16 v[28:31], v[48:51], v[164:167], v[28:31]
    ds_read_b128 v[48:51], v9 offset:7168
    s_waitcnt lgkmcnt(7)
    v_mfma_f32_16x16x32_bf16 v[32:35], v[52:55], v[164:167], v[32:35]
    ds_read_b128 v[52:55], v9 offset:8192
    s_waitcnt vmcnt(8) lgkmcnt(7)
    v_mfma_f32_16x16x32_bf16 v[16:19], v[56:59], v[172:175], v[16:19]
    ds_read_b128 v[56:59], v9 offset:9216
    s_waitcnt lgkmcnt(7)
    v_mfma_f32_16x16x32_bf16 v[20:23], v[60:63], v[172:175], v[20:23]
    buffer_load_dwordx4 v[168:171], v3, s[20:23], s4 offen offset:2048 sc1
    ds_read_b128 v[60:63], v9 offset:10240
    s_waitcnt lgkmcnt(7)
    v_mfma_f32_16x16x32_bf16 v[24:27], v[64:67], v[172:175], v[24:27]
    ds_read_b128 v[64:67], v9 offset:11264
    s_waitcnt lgkmcnt(7)
    v_mfma_f32_16x16x32_bf16 v[28:31], v[40:43], v[172:175], v[28:31]
    s_waitcnt lgkmcnt(6)
    v_cmp_gt_u32 vcc, 29, v90
    s_cbranch_vccnz L_ll178
L_ld179:
    ds_read_b128 v[40:43], v3 offset:0
    s_waitcnt lgkmcnt(6)
    v_mfma_f32_16x16x32_bf16 v[32:35], v[44:47], v[172:175], v[32:35]
    ds_read_b128 v[44:47], v3 offset:1024
    s_waitcnt vmcnt(8) lgkmcnt(6)
    v_mfma_f32_16x16x32_bf16 v[16:19], v[48:51], v[180:183], v[16:19]
    ds_read_b128 v[48:51], v3 offset:2048
    s_waitcnt lgkmcnt(6)
    v_mfma_f32_16x16x32_bf16 v[20:23], v[52:55], v[180:183], v[20:23]
    buffer_load_dwordx4 v[176:179], v3, s[20:23], s4 offen offset:3072 sc1
    ds_read_b128 v[52:55], v3 offset:3072
    s_waitcnt lgkmcnt(6)
    v_mfma_f32_16x16x32_bf16 v[24:27], v[56:59], v[180:183], v[24:27]
    ds_read_b128 v[56:59], v3 offset:4096
    s_waitcnt lgkmcnt(6)
    v_mfma_f32_16x16x32_bf16 v[28:31], v[60:63], v[180:183], v[28:31]
    buffer_load_dword v15, v14, s[20:23], s33 offen sc1
    ds_read_b128 v[60:63], v3 offset:5120
    s_waitcnt lgkmcnt(6)
    v_mfma_f32_16x16x32_bf16 v[32:35], v[64:67], v[180:183], v[32:35]
    ds_read_b128 v[64:67], v3 offset:6144
    s_waitcnt vmcnt(8) lgkmcnt(6)
    v_mfma_f32_16x16x32_bf16 v[16:19], v[40:43], v[188:191], v[16:19]
    ds_read_b128 v[40:43], v3 offset:7168
    s_waitcnt lgkmcnt(6)
    v_mfma_f32_16x16x32_bf16 v[20:23], v[44:47], v[188:191], v[20:23]
    s_add_u32 s4, s40, s11
    buffer_load_dwordx4 v[184:187], v3, s[20:23], s4 offen offset:0 sc1
    ds_read_b128 v[44:47], v3 offset:8192
    s_waitcnt lgkmcnt(6)
    v_mfma_f32_16x16x32_bf16 v[24:27], v[48:51], v[188:191], v[24:27]
    ds_read_b128 v[48:51], v3 offset:9216
    s_waitcnt lgkmcnt(6)
    v_mfma_f32_16x16x32_bf16 v[28:31], v[52:55], v[188:191], v[28:31]
    ds_read_b128 v[52:55], v3 offset:10240
    s_waitcnt lgkmcnt(6)
    v_mfma_f32_16x16x32_bf16 v[32:35], v[56:59], v[188:191], v[32:35]
    ds_read_b128 v[56:59], v3 offset:11264
    s_waitcnt vmcnt(8) lgkmcnt(6)
    v_mfma_f32_16x16x32_bf16 v[16:19], v[60:63], v[196:199], v[16:19]
    ds_read_b128 v[60:63], v3 offset:12288
    s_waitcnt lgkmcnt(6)
    v_mfma_f32_16x16x32_bf16 v[20:23], v[64:67], v[196:199], v[20:23]
    buffer_load_dwordx4 v[192:195], v3, s[20:23], s4 offen offset:1024 sc1
    ds_read_b128 v[64:67], v3 offset:13312
    s_waitcnt lgkmcnt(6)
    v_mfma_f32_16x16x32_bf16 v[24:27], v[40:43], v[196:199], v[24:27]
    ds_read_b128 v[40:43], v3 offset:14336
    s_waitcnt lgkmcnt(6)
    v_mfma_f32_16x16x32_bf16 v[28:31], v[44:47], v[196:199], v[28:31]
    ds_read_b128 v[44:47], v3 offset:15360
    s_waitcnt lgkmcnt(6)
    v_mfma_f32_16x16x32_bf16 v[32:35], v[48:51], v[196:199], v[32:35]
    ds_read_b128 v[48:51], v3 offset:16384
    s_waitcnt vmcnt(8) lgkmcnt(6)
    v_mfma_f32_16x16x32_bf16 v[16:19], v[52:55], v[204:207], v[16:19]
    ds_read_b128 v[52:55], v3 offset:17408
    s_waitcnt lgkmcnt(6)
    v_mfma_f32_16x16x32_bf16 v[20:23], v[56:59], v[204:207], v[20:23]
    buffer_load_dwordx4 v[200:203], v250, s[20:23], s4 offen offset:2048 sc1
    ds_read_b128 v[56:59], v3 offset:18432
    s_waitcnt lgkmcnt(6)
    v_mfma_f32_16x16x32_bf16 v[24:27], v[60:63], v[204:207], v[24:27]
    ds_read_b128 v[60:63], v3 offset:19456
    s_waitcnt lgkmcnt(6)
    v_mfma_f32_16x16x32_bf16 v[28:31], v[64:67], v[204:207], v[28:31]
    ds_read_b128 v[64:67], v8 offset:57344
    s_waitcnt lgkmcnt(6)
    v_mfma_f32_16x16x32_bf16 v[32:35], v[40:43], v[204:207], v[32:35]
    ds_read_b128 v[40:43], v8 offset:58368
    s_waitcnt vmcnt(8) lgkmcnt(6)
    v_mfma_f32_16x16x32_bf16 v[16:19], v[44:47], v[212:215], v[16:19]
    ds_read_b128 v[44:47], v8 offset:59392
    s_waitcnt lgkmcnt(6)
    v_mfma_f32_16x16x32_bf16 v[20:23], v[48:51], v[212:215], v[20:23]
    buffer_load_dwordx4 v[208:211], v250, s[20:23], s4 offen offset:3072 sc1
    ds_read_b128 v[48:51], v8 offset:60416
    s_waitcnt lgkmcnt(6)
    v_mfma_f32_16x16x32_bf16 v[24:27], v[52:55], v[212:215], v[24:27]
    ds_read_b128 v[52:55], v8 offset:61440
    s_waitcnt lgkmcnt(6)
    v_mfma_f32_16x16x32_bf16 v[28:31], v[56:59], v[212:215], v[28:31]
    ds_read_b128 v[56:59], v8 offset:62464
    s_waitcnt lgkmcnt(6)
    v_mfma_f32_16x16x32_bf16 v[32:35], v[60:63], v[212:215], v[32:35]
    ds_read_b128 v[60:63], v8 offset:63488
    s_waitcnt vmcnt(8) lgkmcnt(6)
    v_mfma_f32_16x16x32_bf16 v[92:95], v[64:67], v[152:155], v[92:95]
    ds_read_b128 v[64:67], v8 offset:64512
    s_waitcnt lgkmcnt(6)
    v_mfma_f32_16x16x32_bf16 v[96:99], v[40:43], v[152:155], v[96:99]
    ds_read_b128 v[40:43], v9 offset:0
    s_waitcnt lgkmcnt(6)
    v_mfma_f32_16x16x32_bf16 v[100:103], v[44:47], v[152:155], v[100:103]
    s_waitcnt vmcnt(4)
    v_cmp_gt_u32 vcc, 10, v15
    s_cbranch_vccnz L_pl181
L_pd182:
    s_add_u32 s44, s12, s45
    s_add_u32 s5, s44, 2621440
    s_add_u32 s4, s44, 5242880
    s_add_u32 s43, s4, 8192
    s_add_u32 s38, s44, 8192
    s_add_u32 s44, s44, 0
    s_cmp_lg_u32 s24, 0
    s_cbranch_scc1 L_sf184
    buffer_store_dwordx4 v[16:19], v3, s[20:23], s4 offen
    buffer_store_dwordx4 v[20:23], v3, s[20:23], s43 offen
    buffer_store_dwordx4 v[24:27], v3, s[20:23], s44 offen
    buffer_store_dwordx4 v[28:31], v3, s[20:23], s38 offen
    buffer_store_dwordx4 v[32:35], v3, s[20:23], s5 offen
L_se185:
    ds_read_b128 v[44:47], v9 offset:1024
    s_waitcnt lgkmcnt(6)
    v_mfma_f32_16x16x32_bf16 v[104:107], v[48:51], v[152:155], v[104:107]
    ds_read_b128 v[48:51], v9 offset:2048
    s_waitcnt lgkmcnt(6)
    v_mfma_f32_16x16x32_bf16 v[108:111], v[52:55], v[152:155], v[108:111]
    ds_read_b128 v[52:55], v9 offset:3072
    s_waitcnt vmcnt(12) lgkmcnt(6)
    v_mfma_f32_16x16x32_bf16 v[92:95], v[56:59], v[160:163], v[92:95]
    ds_read_b128 v[56:59], v9 offset:4096
    s_waitcnt lgkmcnt(6)
    v_mfma_f32_16x16x32_bf16 v[96:99], v[60:63], v[160:163], v[96:99]
    ds_read_b128 v[60:63], v9 offset:5120
    s_waitcnt lgkmcnt(6)
    v_mfma_f32_16x16x32_bf16 v[100:103], v[64:67], v[160:163], v[100:103]
    ds_read_b128 v[64:67], v9 offset:6144
    s_waitcnt lgkmcnt(6)
    v_mfma_f32_16x16x32_bf16 v[104:107], v[40:43], v[160:163], v[104:107]
    ds_read_b128 v[40:43], v9 offset:7168
    s_waitcnt lgkmcnt(6)
    v_mfma_f32_16x16x32_bf16 v[108:111], v[44:47], v[160:163], v[108:111]
    ds_read_b128 v[44:47], v9 offset:8192
    s_waitcnt vmcnt(11) lgkmcnt(6)
    v_mfma_f32_16x16x32_bf16 v[92:95], v[48:51], v[168:171], v[92:95]
    ds_read_b128 v[48:51], v9 offset:9216
    s_waitcnt lgkmcnt(6)
    v_mfma_f32_16x16x32_bf16 v[96:99], v[52:55], v[168:171], v[96:99]
    ds_read_b128 v[52:55], v9 offset:10240
    s_waitcnt lgkmcnt(6)
    v_mfma_f32_16x16x32_bf16 v[100:103], v[56:59], v[168:171], v[100:103]
    ds_read_b128 v[56:59], v9 offset:11264
    s_waitcnt lgkmcnt(6)
    v_mfma_f32_16x16x32_bf16 v[104:107], v[60:63], v[168:171], v[104:107]
    ds_read_b128 v[60:63], v3 offset:0
    s_waitcnt lgkmcnt(6)
    v_mfma_f32_16x16x32_bf16 v[108:111], v[64:67], v[168:171], v[108:111]
    ds_read_b128 v[64:67], v3 offset:1024
    s_waitcnt vmcnt(10) lgkmcnt(6)
    v_mfma_f32_16x16x32_bf16 v[92:95], v[40:43], v[176:179], v[92:95]
    ds_read_b128 v[40:43], v3 offset:2048
    s_waitcnt lgkmcnt(6)
    v_mfma_f32_16x16x32_bf16 v[96:99], v[44:47], v[176:179], v[96:99]
    ds_read_b128 v[44:47], v3 offset:3072
    s_waitcnt lgkmcnt(6)
    v_mfma_f32_16x16x32_bf16 v[100:103], v[48:51], v[176:179], v[100:103]
    ds_read_b128 v[48:51], v3 offset:4096
    s_waitcnt lgkmcnt(6)
    v_mfma_f32_16x16x32_bf16 v[104:107], v[52:55], v[176:179], v[104:107]
    ds_read_b128 v[52:55], v3 offset:5120
    s_waitcnt lgkmcnt(6)
    v_mfma_f32_16x16x32_bf16 v[108:111], v[56:59], v[176:179], v[108:111]
    ds_read_b128 v[56:59], v3 offset:6144
    s_waitcnt vmcnt(8) lgkmcnt(6)
    v_mfma_f32_16x16x32_bf16 v[92:95], v[60:63], v[184:187], v[92:95]
    ds_read_b128 v[60:63], v3 offset:7168
    s_waitcnt lgkmcnt(6)
    v_mfma_f32_16x16x32_bf16 v[96:99], v[64:67], v[184:187], v[96:99]
    ds_read_b128 v[64:67], v3 offset:8192
    s_waitcnt lgkmcnt(6)
    v_mfma_f32_16x16x32_bf16 v[100:103], v[40:43], v[184:187], v[100:103]
    ds_read_b128 v[40:43], v3 offset:9216
    s_waitcnt lgkmcnt(6)
    v_mfma_f32_16x16x32_bf16 v[104:107], v[44:47], v[184:187], v[104:107]
    ds_read_b128 v[44:47], v3 offset:10240
    s_waitcnt lgkmcnt(6)
    v_mfma_f32_16x16x32_bf16 v[108:111], v[48:51], v[184:187], v[108:111]
    s_waitcnt vmcnt(0)
    v_mov_b32 v4, 11
    s_mov_b64 exec, 1
    s_cmp_lg_u32 s24, 0
    s_cbranch_scc1 L_sf186
    buffer_store_dword v4, v2, s[20:23], s34 offen
L_se187:
    s_mov_b64 exec, -1
    s_add_u32 s44, s40, s45
    s_add_u32 s5, s44, 2621440
    s_add_u32 s4, s44, 5242880
    s_add_u32 s43, s4, 8192
    s_add_u32 s38, s44, 8192
    s_add_u32 s44, s44, 0
    ds_read_b128 v[48:51], v3 offset:11264
    s_waitcnt vmcnt(8) lgkmcnt(6)
    v_mfma_f32_16x16x32_bf16 v[92:95], v[52:55], v[192:195], v[92:95]
    ds_read_b128 v[52:55], v3 offset:12288
    s_waitcnt lgkmcnt(6)
    v_mfma_f32_16x16x32_bf16 v[96:99], v[56:59], v[192:195], v[96:99]
    ds_read_b128 v[56:59], v3 offset:13312
    s_waitcnt lgkmcnt(6)
    v_mfma_f32_16x16x32_bf16 v[100:103], v[60:63], v[192:195], v[100:103]
    ds_read_b128 v[60:63], v3 offset:14336
    s_waitcnt lgkmcnt(6)
    v_mfma_f32_16x16x32_bf16 v[104:107], v[64:67], v[192:195], v[104:107]
    ds_read_b128 v[64:67], v3 offset:15360
    s_waitcnt lgkmcnt(6)
    v_mfma_f32_16x16x32_bf16 v[108:111], v[40:43], v[192:195], v[108:111]
    ds_read_b128 v[40:43], v3 offset:16384
    s_waitcnt vmcnt(7) lgkmcnt(6)
    v_mfma_f32_16x16x32_bf16 v[92:95], v[44:47], v[200:203], v[92:95]
    ds_read_b128 v[44:47], v3 offset:17408
    s_waitcnt lgkmcnt(6)
    v_mfma_f32_16x16x32_bf16 v[96:99], v[48:51], v[200:203], v[96:99]
    ds_read_b128 v[48:51], v3 offset:18432
    s_waitcnt lgkmcnt(6)
    v_mfma_f32_16x16x32_bf16 v[100:103], v[52:55], v[200:203], v[100:103]
    ds_read_b128 v[52:55], v3 offset:19456
    s_waitcnt lgkmcnt(6)
    v_mfma_f32_16x16x32_bf16 v[104:107], v[56:59], v[200:203], v[104:107]
    s_waitcnt lgkmcnt(5)
    v_mfma_f32_16x16x32_bf16 v[108:111], v[60:63], v[200:203], v[108:111]
    s_waitcnt vmcnt(6) lgkmcnt(4)
    v_mfma_f32_16x16x32_bf16 v[92:95], v[64:67], v[208:211], v[92:95]
    s_waitcnt lgkmcnt(3)
    v_mfma_f32_16x16x32_bf16 v[96:99], v[40:43], v[208:211], v[96:99]
    s_waitcnt lgkmcnt(2)
    v_mfma_f32_16x16x32_bf16 v[100:103], v[44:47], v[208:211], v[100:103]
    s_waitcnt lgkmcnt(1)
    v_mfma_f32_16x16x32_bf16 v[104:107], v[48:51], v[208:211], v[104:107]
    s_waitcnt lgkmcnt(0)
    v_mfma_f32_16x16x32_bf16 v[108:111], v[52:55], v[208:211], v[108:111]
    buffer_load_dword v15, v2, s[20:23], s8 offen sc1
    s_waitcnt vmcnt(0)
    v_cmp_gt_u32 vcc, 11, v15
    s_cbranch_vccnz L_pl188
L_pd189:
    buffer_load_dwordx4 v[16:19], v3, s[20:23], s4 offen sc1
    buffer_load_dwordx4 v[20:23], v3, s[20:23], s43 offen sc1
    buffer_load_dwordx4 v[24:27], v3, s[20:23], s44 offen sc1
    buffer_load_dwordx4 v[28:31], v3, s[20:23], s38 offen sc1
    buffer_load_dwordx4 v[32:35], v3, s[20:23], s5 offen sc1
    s_mul_i32 s46, s30, 3072
    s_add_u32 s46, s46, 143360
    v_add_u32 v10, s46, v3
    s_lshl_b32 s43, s35, 6
    s_add_u32 s43, s43, s40
    s_lshl_b32 s44, s36, 6
    s_add_u32 s44, s44, s40
    s_lshl_b32 s45, s37, 3
    s_add_u32 s44, s44, s45
    s_waitcnt vmcnt(4)
    v_pk_add_f32 v[92:93], v[92:93], v[16:17]
    v_pk_add_f32 v[94:95], v[94:95], v[18:19]
    s_waitcnt vmcnt(3)
    v_pk_add_f32 v[96:97], v[96:97], v[20:21]
    v_pk_add_f32 v[98:99], v[98:99], v[22:23]
    s_waitcnt vmcnt(2)
    v_pk_add_f32 v[100:101], v[100:101], v[24:25]
    v_pk_add_f32 v[102:103], v[102:103], v[26:27]
    s_waitcnt vmcnt(1)
    v_pk_add_f32 v[104:105], v[104:105], v[28:29]
    v_pk_add_f32 v[106:107], v[106:107], v[30:31]
    s_waitcnt vmcnt(0)
    v_pk_add_f32 v[108:109], v[108:109], v[32:33]
    v_pk_add_f32 v[110:111], v[110:111], v[34:35]
    v_cvt_pk_bf16_f32 v132, v92, v93
    v_cvt_pk_bf16_f32 v133, v94, v95
    v_cvt_pk_bf16_f32 v134, v96, v97
    v_cvt_pk_bf16_f32 v135, v98, v99
    v_cvt_pk_bf16_f32 v136, v100, v101
    v_cvt_pk_bf16_f32 v137, v102, v103
    v_cvt_pk_bf16_f32 v138, v104, v105
    v_cvt_pk_bf16_f32 v139, v106, v107
    v_cvt_pk_bf16_f32 v140, v108, v109
    v_cvt_pk_bf16_f32 v141, v110, v111
    ds_write_b128 v5, v[132:135]
    ds_write_b128 v5, v[136:139] offset:1024
    ds_write_b64 v5, v[140:141] offset:2048
    ds_read_b128 v[112:115], v10
    ds_read_b128 v[116:119], v10 offset:1024
    ds_read_b64 v[120:121], v10 offset:2048
    s_waitcnt lgkmcnt(2)
    buffer_store_dwordx4 v[112:115], v248, s[16:19], s43 offen
    s_waitcnt lgkmcnt(1)
    buffer_store_dwordx4 v[116:119], v248, s[16:19], s43 offen offset:64
    s_waitcnt lgkmcnt(0)
    buffer_store_dwordx2 v[120:121], v248, s[16:19], s44 offen
    s_endpgm
L_loader:
    s_and_b32 s25, s2, 7
    s_lshr_b32 s26, s2, 3
    s_and_b32 s27, s26, 3
    s_lshl_b32 s28, s25, 2
    s_add_u32 s27, s27, s28
    s_lshr_b32 s28, s2, 5
    s_and_b32 s29, s30, 3
    s_lshl_b32 s43, s27, 2
    s_add_u32 s29, s29, s43
    s_mul_i32 s34, s28, 5
    s_and_b32 s37, s28, 1
    s_lshr_b32 s35, s34, 1
    s_add_u32 s36, s35, 2
    s_lshl_b32 s43, s37, 1
    s_sub_u32 s36, s36, s43
    s_add_u32 s35, s35, s37
    v_lshlrev_b32 v3, 4, v1
    s_sub_u32 s33, s30, 4
    s_mul_i32 s32, s28, 880640
    s_add_u32 s32, s32, 10752000
    s_mul_i32 s39, s33, 5120
    s_add_u32 s38, s32, s39
    s_mul_i32 s10, s26, 10240
    s_lshr_b32 s43, s33, 1
    s_add_u32 s43, s43, s25
    s_max_u32 s43, s43, 1
    s_sub_u32 s43, s43, 1
    s_lshl_b32 s8, s43, 1
    s_mul_i32 s43, s43, 327680
    s_add_u32 s10, s10, s43
    s_and_b32 s43, s33, 1
    s_add_u32 s8, s8, s43
    s_lshl_b32 s8, s8, 4
    s_mul_i32 s9, s26, 20
    s_lshr_b32 s16, s9, 7
    s_add_u32 s9, s9, 19
    s_lshr_b32 s9, s9, 7
    s_sub_u32 s9, s9, s16
    s_lshl_b32 s9, s9, 7
    s_add_u32 s8, s8, s16
    s_lshl_b32 s8, s8, 7
    s_add_u32 s8, s8, 18173184
    s_mul_i32 s43, s43, 5120
    s_add_u32 s10, s10, s43
    s_add_u32 s11, s39, 102400
    v_and_b32 v4, 3, v1
    v_lshlrev_b32 v4, 2, v4
    v_add_u32 v4, 161888, v4
    s_lshl_b32 s43, s33, 2
    s_add_u32 s43, s43, 161888
    v_mov_b32 v5, s43
    v_add_u32 v12, s39, v3
    v_add_u32 v13, 0x10000, v12
    v_add_u32 v14, 0x20000, v12
    v_lshrrev_b32 v15, 2, v1
    v_mul_u32_u24 v15, 1280, v15
    v_and_b32 v8, 3, v1
    v_lshl_add_u32 v15, v8, 4, v15
    s_mul_i32 s40, s28, 5
    s_lshr_b32 s40, s40, 2
    s_lshl_b32 s41, s40, 9
    s_add_u32 s41, s41, 18136064
    s_lshl_b32 s42, s40, 10
    s_add_u32 s42, s42, 18156672
    s_mul_i32 s44, s28, 7
    s_cmp_eq_u32 s28, 7
    s_subb_u32 s44, s44, 0
    s_lshr_b32 s40, s44, 1
    s_min_u32 s40, s40, 22
    s_mul_i32 s40, s40, 384
    s_add_u32 s40, s40, 18146304
    s_add_u32 s31, s25, 1
    s_min_u32 s31, s31, 7
    s_lshl_b32 s31, s31, 5
    s_and_b32 s43, s27, 3
    s_lshl_b32 s43, s43, 3
    s_max_u32 s43, s43, 2
    s_sub_u32 s43, s43, 2
    s_min_u32 s43, s43, 20
    s_add_u32 s31, s31, s43
    s_lshl_b32 s31, s31, 7
    s_add_u32 s31, s31, 18171968
    s_mov_b32 s12, s4
    s_and_b32 s13, s5, 0xffff
    s_mov_b32 s14, 2621440
    s_mov_b32 s15, 0x20000
    s_cmp_lg_u32 s33, 0
    s_cbranch_scc1 L_ct191
    s_sub_u32 s43, s26, 0
    s_and_b32 s43, s43, 31
    s_lshl_b32 s43, s43, 12
    s_cmp_ge_u32 s43, L_code_end-L_k2
    s_cbranch_scc1 L_ct191
    s_getpc_b64 s[66:67]
L_pc192:
    s_sub_u32 s66, s66, L_pc192-L_k2
    s_subb_u32 s67, s67, 0
    v_lshl_add_u32 v32, v1, 6, s43
    v_min_u32 v32, L_code_end-L_k2-4, v32
    v_mov_b32 v33, s67
    v_add_co_u32 v32, vcc, s66, v32
    s_nop 1
    v_addc_co_u32 v33, vcc, 0, v33, vcc
    global_load_dword v34, v[32:33], off
L_ct191:
    s_barrier
    s_add_u32 m0, s11, 0
    s_add_u32 s43, s10, 2621440
    buffer_load_dwordx4 v3, s[20:23], s43 offen offset:0 sc1 lds
    buffer_load_dwordx4 v3, s[20:23], s43 offen offset:1024 sc1 lds
    buffer_load_dwordx4 v3, s[20:23], s43 offen offset:2048 sc1 lds
    buffer_load_dwordx4 v3, s[20:23], s43 offen offset:3072 sc1 lds
    s_add_u32 m0, s11, 4096
    s_add_u32 s43, s10, 2625536
    buffer_load_dwordx4 v3, s[20:23], s43 offen sc1 lds
    s_waitcnt vmcnt(0)
    v_mov_b32 v10, 1
    ds_write_b32 v5, v10
    s_add_u32 m0, s11, 20480
    s_add_u32 s43, s10, 5242880
    buffer_load_dwordx4 v3, s[20:23], s43 offen offset:0 sc1 lds
    buffer_load_dwordx4 v3, s[20:23], s43 offen offset:1024 sc1 lds
    buffer_load_dwordx4 v3, s[20:23], s43 offen offset:2048 sc1 lds
    buffer_load_dwordx4 v3, s[20:23], s43 offen offset:3072 sc1 lds
    s_add_u32 m0, s11, 24576
    s_add_u32 s43, s10, 5246976
    buffer_load_dwordx4 v3, s[20:23], s43 offen sc1 lds
    s_buffer_load_dword s48, s[20:23], s41 offset:0
    s_buffer_load_dword s49, s[20:23], s41 offset:128
    s_buffer_load_dword s50, s[20:23], s41 offset:256
    s_buffer_load_dword s51, s[20:23], s41 offset:384
    s_buffer_load_dword s52, s[20:23], s41 offset:512
    s_buffer_load_dword s53, s[20:23], s41 offset:640
    s_buffer_load_dword s54, s[20:23], s41 offset:768
    s_buffer_load_dword s55, s[20:23], s41 offset:896
    s_waitcnt vmcnt(0)
    v_mov_b32 v10, 2
    ds_write_b32 v5, v10
    s_mul_i32 s45, s33, 13312
    s_add_u32 s45, s45, 49152
    s_add_u32 s46, s45, s32
    s_add_u32 m0, s45, 0
    s_add_u32 s43, s46, 0
    buffer_load_dwordx4 v3, s[20:23], s43 offen offset:0 sc1 lds
    buffer_load_dwordx4 v3, s[20:23], s43 offen offset:1024 sc1 lds
    buffer_load_dwordx4 v3, s[20:23], s43 offen offset:2048 sc1 lds
    buffer_load_dwordx4 v3, s[20:23], s43 offen offset:3072 sc1 lds
    s_add_u32 m0, s45, 4096
    s_add_u32 s43, s46, 4096
    buffer_load_dwordx4 v3, s[20:23], s43 offen offset:0 sc1 lds
    buffer_load_dwordx4 v3, s[20:23], s43 offen offset:1024 sc1 lds
    buffer_load_dwordx4 v3, s[20:23], s43 offen offset:2048 sc1 lds
    buffer_load_dwordx4 v3, s[20:23], s43 offen offset:3072 sc1 lds
    s_add_u32 m0, s45, 8192
    s_add_u32 s43, s46, 8192
    buffer_load_dwordx4 v3, s[20:23], s43 offen offset:0 sc1 lds
    buffer_load_dwordx4 v3, s[20:23], s43 offen offset:1024 sc1 lds
    buffer_load_dwordx4 v3, s[20:23], s43 offen offset:2048 sc1 lds
    buffer_load_dwordx4 v3, s[20:23], s43 offen offset:3072 sc1 lds
    s_add_u32 m0, s45, 12288
    s_add_u32 s43, s46, 12288
    buffer_load_dwordx4 v3, s[20:23], s43 offen offset:0 sc1 lds
    s_mul_i32 s46, s29, 20480
    s_lshl_b32 s43, s35, 6
    s_add_u32 s43, s43, s46
    s_mul_i32 s45, s33, 3072
    s_add_u32 m0, s45, 143360
    s_nop 0
    buffer_load_dwordx4 v15, s[12:15], s43 offen lds
    s_add_u32 m0, s45, 144384
    s_add_u32 s43, s43, 64
    buffer_load_dwordx4 v15, s[12:15], s43 offen lds
    s_lshl_b32 s43, s36, 6
    s_add_u32 s43, s43, s46
    s_add_u32 m0, s45, 145408
    s_nop 0
    buffer_load_dwordx4 v15, s[12:15], s43 offen lds
    s_waitcnt lgkmcnt(0)
    s_min_u32 s48, s48, s49
    s_min_u32 s48, s48, s50
    s_min_u32 s48, s48, s51
    s_min_u32 s48, s48, s52
    s_min_u32 s48, s48, s53
    s_min_u32 s48, s48, s54
    s_min_u32 s48, s48, s55
    s_cmp_lt_u32 s48, 1
    s_cbranch_scc1 L_zr197
L_zq196:
    s_buffer_load_dword s64, s[20:23], s40 offset:0
    s_buffer_load_dword s65, s[20:23], s40 offset:128
    s_buffer_load_dword s66, s[20:23], s40 offset:256
    s_buffer_load_dword s67, s[20:23], s40 offset:384
    s_buffer_load_dword s68, s[20:23], s40 offset:512
    s_buffer_load_dword s69, s[20:23], s40 offset:640
    s_buffer_load_dword s70, s[20:23], s40 offset:768
    s_buffer_load_dword s71, s[20:23], s40 offset:896
    s_buffer_load_dword s72, s[20:23], s40 offset:1024
    s_buffer_load_dword s73, s[20:23], s40 offset:1152
    s_buffer_load_dword s74, s[20:23], s40 offset:1280
    s_buffer_load_dword s75, s[20:23], s40 offset:1408
    s_buffer_load_dword s76, s[20:23], s40 offset:1536
    s_buffer_load_dword s77, s[20:23], s40 offset:1664
    s_buffer_load_dword s78, s[20:23], s40 offset:1792
    s_and_b32 s43, s27, 1
    s_mul_i32 s7, s43, 20480
    s_mul_i32 s6, s7, 7
    s_add_u32 s6, s6, s38
    s_add_u32 s7, s7, s38
    s_lshr_b32 s17, s33, 1
    s_and_b32 s17, s17, s43
    s_mul_i32 s17, s17, 10240
    s_sub_u32 s17, s7, s17
    s_add_u32 s43, s38, 102400
    buffer_load_dwordx4 v[36:39], v3, s[20:23], s43 offen offset:0 sc1
    buffer_load_dwordx4 v[40:43], v3, s[20:23], s43 offen offset:1024 sc1
    buffer_load_dwordx4 v[44:47], v3, s[20:23], s43 offen offset:2048 sc1
    buffer_load_dwordx4 v[48:51], v3, s[20:23], s43 offen offset:3072 sc1
    s_add_u32 s43, s38, 106496
    buffer_load_dwordx4 v[52:55], v3, s[20:23], s43 offen offset:0 sc1
    s_waitcnt lgkmcnt(0)
    s_min_u32 s64, s64, s65
    s_min_u32 s64, s64, s66
    s_min_u32 s64, s64, s67
    s_min_u32 s64, s64, s68
    s_min_u32 s64, s64, s69
    s_min_u32 s64, s64, s70
    s_min_u32 s64, s64, s71
    s_min_u32 s64, s64, s72
    s_min_u32 s64, s64, s73
    s_min_u32 s64, s64, s74
    s_min_u32 s64, s64, s75
    s_min_u32 s64, s64, s76
    s_min_u32 s64, s64, s77
    s_min_u32 s64, s64, s78
    s_cmp_lt_u32 s64, 1
    s_cbranch_scc1 L_zr203
L_zq202:
    s_buffer_load_dword s56, s[20:23], s41 offset:5120
    s_buffer_load_dword s57, s[20:23], s41 offset:5248
    s_buffer_load_dword s58, s[20:23], s41 offset:5376
    s_buffer_load_dword s59, s[20:23], s41 offset:5504
    s_buffer_load_dword s60, s[20:23], s41 offset:5632
    s_buffer_load_dword s61, s[20:23], s41 offset:5760
    s_buffer_load_dword s62, s[20:23], s41 offset:5888
    s_buffer_load_dword s63, s[20:23], s41 offset:6016
    s_cmp_ge_u32 s30, 6
    s_cbranch_scc1 L_nocs
    s_lshl_b32 s44, s44, 7
    s_add_u32 s44, s44, 17809408
    s_mov_b32 s45, 8192
    s_mov_b32 s46, 156672
    s_cmp_eq_u32 s30, 5
    s_cbranch_scc1 L_cs1
    s_mul_i32 s44, s28, 320
    s_add_u32 s44, s44, 17797120
    s_mov_b32 s45, 2560
    s_mov_b32 s46, 155648
L_cs1:
    s_lshl_b32 s43, s33, 30
    v_add_u32 v9, s43, v3
    buffer_load_dwordx4 v[16:19], v3, s[20:23], s44 offen sc1
    s_add_u32 s44, s44, s45
    buffer_load_dwordx4 v[20:23], v3, s[20:23], s44 offen sc1
    s_add_u32 s44, s44, s45
    buffer_load_dwordx4 v[24:27], v3, s[20:23], s44 offen sc1
    s_add_u32 s44, s44, s45
    buffer_load_dwordx4 v[28:31], v9, s[20:23], s44 offen sc1
    s_add_u32 s44, s44, s45
L_nocs:
    s_add_u32 s43, s38, 122880
    buffer_load_dwordx4 v[56:59], v3, s[20:23], s43 offen offset:0 sc1
    buffer_load_dwordx4 v[60:63], v3, s[20:23], s43 offen offset:1024 sc1
    buffer_load_dwordx4 v[64:67], v3, s[20:23], s43 offen offset:2048 sc1
    buffer_load_dwordx4 v[68:71], v3, s[20:23], s43 offen offset:3072 sc1
    s_add_u32 s43, s38, 126976
    buffer_load_dwordx4 v[72:75], v3, s[20:23], s43 offen offset:0 sc1
    s_add_u32 s43, s38, 143360
    buffer_load_dwordx4 v[76:79], v3, s[20:23], s43 offen offset:0 sc1
    buffer_load_dwordx4 v[80:83], v3, s[20:23], s43 offen offset:1024 sc1
    buffer_load_dwordx4 v[84:87], v3, s[20:23], s43 offen offset:2048 sc1
    buffer_load_dwordx4 v[88:91], v3, s[20:23], s43 offen offset:3072 sc1
    s_add_u32 s43, s38, 147456
    buffer_load_dwordx4 v[92:95], v3, s[20:23], s43 offen offset:0 sc1
    s_waitcnt vmcnt(5)
    s_cmp_ge_u32 s30, 6
    s_cbranch_scc1 L_nocs2
    v_add_u32 v8, s46, v3
    v_add_f32 v16, v16, v20
    v_add_f32 v24, v24, v28
    v_add_f32 v17, v17, v21
    v_add_f32 v25, v25, v29
    v_add_f32 v18, v18, v22
    v_add_f32 v26, v26, v30
    v_add_f32 v19, v19, v23
    v_add_f32 v27, v27, v31
    v_add_f32 v16, v16, v24
    v_add_f32 v17, v17, v25
    v_add_f32 v18, v18, v26
    v_add_f32 v19, v19, v27
    ds_write_b128 v8, v[16:19]
L_nocs2:
    v_mov_b32 v10, 5
    ds_write_b32 v5, v10
    s_add_u32 s43, s38, 163840
    buffer_load_dwordx4 v[96:99], v3, s[20:23], s43 offen offset:0 sc1
    buffer_load_dwordx4 v[100:103], v3, s[20:23], s43 offen offset:1024 sc1
    buffer_load_dwordx4 v[104:107], v3, s[20:23], s43 offen offset:2048 sc1
    buffer_load_dwordx4 v[108:111], v3, s[20:23], s43 offen offset:3072 sc1
    s_add_u32 s43, s38, 167936
    buffer_load_dwordx4 v[112:115], v3, s[20:23], s43 offen offset:0 sc1
    s_waitcnt lgkmcnt(0)
    s_min_u32 s56, s56, s57
    s_min_u32 s56, s56, s58
    s_min_u32 s56, s56, s59
    s_min_u32 s56, s56, s60
    s_min_u32 s56, s56, s61
    s_min_u32 s56, s56, s62
    s_min_u32 s56, s56, s63
    s_cmp_lt_u32 s56, 1
    s_cbranch_scc1 L_zr209
L_zq208:
    s_buffer_load_dword s48, s[20:23], s42 offset:0
    s_buffer_load_dword s49, s[20:23], s42 offset:128
    s_buffer_load_dword s50, s[20:23], s42 offset:256
    s_buffer_load_dword s51, s[20:23], s42 offset:384
    s_buffer_load_dword s52, s[20:23], s42 offset:512
    s_buffer_load_dword s53, s[20:23], s42 offset:640
    s_buffer_load_dword s54, s[20:23], s42 offset:768
    s_buffer_load_dword s55, s[20:23], s42 offset:896
    s_buffer_load_dword s56, s[20:23], s42 offset:1024
    s_buffer_load_dword s57, s[20:23], s42 offset:1152
    s_buffer_load_dword s58, s[20:23], s42 offset:1280
    s_buffer_load_dword s59, s[20:23], s42 offset:1408
    s_buffer_load_dword s60, s[20:23], s42 offset:1536
    s_buffer_load_dword s61, s[20:23], s42 offset:1664
    s_buffer_load_dword s62, s[20:23], s42 offset:1792
    s_buffer_load_dword s63, s[20:23], s42 offset:1920
    s_add_u32 s43, s38, 184320
    buffer_load_dwordx4 v[116:119], v3, s[20:23], s43 offen offset:0 sc1
    buffer_load_dwordx4 v[120:123], v3, s[20:23], s43 offen offset:1024 sc1
    buffer_load_dwordx4 v[124:127], v3, s[20:23], s43 offen offset:2048 sc1
    buffer_load_dwordx4 v[128:131], v3, s[20:23], s43 offen offset:3072 sc1
    s_add_u32 s43, s38, 188416
    buffer_load_dwordx4 v[132:135], v3, s[20:23], s43 offen offset:0 sc1
    s_add_u32 s43, s38, 204800
    buffer_load_dwordx4 v[136:139], v3, s[20:23], s43 offen offset:0 sc1
    buffer_load_dwordx4 v[140:143], v3, s[20:23], s43 offen offset:1024 sc1
    buffer_load_dwordx4 v[144:147], v3, s[20:23], s43 offen offset:2048 sc1
    buffer_load_dwordx4 v[148:151], v3, s[20:23], s43 offen offset:3072 sc1
    s_add_u32 s43, s38, 208896
    buffer_load_dwordx4 v[152:155], v3, s[20:23], s43 offen offset:0 sc1
    s_add_u32 s43, s38, 225280
    buffer_load_dwordx4 v[156:159], v3, s[20:23], s43 offen offset:0 sc1
    buffer_load_dwordx4 v[160:163], v3, s[20:23], s43 offen offset:1024 sc1
    buffer_load_dwordx4 v[164:167], v3, s[20:23], s43 offen offset:2048 sc1
    buffer_load_dwordx4 v[168:171], v3, s[20:23], s43 offen offset:3072 sc1
    s_add_u32 s43, s38, 229376
    buffer_load_dwordx4 v[172:175], v3, s[20:23], s43 offen offset:0 sc1
    s_add_u32 s43, s38, 245760
    buffer_load_dwordx4 v[176:179], v3, s[20:23], s43 offen offset:0 sc1
    buffer_load_dwordx4 v[180:183], v3, s[20:23], s43 offen offset:1024 sc1
    buffer_load_dwordx4 v[184:187], v3, s[20:23], s43 offen offset:2048 sc1
    buffer_load_dwordx4 v[188:191], v3, s[20:23], s43 offen offset:3072 sc1
    s_add_u32 s43, s38, 249856
    buffer_load_dwordx4 v[192:195], v3, s[20:23], s43 offen offset:0 sc1
    s_add_u32 s43, s38, 266240
    buffer_load_dwordx4 v[196:199], v3, s[20:23], s43 offen offset:0 sc1
    buffer_load_dwordx4 v[200:203], v3, s[20:23], s43 offen offset:1024 sc1
    buffer_load_dwordx4 v[204:207], v3, s[20:23], s43 offen offset:2048 sc1
    buffer_load_dwordx4 v[208:211], v3, s[20:23], s43 offen offset:3072 sc1
    s_add_u32 s43, s38, 270336
    buffer_load_dwordx4 v[212:215], v3, s[20:23], s43 offen offset:0 sc1
    s_add_u32 s43, s38, 286720
    buffer_load_dwordx4 v[216:219], v3, s[20:23], s43 offen offset:0 sc1
    buffer_load_dwordx4 v[220:223], v3, s[20:23], s43 offen offset:1024 sc1
    buffer_load_dwordx4 v[224:227], v3, s[20:23], s43 offen offset:2048 sc1
    buffer_load_dwordx4 v[228:231], v3, s[20:23], s43 offen offset:3072 sc1
    s_add_u32 s43, s38, 290816
    buffer_load_dwordx4 v[232:235], v3, s[20:23], s43 offen offset:0 sc1
    s_waitcnt lgkmcnt(0)
    s_min_u32 s48, s48, s49
    s_min_u32 s48, s48, s50
    s_min_u32 s48, s48, s51
    s_min_u32 s48, s48, s52
    s_min_u32 s48, s48, s53
    s_min_u32 s48, s48, s54
    s_min_u32 s48, s48, s55
    s_min_u32 s48, s48, s56
    s_min_u32 s48, s48, s57
    s_min_u32 s48, s48, s58
    s_min_u32 s48, s48, s59
    s_min_u32 s48, s48, s60
    s_min_u32 s48, s48, s61
    s_min_u32 s48, s48, s62
    s_min_u32 s48, s48, s63
    s_cmp_lt_u32 s48, 1
    s_cbranch_scc1 L_zr215
L_zq214:
    s_buffer_load_dword s64, s[20:23], s31 offset:0
    s_buffer_load_dword s65, s[20:23], s31 offset:128
    s_buffer_load_dword s66, s[20:23], s31 offset:256
    s_buffer_load_dword s67, s[20:23], s31 offset:384
    s_buffer_load_dword s68, s[20:23], s31 offset:512
    s_buffer_load_dword s69, s[20:23], s31 offset:640
    s_buffer_load_dword s70, s[20:23], s31 offset:768
    s_buffer_load_dword s71, s[20:23], s31 offset:896
    s_buffer_load_dword s72, s[20:23], s31 offset:1024
    s_buffer_load_dword s73, s[20:23], s31 offset:1152
    s_buffer_load_dword s74, s[20:23], s31 offset:1280
    s_buffer_load_dword s75, s[20:23], s31 offset:1408
    ds_read_b32 v11, v4 offset:16
    s_waitcnt lgkmcnt(0)
    v_cmp_gt_u32 vcc, 1, v11
    s_cbranch_vccnz L_ll220
L_ld221:
    s_waitcnt vmcnt(45)
    ds_write_b128 v13, v[36:39] offset:36864
    ds_write_b128 v13, v[40:43] offset:37888
    ds_write_b128 v13, v[44:47] offset:38912
    ds_write_b128 v13, v[48:51] offset:39936
    ds_write_b128 v13, v[52:55] offset:40960
    s_waitcnt vmcnt(40)
    ds_write_b128 v13, v[56:59] offset:57344
    ds_write_b128 v13, v[60:63] offset:58368
    ds_write_b128 v13, v[64:67] offset:59392
    ds_write_b128 v13, v[68:71] offset:60416
    ds_write_b128 v13, v[72:75] offset:61440
    s_waitcnt lgkmcnt(0)
    s_min_u32 s64, s64, s65
    s_min_u32 s64, s64, s66
    s_min_u32 s64, s64, s67
    s_min_u32 s64, s64, s68
    s_min_u32 s64, s64, s69
    s_min_u32 s64, s64, s70
    s_min_u32 s64, s64, s71
    s_min_u32 s64, s64, s72
    s_min_u32 s64, s64, s73
    s_min_u32 s64, s64, s74
    s_min_u32 s64, s64, s75
    s_cmp_lt_u32 s64, 1
    s_cbranch_scc1 L_zr224
L_zq223:
    v_mov_b32 v10, 6
    ds_write_b32 v5, v10
    ds_read_b32 v11, v4 offset:16
    s_waitcnt lgkmcnt(0)
    v_cmp_gt_u32 vcc, 3, v11
    s_cbranch_vccnz L_ll226
L_ld227:
    s_cmp_lg_u32 s33, 0
    s_cbranch_scc1 L_ct229
    s_sub_u32 s43, s26, 12
    s_and_b32 s43, s43, 31
    s_lshl_b32 s43, s43, 12
    s_cmp_ge_u32 s43, L_code_end-L_c1
    s_cbranch_scc1 L_ct229
    s_getpc_b64 s[66:67]
L_pc230:
    s_sub_u32 s66, s66, L_pc230-L_c1
    s_subb_u32 s67, s67, 0
    v_lshl_add_u32 v32, v1, 6, s43
    v_min_u32 v32, L_code_end-L_c1-4, v32
    v_mov_b32 v33, s67
    v_add_co_u32 v32, vcc, s66, v32
    s_nop 1
    v_addc_co_u32 v33, vcc, 0, v33, vcc
    global_load_dword v34, v[32:33], off
L_ct229:
    s_waitcnt lgkmcnt(0)
    s_add_u32 s43, s6, 307200
    buffer_load_dwordx4 v[236:239], v3, s[20:23], s43 offen offset:0 sc1
    buffer_load_dwordx4 v[240:243], v3, s[20:23], s43 offen offset:1024 sc1
    buffer_load_dwordx4 v[244:247], v3, s[20:23], s43 offen offset:2048 sc1
    buffer_load_dwordx4 v[248:251], v3, s[20:23], s43 offen offset:3072 sc1
    s_add_u32 s43, s6, 311296
    buffer_load_dwordx4 v[252:255], v3, s[20:23], s43 offen offset:0 sc1
    s_add_u32 s43, s6, 327680
    buffer_load_dwordx4 v[36:39], v3, s[20:23], s43 offen offset:0 sc1
    buffer_load_dwordx4 v[40:43], v3, s[20:23], s43 offen offset:1024 sc1
    buffer_load_dwordx4 v[44:47], v3, s[20:23], s43 offen offset:2048 sc1
    buffer_load_dwordx4 v[48:51], v3, s[20:23], s43 offen offset:3072 sc1
    s_add_u32 s43, s6, 331776
    buffer_load_dwordx4 v[52:55], v3, s[20:23], s43 offen offset:0 sc1
    s_waitcnt vmcnt(45)
    ds_write_b128 v12, v[76:79] offset:0
    ds_write_b128 v12, v[80:83] offset:1024
    ds_write_b128 v12, v[84:87] offset:2048
    ds_write_b128 v12, v[88:91] offset:3072
    ds_write_b128 v12, v[92:95] offset:4096
    s_waitcnt vmcnt(40)
    ds_write_b128 v12, v[96:99] offset:20480
    ds_write_b128 v12, v[100:103] offset:21504
    ds_write_b128 v12, v[104:107] offset:22528
    ds_write_b128 v12, v[108:111] offset:23552
    ds_write_b128 v12, v[112:115] offset:24576
    s_waitcnt vmcnt(35)
    ds_write_b128 v12, v[116:119] offset:40960
    ds_write_b128 v12, v[120:123] offset:41984
    ds_write_b128 v12, v[124:127] offset:43008
    ds_write_b128 v12, v[128:131] offset:44032
    ds_write_b128 v12, v[132:135] offset:45056
    v_mov_b32 v10, 10
    ds_write_b32 v5, v10
    ds_read_b32 v11, v4 offset:16
    s_waitcnt lgkmcnt(0)
    v_cmp_gt_u32 vcc, 5, v11
    s_cbranch_vccnz L_ll231
L_ld232:
    s_waitcnt vmcnt(30)
    ds_write_b128 v12, v[136:139] offset:61440
    ds_write_b128 v12, v[140:143] offset:62464
    ds_write_b128 v12, v[144:147] offset:63488
    ds_write_b128 v12, v[148:151] offset:64512
    ds_write_b128 v13, v[152:155] offset:0
    s_waitcnt vmcnt(25)
    ds_write_b128 v13, v[156:159] offset:16384
    ds_write_b128 v13, v[160:163] offset:17408
    ds_write_b128 v13, v[164:167] offset:18432
    ds_write_b128 v13, v[168:171] offset:19456
    ds_write_b128 v13, v[172:175] offset:20480
    ds_read_b32 v11, v4 offset:16
    s_waitcnt lgkmcnt(0)
    v_cmp_gt_u32 vcc, 8, v11
    s_cbranch_vccnz L_ll234
L_ld235:
    s_waitcnt lgkmcnt(0)
    s_add_u32 s43, s6, 348160
    buffer_load_dwordx4 v[56:59], v3, s[20:23], s43 offen offset:0 sc1
    buffer_load_dwordx4 v[60:63], v3, s[20:23], s43 offen offset:1024 sc1
    buffer_load_dwordx4 v[64:67], v3, s[20:23], s43 offen offset:2048 sc1
    buffer_load_dwordx4 v[68:71], v3, s[20:23], s43 offen offset:3072 sc1
    s_add_u32 s43, s6, 352256
    buffer_load_dwordx4 v[72:75], v3, s[20:23], s43 offen offset:0 sc1
    s_add_u32 s43, s6, 368640
    buffer_load_dwordx4 v[76:79], v3, s[20:23], s43 offen offset:0 sc1
    buffer_load_dwordx4 v[80:83], v3, s[20:23], s43 offen offset:1024 sc1
    buffer_load_dwordx4 v[84:87], v3, s[20:23], s43 offen offset:2048 sc1
    buffer_load_dwordx4 v[88:91], v3, s[20:23], s43 offen offset:3072 sc1
    s_add_u32 s43, s6, 372736
    buffer_load_dwordx4 v[92:95], v3, s[20:23], s43 offen offset:0 sc1
    s_waitcnt vmcnt(30)
    ds_write_b128 v13, v[176:179] offset:36864
    ds_write_b128 v13, v[180:183] offset:37888
    ds_write_b128 v13, v[184:187] offset:38912
    ds_write_b128 v13, v[188:191] offset:39936
    ds_write_b128 v13, v[192:195] offset:40960
    s_waitcnt vmcnt(25)
    ds_write_b128 v13, v[196:199] offset:57344
    ds_write_b128 v13, v[200:203] offset:58368
    ds_write_b128 v13, v[204:207] offset:59392
    ds_write_b128 v13, v[208:211] offset:60416
    ds_write_b128 v13, v[212:215] offset:61440
    s_waitcnt vmcnt(20)
    ds_write_b128 v12, v[216:219] offset:0
    ds_write_b128 v12, v[220:223] offset:1024
    ds_write_b128 v12, v[224:227] offset:2048
    ds_write_b128 v12, v[228:231] offset:3072
    ds_write_b128 v12, v[232:235] offset:4096
    v_mov_b32 v10, 15
    ds_write_b32 v5, v10
    ds_read_b32 v11, v4 offset:16
    s_waitcnt lgkmcnt(0)
    v_cmp_gt_u32 vcc, 10, v11
    s_cbranch_vccnz L_ll237
L_ld238:
    s_waitcnt vmcnt(15)
    ds_write_b128 v12, v[236:239] offset:20480
    ds_write_b128 v12, v[240:243] offset:21504
    ds_write_b128 v12, v[244:247] offset:22528
    ds_write_b128 v12, v[248:251] offset:23552
    ds_write_b128 v12, v[252:255] offset:24576
    s_waitcnt vmcnt(10)
    ds_write_b128 v12, v[36:39] offset:40960
    ds_write_b128 v12, v[40:43] offset:41984
    ds_write_b128 v12, v[44:47] offset:43008
    ds_write_b128 v12, v[48:51] offset:44032
    ds_write_b128 v12, v[52:55] offset:45056
    ds_read_b32 v11, v4 offset:16
    s_waitcnt lgkmcnt(0)
    v_cmp_gt_u32 vcc, 13, v11
    s_cbranch_vccnz L_ll240
L_ld241:
    s_cmp_lg_u32 s33, 0
    s_cbranch_scc1 L_ct243
    s_sub_u32 s43, s26, 22
    s_and_b32 s43, s43, 31
    s_lshl_b32 s43, s43, 12
    s_cmp_ge_u32 s43, L_code_end-L_c3
    s_cbranch_scc1 L_ct243
    s_getpc_b64 s[66:67]
L_pc244:
    s_sub_u32 s66, s66, L_pc244-L_c3
    s_subb_u32 s67, s67, 0
    v_lshl_add_u32 v32, v1, 6, s43
    v_min_u32 v32, L_code_end-L_c3-4, v32
    v_mov_b32 v33, s67
    v_add_co_u32 v32, vcc, s66, v32
    s_nop 1
    v_addc_co_u32 v33, vcc, 0, v33, vcc
    global_load_dword v34, v[32:33], off
L_ct243:
    s_waitcnt lgkmcnt(0)
    s_add_u32 m0, s39, 102400
    s_add_u32 s43, s6, 389120
    buffer_load_dwordx4 v3, s[20:23], s43 offen offset:0 sc1 lds
    buffer_load_dwordx4 v3, s[20:23], s43 offen offset:1024 sc1 lds
    buffer_load_dwordx4 v3, s[20:23], s43 offen offset:2048 sc1 lds
    buffer_load_dwordx4 v3, s[20:23], s43 offen offset:3072 sc1 lds
    s_add_u32 m0, s39, 106496
    s_add_u32 s43, s6, 393216
    buffer_load_dwordx4 v3, s[20:23], s43 offen offset:0 sc1 lds
    s_waitcnt vmcnt(10)
    ds_write_b128 v12, v[56:59] offset:61440
    ds_write_b128 v12, v[60:63] offset:62464
    ds_write_b128 v12, v[64:67] offset:63488
    ds_write_b128 v12, v[68:71] offset:64512
    ds_write_b128 v13, v[72:75] offset:0
    s_waitcnt vmcnt(5)
    ds_write_b128 v13, v[76:79] offset:16384
    ds_write_b128 v13, v[80:83] offset:17408
    ds_write_b128 v13, v[84:87] offset:18432
    ds_write_b128 v13, v[88:91] offset:19456
    ds_write_b128 v13, v[92:95] offset:20480
    s_waitcnt vmcnt(0)
    v_mov_b32 v10, 20
    ds_write_b32 v5, v10
    ds_read_b32 v11, v4 offset:16
    s_waitcnt lgkmcnt(0)
    v_cmp_gt_u32 vcc, 15, v11
    s_cbranch_vccnz L_ll245
L_ld246:
    ds_read_b32 v11, v4 offset:16
    s_waitcnt lgkmcnt(0)
    v_cmp_gt_u32 vcc, 16, v11
    s_cbranch_vccnz L_ll248
L_ld249:
    s_lshl_b32 s44, s25, 11
    s_add_u32 s44, s44, 18096128
    v_lshrrev_b32 v6, 2, v1
    v_lshlrev_b32 v6, 7, v6
    v_and_b32 v7, 3, v1
    v_lshl_add_u32 v6, v7, 3, v6
    s_mov_b32 s47, 0
L_gw251:
    buffer_load_dwordx2 v[8:9], v6, s[20:23], s44 offen sc1
    s_add_u32 s47, s47, 1
    s_waitcnt vmcnt(0)
    v_min_u32 v8, v8, v9
    v_cmp_gt_u32 vcc, 1, v8
    s_cbranch_vccz L_gx252
    s_sleep 2
    s_cmp_lt_u32 s47, 400000
    s_cbranch_scc1 L_gw251
L_gx252:
    s_add_u32 m0, s39, 122880
    s_add_u32 s43, s6, 409600
    s_waitcnt vmcnt(5)
    buffer_load_dwordx4 v3, s[20:23], s43 offen offset:0 sc1 lds
    s_waitcnt vmcnt(5)
    buffer_load_dwordx4 v3, s[20:23], s43 offen offset:1024 sc1 lds
    s_waitcnt vmcnt(5)
    buffer_load_dwordx4 v3, s[20:23], s43 offen offset:2048 sc1 lds
    s_waitcnt vmcnt(5)
    buffer_load_dwordx4 v3, s[20:23], s43 offen offset:3072 sc1 lds
    s_add_u32 m0, s39, 126976
    s_add_u32 s43, s6, 413696
    s_waitcnt vmcnt(5)
    buffer_load_dwordx4 v3, s[20:23], s43 offen offset:0 sc1 lds
    ds_read_b32 v11, v4 offset:16
    s_waitcnt lgkmcnt(0)
    v_cmp_gt_u32 vcc, 16, v11
    s_cbranch_vccnz L_ll253
L_ld254:
    s_add_u32 m0, s39, 0
    s_add_u32 s43, s6, 430080
    s_waitcnt vmcnt(5)
    buffer_load_dwordx4 v3, s[20:23], s43 offen offset:0 sc1 lds
    s_waitcnt vmcnt(5)
    buffer_load_dwordx4 v3, s[20:23], s43 offen offset:1024 sc1 lds
    s_waitcnt vmcnt(5)
    buffer_load_dwordx4 v3, s[20:23], s43 offen offset:2048 sc1 lds
    s_waitcnt vmcnt(5)
    buffer_load_dwordx4 v3, s[20:23], s43 offen offset:3072 sc1 lds
    s_add_u32 m0, s39, 4096
    s_add_u32 s43, s6, 434176
    s_waitcnt vmcnt(5)
    buffer_load_dwordx4 v3, s[20:23], s43 offen offset:0 sc1 lds
    s_waitcnt vmcnt(5)
    v_mov_b32 v10, 21
    ds_write_b32 v5, v10
    ds_read_b32 v11, v4 offset:16
    s_waitcnt lgkmcnt(0)
    v_cmp_gt_u32 vcc, 16, v11
    s_cbranch_vccnz L_ll256
L_ld257:
    s_add_u32 m0, s39, 20480
    s_add_u32 s43, s7, 593920
    s_waitcnt vmcnt(5)
    buffer_load_dwordx4 v3, s[20:23], s43 offen offset:0 sc1 lds
    s_waitcnt vmcnt(5)
    buffer_load_dwordx4 v3, s[20:23], s43 offen offset:1024 sc1 lds
    s_waitcnt vmcnt(5)
    buffer_load_dwordx4 v3, s[20:23], s43 offen offset:2048 sc1 lds
    s_waitcnt vmcnt(5)
    buffer_load_dwordx4 v3, s[20:23], s43 offen offset:3072 sc1 lds
    s_add_u32 m0, s39, 24576
    s_add_u32 s43, s7, 598016
    s_waitcnt vmcnt(5)
    buffer_load_dwordx4 v3, s[20:23], s43 offen offset:0 sc1 lds
    s_waitcnt vmcnt(5)
    v_mov_b32 v10, 22
    ds_write_b32 v5, v10
    ds_read_b32 v11, v4 offset:16
    s_waitcnt lgkmcnt(0)
    v_cmp_gt_u32 vcc, 17, v11
    s_cbranch_vccnz L_ll259
L_ld260:
    s_add_u32 m0, s39, 40960
    s_add_u32 s43, s7, 634880
    s_waitcnt vmcnt(5)
    buffer_load_dwordx4 v3, s[20:23], s43 offen offset:0 sc1 lds
    s_waitcnt vmcnt(5)
    buffer_load_dwordx4 v3, s[20:23], s43 offen offset:1024 sc1 lds
    s_waitcnt vmcnt(5)
    buffer_load_dwordx4 v3, s[20:23], s43 offen offset:2048 sc1 lds
    s_waitcnt vmcnt(5)
    buffer_load_dwordx4 v3, s[20:23], s43 offen offset:3072 sc1 lds
    s_add_u32 m0, s39, 45056
    s_add_u32 s43, s7, 638976
    s_waitcnt vmcnt(5)
    buffer_load_dwordx4 v3, s[20:23], s43 offen offset:0 sc1 lds
    s_waitcnt vmcnt(5)
    v_mov_b32 v10, 23
    ds_write_b32 v5, v10
    ds_read_b32 v11, v4 offset:16
    s_waitcnt lgkmcnt(0)
    v_cmp_gt_u32 vcc, 18, v11
    s_cbranch_vccnz L_ll262
L_ld263:
    s_add_u32 m0, s39, 61440
    s_add_u32 s43, s7, 675840
    s_waitcnt vmcnt(5)
    buffer_load_dwordx4 v3, s[20:23], s43 offen offset:0 sc1 lds
    s_waitcnt vmcnt(5)
    buffer_load_dwordx4 v3, s[20:23], s43 offen offset:1024 sc1 lds
    s_waitcnt vmcnt(5)
    buffer_load_dwordx4 v3, s[20:23], s43 offen offset:2048 sc1 lds
    s_waitcnt vmcnt(5)
    buffer_load_dwordx4 v3, s[20:23], s43 offen offset:3072 sc1 lds
    s_add_u32 m0, s39, 65536
    s_add_u32 s43, s7, 679936
    s_waitcnt vmcnt(5)
    buffer_load_dwordx4 v3, s[20:23], s43 offen offset:0 sc1 lds
    s_waitcnt vmcnt(5)
    v_mov_b32 v10, 24
    ds_write_b32 v5, v10
    ds_read_b32 v11, v4 offset:16
    s_waitcnt lgkmcnt(0)
    v_cmp_gt_u32 vcc, 19, v11
    s_cbranch_vccnz L_ll265
L_ld266:
    s_add_u32 m0, s39, 81920
    s_add_u32 s43, s7, 716800
    s_waitcnt vmcnt(5)
    buffer_load_dwordx4 v3, s[20:23], s43 offen offset:0 sc1 lds
    s_waitcnt vmcnt(5)
    buffer_load_dwordx4 v3, s[20:23], s43 offen offset:1024 sc1 lds
    s_waitcnt vmcnt(5)
    buffer_load_dwordx4 v3, s[20:23], s43 offen offset:2048 sc1 lds
    s_waitcnt vmcnt(5)
    buffer_load_dwordx4 v3, s[20:23], s43 offen offset:3072 sc1 lds
    s_add_u32 m0, s39, 86016
    s_add_u32 s43, s7, 720896
    s_waitcnt vmcnt(5)
    buffer_load_dwordx4 v3, s[20:23], s43 offen offset:0 sc1 lds
    s_waitcnt vmcnt(5)
    v_mov_b32 v10, 25
    ds_write_b32 v5, v10
    ds_read_b32 v11, v4 offset:16
    s_waitcnt lgkmcnt(0)
    v_cmp_gt_u32 vcc, 20, v11
    s_cbranch_vccnz L_ll268
L_ld269:
    s_add_u32 m0, s39, 102400
    s_add_u32 s43, s7, 757760
    s_waitcnt vmcnt(5)
    buffer_load_dwordx4 v3, s[20:23], s43 offen offset:0 sc1 lds
    s_waitcnt vmcnt(5)
    buffer_load_dwordx4 v3, s[20:23], s43 offen offset:1024 sc1 lds
    s_waitcnt vmcnt(5)
    buffer_load_dwordx4 v3, s[20:23], s43 offen offset:2048 sc1 lds
    s_waitcnt vmcnt(5)
    buffer_load_dwordx4 v3, s[20:23], s43 offen offset:3072 sc1 lds
    s_add_u32 m0, s39, 106496
    s_add_u32 s43, s7, 761856
    s_waitcnt vmcnt(5)
    buffer_load_dwordx4 v3, s[20:23], s43 offen offset:0 sc1 lds
    s_waitcnt vmcnt(5)
    v_mov_b32 v10, 26
    ds_write_b32 v5, v10
    s_waitcnt vmcnt(0)
    v_mov_b32 v10, 27
    ds_write_b32 v5, v10
    ds_read_b32 v11, v4 offset:16
    s_waitcnt lgkmcnt(0)
    v_cmp_gt_u32 vcc, 23, v11
    s_cbranch_vccnz L_ll271
L_ld272:
    ds_read_b32 v11, v4 offset:16
    s_waitcnt lgkmcnt(0)
    v_cmp_gt_u32 vcc, 21, v11
    s_cbranch_vccnz L_ll274
L_ld275:
    s_add_u32 m0, s39, 122880
    s_add_u32 s43, s7, 798720
    s_waitcnt vmcnt(5)
    buffer_load_dwordx4 v3, s[20:23], s43 offen offset:0 sc1 lds
    s_waitcnt vmcnt(5)
    buffer_load_dwordx4 v3, s[20:23], s43 offen offset:1024 sc1 lds
    s_waitcnt vmcnt(5)
    buffer_load_dwordx4 v3, s[20:23], s43 offen offset:2048 sc1 lds
    s_waitcnt vmcnt(5)
    buffer_load_dwordx4 v3, s[20:23], s43 offen offset:3072 sc1 lds
    s_add_u32 m0, s39, 126976
    s_add_u32 s43, s7, 802816
    s_waitcnt vmcnt(5)
    buffer_load_dwordx4 v3, s[20:23], s43 offen offset:0 sc1 lds
    ds_read_b32 v11, v4 offset:16
    s_waitcnt lgkmcnt(0)
    v_cmp_gt_u32 vcc, 22, v11
    s_cbranch_vccnz L_ll277
L_ld278:
    s_add_u32 m0, s39, 0
    s_add_u32 s43, s17, 839680
    s_waitcnt vmcnt(5)
    buffer_load_dwordx4 v3, s[20:23], s43 offen offset:0 sc1 lds
    s_waitcnt vmcnt(5)
    buffer_load_dwordx4 v3, s[20:23], s43 offen offset:1024 sc1 lds
    s_waitcnt vmcnt(5)
    buffer_load_dwordx4 v3, s[20:23], s43 offen offset:2048 sc1 lds
    s_waitcnt vmcnt(5)
    buffer_load_dwordx4 v3, s[20:23], s43 offen offset:3072 sc1 lds
    s_add_u32 m0, s39, 4096
    s_add_u32 s43, s17, 843776
    s_waitcnt vmcnt(5)
    buffer_load_dwordx4 v3, s[20:23], s43 offen offset:0 sc1 lds
    s_waitcnt vmcnt(5)
    v_mov_b32 v10, 28
    ds_write_b32 v5, v10
    s_waitcnt vmcnt(0)
    v_mov_b32 v10, 29
    ds_write_b32 v5, v10
L_end:
    s_endpgm
L_zr5:
    s_mov_b32 s47, 0
    v_mul_u32_u24 v58, 4, v1
    v_add_u32 v58, 0, v58
    s_mov_b64 exec, 1
L_zs6:
    buffer_load_dword v59, v58, s[76:79], 0 offen sc1
    s_add_u32 s47, s47, 1
    s_waitcnt vmcnt(0)
    v_cmp_gt_u32 vcc, 64, v59
    s_cbranch_vccz L_zs6x
    s_sleep 6
    s_cmp_lt_u32 s47, 400000
    s_cbranch_scc1 L_zs6
L_zs6x:
    s_mov_b64 exec, -1
    s_branch L_zq4
L_zr14:
    s_mov_b32 s47, 0
    v_mul_u32_u24 v58, s70, v1
    v_add_u32 v58, 0, v58
    s_mov_b64 exec, 31
L_zs15:
    buffer_load_dword v59, v58, s[20:23], s56 offen sc1
    s_add_u32 s47, s47, 1
    s_waitcnt vmcnt(0)
    v_cmp_gt_u32 vcc, 1, v59
    s_cbranch_vccz L_zs15x
    s_sleep 6
    s_cmp_lt_u32 s47, 400000
    s_cbranch_scc1 L_zs15
L_zs15x:
    s_mov_b64 exec, -1
    s_branch L_zq13
L_zr17:
    s_mov_b32 s47, 0
    v_mul_u32_u24 v58, 128, v1
    v_add_u32 v58, 0, v58
    s_mov_b64 exec, 255
L_zs18:
    buffer_load_dword v59, v58, s[20:23], s61 offen sc1
    s_add_u32 s47, s47, 1
    s_waitcnt vmcnt(0)
    v_cmp_gt_u32 vcc, 1, v59
    s_cbranch_vccz L_zs18x
    s_sleep 6
    s_cmp_lt_u32 s47, 400000
    s_cbranch_scc1 L_zs18
L_zs18x:
    s_mov_b64 exec, -1
    s_branch L_zq16
L_zr20:
    s_mov_b32 s47, 0
    v_mul_u32_u24 v58, 4, v1
    v_add_u32 v58, 0, v58
    s_mov_b64 exec, 1
L_zs21:
    buffer_load_dword v59, v58, s[76:79], 0 offen sc1
    s_add_u32 s47, s47, 1
    s_waitcnt vmcnt(0)
    v_cmp_gt_u32 vcc, 64, v59
    s_cbranch_vccz L_zs21x
    s_sleep 6
    s_cmp_lt_u32 s47, 400000
    s_cbranch_scc1 L_zs21
L_zs21x:
    s_mov_b64 exec, -1
    s_branch L_zq19
L_zr26:
    s_mov_b32 s47, 0
    v_mul_u32_u24 v58, 128, v1
    v_add_u32 v58, 0, v58
    s_mov_b64 exec, 255
L_zs27:
    buffer_load_dword v59, v58, s[20:23], s43 offen sc1
    s_add_u32 s47, s47, 1
    s_waitcnt vmcnt(0)
    v_cmp_gt_u32 vcc, 1, v59
    s_cbranch_vccz L_zs27x
    s_sleep 6
    s_cmp_lt_u32 s47, 400000
    s_cbranch_scc1 L_zs27
L_zs27x:
    s_mov_b64 exec, -1
    s_branch L_zq25
L_fw28:
    s_lshl_b32 s43, s31, 4
    s_add_u32 s43, s43, s32
    s_lshl_b32 s43, s43, 7
    s_add_u32 s43, s43, 18171904
    v_mov_b32 v60, 1
    v_mov_b32 v61, 0
    s_getreg_b32 s44, hwreg(HW_REG_XCC_ID)
    s_and_b32 s44, s44, 15
    s_add_u32 s44, s44, 1
    v_mov_b32 v62, s44
    s_lshl_b32 s44, s25, 5
    s_add_u32 s44, s44, s26
    s_lshl_b32 s44, s44, 2
    s_add_u32 s44, s44, 18128896
    s_mov_b64 exec, 1
    buffer_store_dword v60, v61, s[20:23], s43 offen sc1
    buffer_store_dword v62, v61, s[20:23], s44 offen sc1
    s_mov_b64 exec, -1
    s_branch L_fe29
L_fw38:
    s_lshl_b32 s43, s31, 4
    s_add_u32 s43, s43, s32
    s_lshl_b32 s43, s43, 7
    s_add_u32 s43, s43, 18171904
    v_mov_b32 v60, 1
    v_mov_b32 v61, 0
    s_getreg_b32 s44, hwreg(HW_REG_XCC_ID)
    s_and_b32 s44, s44, 15
    s_add_u32 s44, s44, 1
    v_mov_b32 v62, s44
    s_lshl_b32 s44, s25, 5
    s_add_u32 s44, s44, s26
    s_lshl_b32 s44, s44, 2
    s_add_u32 s44, s44, 18128896
    s_mov_b64 exec, 1
    buffer_store_dword v60, v61, s[20:23], s43 offen sc1
    buffer_store_dword v62, v61, s[20:23], s44 offen sc1
    s_mov_b64 exec, -1
    s_branch L_fe39
L_pl48:
    s_mov_b32 s47, 0
L_pr50:
    s_sleep 6
    buffer_load_dword v253, v252, s[20:23], s33 offen sc1
    s_add_u32 s47, s47, 1
    s_cmp_ge_u32 s47, 400000
    s_waitcnt vmcnt(0)
    s_cbranch_scc1 L_pd49
    v_cmp_gt_u32 vcc, 1, v253
    s_cbranch_vccnz L_pr50
    s_branch L_pd49
L_pl51:
    s_mov_b32 s47, 0
L_pr53:
    s_sleep 3
    buffer_load_dword v59, v58, s[20:23], s38 offen sc1
    s_add_u32 s47, s47, 1
    s_cmp_ge_u32 s47, 400000
    s_waitcnt vmcnt(0)
    s_cbranch_scc1 L_pd52
    v_cmp_gt_u32 vcc, 2, v59
    s_cbranch_vccnz L_pr53
    s_branch L_pd52
L_ll54:
    s_mov_b32 s47, 0
L_lr56:
    ds_read_b32 v253, v254 offset:0
    s_add_u32 s47, s47, 1
    s_cmp_ge_u32 s47, 1600000
    s_waitcnt lgkmcnt(0)
    s_cbranch_scc1 L_ld55
    v_cmp_gt_u32 vcc, 1, v253
    s_cbranch_vccnz L_lr56
    s_branch L_ld55
L_ab57:
    v_mov_b32 v30, 0xff800000
    v_cndmask_b32 v32, v30, v32, s[48:49]
    v_cndmask_b32 v33, v30, v33, s[50:51]
    v_cndmask_b32 v34, v30, v34, s[52:53]
    v_cndmask_b32 v35, v30, v35, s[54:55]
    v_cndmask_b32 v36, v30, v36, s[56:57]
    v_cndmask_b32 v37, v30, v37, s[58:59]
    v_cndmask_b32 v38, v30, v38, s[60:61]
    v_cndmask_b32 v39, v30, v39, s[62:63]
    v_cndmask_b32 v40, v30, v40, s[64:65]
    v_cndmask_b32 v41, v30, v41, s[66:67]
    v_cndmask_b32 v42, v30, v42, s[68:69]
    v_cndmask_b32 v43, v30, v43, s[70:71]
    v_cndmask_b32 v44, v30, v44, s[72:73]
    v_cndmask_b32 v45, v30, v45, s[74:75]
    v_cndmask_b32 v46, v30, v46, s[76:77]
    v_cndmask_b32 v47, v30, v47, s[78:79]
    s_cmp_ge_u32 s31, 7
    s_cbranch_scc1 L_ay59
    v_mov_b32 v48, v30
    v_mov_b32 v49, v30
    v_mov_b32 v50, v30
    v_mov_b32 v51, v30
    v_mov_b32 v52, v30
    v_mov_b32 v53, v30
    v_mov_b32 v54, v30
    v_mov_b32 v55, v30
    v_mov_b32 v56, v30
    v_mov_b32 v57, v30
    v_mov_b32 v58, v30
    v_mov_b32 v59, v30
    v_mov_b32 v60, v30
    v_mov_b32 v61, v30
    v_mov_b32 v62, v30
    v_mov_b32 v63, v30
    s_cmp_ge_u32 s31, 6
    s_cbranch_scc1 L_ay59
    v_mov_b32 v64, v30
    v_mov_b32 v65, v30
    v_mov_b32 v66, v30
    v_mov_b32 v67, v30
    v_mov_b32 v68, v30
    v_mov_b32 v69, v30
    v_mov_b32 v70, v30
    v_mov_b32 v71, v30
    v_mov_b32 v72, v30
    v_mov_b32 v73, v30
    v_mov_b32 v74, v30
    v_mov_b32 v75, v30
    v_mov_b32 v76, v30
    v_mov_b32 v77, v30
    v_mov_b32 v78, v30
    v_mov_b32 v79, v30
    s_cmp_ge_u32 s31, 5
    s_cbranch_scc1 L_ay59
    v_mov_b32 v80, v30
    v_mov_b32 v81, v30
    v_mov_b32 v82, v30
    v_mov_b32 v83, v30
    v_mov_b32 v84, v30
    v_mov_b32 v85, v30
    v_mov_b32 v86, v30
    v_mov_b32 v87, v30
    v_mov_b32 v88, v30
    v_mov_b32 v89, v30
    v_mov_b32 v90, v30
    v_mov_b32 v91, v30
    v_mov_b32 v92, v30
    v_mov_b32 v93, v30
    v_mov_b32 v94, v30
    v_mov_b32 v95, v30
    s_cmp_ge_u32 s31, 4
    s_cbranch_scc1 L_ay59
    v_mov_b32 v96, v30
    v_mov_b32 v97, v30
    v_mov_b32 v98, v30
    v_mov_b32 v99, v30
    v_mov_b32 v100, v30
    v_mov_b32 v101, v30
    v_mov_b32 v102, v30
    v_mov_b32 v103, v30
    v_mov_b32 v104, v30
    v_mov_b32 v105, v30
    v_mov_b32 v106, v30
    v_mov_b32 v107, v30
    v_mov_b32 v108, v30
    v_mov_b32 v109, v30
    v_mov_b32 v110, v30
    v_mov_b32 v111, v30
    s_cmp_ge_u32 s31, 3
    s_cbranch_scc1 L_ay59
    v_mov_b32 v112, v30
    v_mov_b32 v113, v30
    v_mov_b32 v114, v30
    v_mov_b32 v115, v30
    v_mov_b32 v116, v30
    v_mov_b32 v117, v30
    v_mov_b32 v118, v30
    v_mov_b32 v119, v30
    v_mov_b32 v120, v30
    v_mov_b32 v121, v30
    v_mov_b32 v122, v30
    v_mov_b32 v123, v30
    v_mov_b32 v124, v30
    v_mov_b32 v125, v30
    v_mov_b32 v126, v30
    v_mov_b32 v127, v30
    s_cmp_ge_u32 s31, 2
    s_cbranch_scc1 L_ay59
    v_mov_b32 v128, v30
    v_mov_b32 v129, v30
    v_mov_b32 v130, v30
    v_mov_b32 v131, v30
    v_mov_b32 v132, v30
    v_mov_b32 v133, v30
    v_mov_b32 v134, v30
    v_mov_b32 v135, v30
    v_mov_b32 v136, v30
    v_mov_b32 v137, v30
    v_mov_b32 v138, v30
    v_mov_b32 v139, v30
    v_mov_b32 v140, v30
    v_mov_b32 v141, v30
    v_mov_b32 v142, v30
    v_mov_b32 v143, v30
    s_cmp_ge_u32 s31, 1
    s_cbranch_scc1 L_ay59
    v_mov_b32 v144, v30
    v_mov_b32 v145, v30
    v_mov_b32 v146, v30
    v_mov_b32 v147, v30
    v_mov_b32 v148, v30
    v_mov_b32 v149, v30
    v_mov_b32 v150, v30
    v_mov_b32 v151, v30
    v_mov_b32 v152, v30
    v_mov_b32 v153, v30
    v_mov_b32 v154, v30
    v_mov_b32 v155, v30
    v_mov_b32 v156, v30
    v_mov_b32 v157, v30
    v_mov_b32 v158, v30
    v_mov_b32 v159, v30
L_ay59:
    v_max_f32 v28, v32, v33
    v_max_f32 v29, v34, v35
    v_max3_f32 v28, v28, v36, v37
    v_max3_f32 v29, v29, v38, v39
    v_max3_f32 v28, v28, v40, v41
    v_max3_f32 v29, v29, v42, v43
    v_max3_f32 v28, v28, v44, v45
    v_max3_f32 v29, v29, v46, v47
    v_max3_f32 v28, v28, v48, v49
    v_max3_f32 v29, v29, v50, v51
    v_max3_f32 v28, v28, v52, v53
    v_max3_f32 v29, v29, v54, v55
    v_max3_f32 v28, v28, v56, v57
    v_max3_f32 v29, v29, v58, v59
    v_max3_f32 v28, v28, v60, v61
    v_max3_f32 v29, v29, v62, v63
    v_max3_f32 v28, v28, v64, v65
    v_max3_f32 v29, v29, v66, v67
    v_max3_f32 v28, v28, v68, v69
    v_max3_f32 v29, v29, v70, v71
    v_max3_f32 v28, v28, v72, v73
    v_max3_f32 v29, v29, v74, v75
    v_max3_f32 v28, v28, v76, v77
    v_max3_f32 v29, v29, v78, v79
    v_max3_f32 v28, v28, v80, v81
    v_max3_f32 v29, v29, v82, v83
    v_max3_f32 v28, v28, v84, v85
    v_max3_f32 v29, v29, v86, v87
    v_max3_f32 v28, v28, v88, v89
    v_max3_f32 v29, v29, v90, v91
    v_max3_f32 v28, v28, v92, v93
    v_max3_f32 v29, v29, v94, v95
    v_max3_f32 v28, v28, v96, v97
    v_max3_f32 v29, v29, v98, v99
    v_max3_f32 v28, v28, v100, v101
    v_max3_f32 v29, v29, v102, v103
    v_max3_f32 v28, v28, v104, v105
    v_max3_f32 v29, v29, v106, v107
    v_max3_f32 v28, v28, v108, v109
    v_max3_f32 v29, v29, v110, v111
    v_max3_f32 v28, v28, v112, v113
    v_max3_f32 v29, v29, v114, v115
    v_max3_f32 v28, v28, v116, v117
    v_max3_f32 v29, v29, v118, v119
    v_max3_f32 v28, v28, v120, v121
    v_max3_f32 v29, v29, v122, v123
    v_max3_f32 v28, v28, v124, v125
    v_max3_f32 v29, v29, v126, v127
    v_max3_f32 v28, v28, v128, v129
    v_max3_f32 v29, v29, v130, v131
    v_max3_f32 v28, v28, v132, v133
    v_max3_f32 v29, v29, v134, v135
    v_max3_f32 v28, v28, v136, v137
    v_max3_f32 v29, v29, v138, v139
    v_max3_f32 v28, v28, v140, v141
    v_max3_f32 v29, v29, v142, v143
    v_max3_f32 v28, v28, v144, v145
    v_max3_f32 v29, v29, v146, v147
    v_max3_f32 v28, v28, v148, v149
    v_max3_f32 v29, v29, v150, v151
    v_max3_f32 v28, v28, v152, v153
    v_max3_f32 v29, v29, v154, v155
    v_max3_f32 v28, v28, v156, v157
    v_max3_f32 v29, v29, v158, v159
    s_branch L_ae58
L_ll60:
    s_mov_b32 s47, 0
L_lr62:
    ds_read_b32 v253, v254 offset:0
    s_add_u32 s47, s47, 1
    s_cmp_ge_u32 s47, 1600000
    s_waitcnt lgkmcnt(0)
    s_cbranch_scc1 L_ld61
    v_cmp_gt_u32 vcc, 2, v253
    s_cbranch_vccnz L_lr62
    s_branch L_ld61
L_kvl:
    s_lshl_b32 s43, s25, 5
    s_add_u32 s43, s43, s26
    s_lshl_b32 s43, s43, 7
    s_add_u32 s43, s43, 18171968
    v_mov_b32 v30, 1
    s_mov_b64 exec, 1
    buffer_store_dword v30, v2, s[20:23], s43 offen sc1
    s_mov_b64 exec, -1
    s_branch L_kvle
L_sf63:
    s_nop 4
    buffer_store_dwordx4 v[16:19], v3, s[20:23], s40 offen sc1
    buffer_store_dwordx2 v[20:21], v27, s[20:23], s40 offen offset:1024 sc1
    s_nop 1
    s_branch L_se64
L_ab65:
    v_mov_b32 v30, 0xff800000
    v_cndmask_b32 v32, v30, v32, s[48:49]
    v_cndmask_b32 v33, v30, v33, s[50:51]
    v_cndmask_b32 v34, v30, v34, s[52:53]
    v_cndmask_b32 v35, v30, v35, s[54:55]
    v_cndmask_b32 v36, v30, v36, s[56:57]
    v_cndmask_b32 v37, v30, v37, s[58:59]
    v_cndmask_b32 v38, v30, v38, s[60:61]
    v_cndmask_b32 v39, v30, v39, s[62:63]
    v_cndmask_b32 v40, v30, v40, s[64:65]
    v_cndmask_b32 v41, v30, v41, s[66:67]
    v_cndmask_b32 v42, v30, v42, s[68:69]
    v_cndmask_b32 v43, v30, v43, s[70:71]
    v_cndmask_b32 v44, v30, v44, s[72:73]
    v_cndmask_b32 v45, v30, v45, s[74:75]
    v_cndmask_b32 v46, v30, v46, s[76:77]
    v_cndmask_b32 v47, v30, v47, s[78:79]
    s_cmp_ge_u32 s31, 3
    s_cbranch_scc1 L_ay67
    v_mov_b32 v48, v30
    v_mov_b32 v49, v30
    v_mov_b32 v50, v30
    v_mov_b32 v51, v30
    v_mov_b32 v52, v30
    v_mov_b32 v53, v30
    v_mov_b32 v54, v30
    v_mov_b32 v55, v30
    v_mov_b32 v56, v30
    v_mov_b32 v57, v30
    v_mov_b32 v58, v30
    v_mov_b32 v59, v30
    v_mov_b32 v60, v30
    v_mov_b32 v61, v30
    v_mov_b32 v62, v30
    v_mov_b32 v63, v30
    s_cmp_ge_u32 s31, 2
    s_cbranch_scc1 L_ay67
    v_mov_b32 v64, v30
    v_mov_b32 v65, v30
    v_mov_b32 v66, v30
    v_mov_b32 v67, v30
    v_mov_b32 v68, v30
    v_mov_b32 v69, v30
    v_mov_b32 v70, v30
    v_mov_b32 v71, v30
    v_mov_b32 v72, v30
    v_mov_b32 v73, v30
    v_mov_b32 v74, v30
    v_mov_b32 v75, v30
    v_mov_b32 v76, v30
    v_mov_b32 v77, v30
    v_mov_b32 v78, v30
    v_mov_b32 v79, v30
    s_cmp_ge_u32 s31, 1
    s_cbranch_scc1 L_ay67
    v_mov_b32 v80, v30
    v_mov_b32 v81, v30
    v_mov_b32 v82, v30
    v_mov_b32 v83, v30
    v_mov_b32 v84, v30
    v_mov_b32 v85, v30
    v_mov_b32 v86, v30
    v_mov_b32 v87, v30
    v_mov_b32 v88, v30
    v_mov_b32 v89, v30
    v_mov_b32 v90, v30
    v_mov_b32 v91, v30
    v_mov_b32 v92, v30
    v_mov_b32 v93, v30
    v_mov_b32 v94, v30
    v_mov_b32 v95, v30
L_ay67:
    v_max_f32 v28, v32, v33
    v_max_f32 v29, v34, v35
    v_max3_f32 v28, v28, v36, v37
    v_max3_f32 v29, v29, v38, v39
    v_max3_f32 v28, v28, v40, v41
    v_max3_f32 v29, v29, v42, v43
    v_max3_f32 v28, v28, v44, v45
    v_max3_f32 v29, v29, v46, v47
    v_max3_f32 v28, v28, v48, v49
    v_max3_f32 v29, v29, v50, v51
    v_max3_f32 v28, v28, v52, v53
    v_max3_f32 v29, v29, v54, v55
    v_max3_f32 v28, v28, v56, v57
    v_max3_f32 v29, v29, v58, v59
    v_max3_f32 v28, v28, v60, v61
    v_max3_f32 v29, v29, v62, v63
    v_max3_f32 v28, v28, v64, v65
    v_max3_f32 v29, v29, v66, v67
    v_max3_f32 v28, v28, v68, v69
    v_max3_f32 v29, v29, v70, v71
    v_max3_f32 v28, v28, v72, v73
    v_max3_f32 v29, v29, v74, v75
    v_max3_f32 v28, v28, v76, v77
    v_max3_f32 v29, v29, v78, v79
    v_max3_f32 v28, v28, v80, v81
    v_max3_f32 v29, v29, v82, v83
    v_max3_f32 v28, v28, v84, v85
    v_max3_f32 v29, v29, v86, v87
    v_max3_f32 v28, v28, v88, v89
    v_max3_f32 v29, v29, v90, v91
    v_max3_f32 v28, v28, v92, v93
    v_max3_f32 v29, v29, v94, v95
    v_max3_f32 v28, v28, v96, v97
    v_max3_f32 v29, v29, v98, v99
    v_max3_f32 v28, v28, v100, v101
    v_max3_f32 v29, v29, v102, v103
    v_max3_f32 v28, v28, v104, v105
    v_max3_f32 v29, v29, v106, v107
    v_max3_f32 v28, v28, v108, v109
    v_max3_f32 v29, v29, v110, v111
    v_max3_f32 v28, v28, v112, v113
    v_max3_f32 v29, v29, v114, v115
    v_max3_f32 v28, v28, v116, v117
    v_max3_f32 v29, v29, v118, v119
    v_max3_f32 v28, v28, v120, v121
    v_max3_f32 v29, v29, v122, v123
    v_max3_f32 v28, v28, v124, v125
    v_max3_f32 v29, v29, v126, v127
    v_max3_f32 v28, v28, v128, v129
    v_max3_f32 v29, v29, v130, v131
    v_max3_f32 v28, v28, v132, v133
    v_max3_f32 v29, v29, v134, v135
    v_max3_f32 v28, v28, v136, v137
    v_max3_f32 v29, v29, v138, v139
    v_max3_f32 v28, v28, v140, v141
    v_max3_f32 v29, v29, v142, v143
    v_max3_f32 v28, v28, v144, v145
    v_max3_f32 v29, v29, v146, v147
    v_max3_f32 v28, v28, v148, v149
    v_max3_f32 v29, v29, v150, v151
    v_max3_f32 v28, v28, v152, v153
    v_max3_f32 v29, v29, v154, v155
    v_max3_f32 v28, v28, v156, v157
    v_max3_f32 v29, v29, v158, v159
    s_branch L_ae66
L_sf68:
    s_nop 4
    buffer_store_dword v30, v2, s[20:23], s8 offen offset:0 sc1
    s_nop 1
    s_branch L_se69
L_sf70:
    s_nop 4
    buffer_store_dwordx4 v[16:19], v3, s[20:23], s39 offen sc1
    buffer_store_dwordx2 v[20:21], v27, s[20:23], s39 offen offset:1024 sc1
    s_nop 1
    s_branch L_se71
L_sf72:
    s_nop 4
    buffer_store_dword v30, v2, s[20:23], s8 offen offset:512 sc1
    s_nop 1
    s_branch L_se73
L_ll74:
    s_mov_b32 s47, 0
L_lr76:
    ds_read_b32 v90, v254 offset:0
    s_add_u32 s47, s47, 1
    s_cmp_ge_u32 s47, 1600000
    s_waitcnt lgkmcnt(0)
    s_cbranch_scc1 L_ld75
    v_cmp_gt_u32 vcc, 5, v90
    s_cbranch_vccnz L_lr76
    s_branch L_ld75
L_pl77:
    s_mov_b32 s47, 0
L_pr79:
    buffer_load_dword v15, v252, s[20:23], s45 offen sc1
    s_add_u32 s47, s47, 1
    s_cmp_ge_u32 s47, 400000
    s_waitcnt vmcnt(0)
    s_cbranch_scc1 L_pd78
    v_cmp_gt_u32 vcc, 1, v15
    s_cbranch_vccnz L_pr79
    s_branch L_pd78
L_ll80:
    s_mov_b32 s47, 0
L_lr82:
    ds_read_b32 v90, v254 offset:0
    s_add_u32 s47, s47, 1
    s_cmp_ge_u32 s47, 1600000
    s_waitcnt lgkmcnt(0)
    s_cbranch_scc1 L_ld81
    v_cmp_gt_u32 vcc, 6, v90
    s_cbranch_vccnz L_lr82
    s_branch L_ld81
L_sf83:
    s_nop 4
    buffer_store_dwordx4 v[80:83], v3, s[20:23], s43 offen sc1
    buffer_store_dwordx4 v[84:87], v3, s[20:23], s43 offen offset:1024 sc1
    buffer_store_dwordx2 v[88:89], v3, s[20:23], s44 offen sc1
    s_nop 1
    s_branch L_se84
L_sf85:
    s_nop 4
    buffer_store_dword v4, v2, s[20:23], s34 offen sc1
    s_nop 1
    s_branch L_se86
L_pl87:
    s_mov_b32 s47, 0
L_pr89:
    buffer_load_dword v15, v14, s[20:23], s33 offen sc1
    s_add_u32 s47, s47, 1
    s_cmp_ge_u32 s47, 400000
    s_waitcnt vmcnt(0)
    s_cbranch_scc1 L_pd88
    v_cmp_gt_u32 vcc, 1, v15
    s_cbranch_vccnz L_pr89
    s_branch L_pd88
L_sf90:
    s_nop 4
    buffer_store_dwordx2 v[36:37], v3, s[20:23], s44 offen sc1
    s_nop 1
    s_branch L_se91
L_ll92:
    s_mov_b32 s47, 0
L_lr94:
    ds_read_b32 v90, v254 offset:0
    s_add_u32 s47, s47, 1
    s_cmp_ge_u32 s47, 1600000
    s_waitcnt lgkmcnt(0)
    s_cbranch_scc1 L_ld93
    v_cmp_gt_u32 vcc, 10, v90
    s_cbranch_vccnz L_lr94
    s_branch L_ld93
L_sf95:
    s_nop 4
    buffer_store_dword v4, v2, s[20:23], s34 offen sc1
    s_nop 1
    s_branch L_se96
L_pl97:
    s_mov_b32 s47, 0
L_pr99:
    buffer_load_dword v15, v14, s[20:23], s33 offen sc1
    s_add_u32 s47, s47, 1
    s_cmp_ge_u32 s47, 400000
    s_waitcnt vmcnt(0)
    s_cbranch_scc1 L_pd98
    v_cmp_gt_u32 vcc, 2, v15
    s_cbranch_vccnz L_pr99
    s_branch L_pd98
L_sf100:
    s_nop 4
    buffer_store_dwordx4 v[132:135], v229, s[20:23], s43 offen sc1
    buffer_store_dwordx4 v[136:139], v229, s[20:23], s43 offen offset:1024 sc1
    buffer_store_dwordx2 v[140:141], v229, s[20:23], s44 offen sc1
    s_nop 1
    s_branch L_se101
L_halo:
    s_mov_b64 exec, s[14:15]
    s_add_u32 s43, s43, 2621440
    s_add_u32 s44, s44, 2621440
    buffer_store_dwordx4 v[132:135], v229, s[20:23], s43 offen sc1
    buffer_store_dwordx4 v[136:139], v229, s[20:23], s43 offen offset:1024 sc1
    buffer_store_dwordx2 v[140:141], v229, s[20:23], s44 offen sc1
    s_nop 1
    s_branch L_haloe
L_sf102:
    s_nop 4
    buffer_store_dword v4, v2, s[20:23], s34 offen sc1
    s_nop 1
    s_branch L_se103
L_hf:
    s_mov_b64 exec, 1
    buffer_store_dword v4, v2, s[20:23], s39 offen sc1
    s_mov_b64 exec, -1
    s_branch L_hfe
L_pl104:
    s_mov_b32 s47, 0
L_pr106:
    buffer_load_dword v15, v228, s[20:23], 0 offen sc1
    s_add_u32 s47, s47, 1
    s_cmp_ge_u32 s47, 400000
    s_waitcnt vmcnt(0)
    s_cbranch_scc1 L_pd105
    v_cmp_gt_u32 vcc, 3, v15
    s_cbranch_vccnz L_pr106
    s_branch L_pd105
L_ll107:
    s_mov_b32 s47, 0
L_lr109:
    ds_read_b32 v90, v254 offset:0
    s_add_u32 s47, s47, 1
    s_cmp_ge_u32 s47, 1600000
    s_waitcnt lgkmcnt(0)
    s_cbranch_scc1 L_ld108
    v_cmp_gt_u32 vcc, 15, v90
    s_cbranch_vccnz L_lr109
    s_branch L_ld108
L_sf110:
    s_nop 4
    buffer_store_dwordx4 v[132:135], v3, s[20:23], s43 offen sc1
    buffer_store_dwordx4 v[136:139], v3, s[20:23], s43 offen offset:1024 sc1
    buffer_store_dwordx2 v[140:141], v3, s[20:23], s44 offen sc1
    s_nop 1
    s_branch L_se111
L_sf112:
    s_nop 4
    buffer_store_dword v4, v2, s[20:23], s34 offen sc1
    s_nop 1
    s_branch L_se113
L_pl114:
    s_mov_b32 s47, 0
L_pr116:
    buffer_load_dword v15, v14, s[20:23], s33 offen sc1
    s_add_u32 s47, s47, 1
    s_cmp_ge_u32 s47, 400000
    s_waitcnt vmcnt(0)
    s_cbranch_scc1 L_pd115
    v_cmp_gt_u32 vcc, 4, v15
    s_cbranch_vccnz L_pr116
    s_branch L_pd115
L_sf117:
    s_nop 4
    buffer_store_dwordx2 v[36:37], v3, s[20:23], s44 offen sc1
    s_nop 1
    s_branch L_se118
L_ll119:
    s_mov_b32 s47, 0
L_lr121:
    ds_read_b32 v90, v254 offset:0
    s_add_u32 s47, s47, 1
    s_cmp_ge_u32 s47, 1600000
    s_waitcnt lgkmcnt(0)
    s_cbranch_scc1 L_ld120
    v_cmp_gt_u32 vcc, 20, v90
    s_cbranch_vccnz L_lr121
    s_branch L_ld120
L_sf122:
    s_nop 4
    buffer_store_dword v4, v2, s[20:23], s34 offen sc1
    s_nop 1
    s_branch L_se123
L_pl124:
    s_mov_b32 s47, 0
L_pr126:
    buffer_load_dword v15, v14, s[20:23], s33 offen sc1
    s_add_u32 s47, s47, 1
    s_cmp_ge_u32 s47, 400000
    s_waitcnt vmcnt(0)
    s_cbranch_scc1 L_pd125
    v_cmp_gt_u32 vcc, 5, v15
    s_cbranch_vccnz L_pr126
    s_branch L_pd125
L_ll127:
    s_mov_b32 s47, 0
L_lr129:
    ds_read_b32 v90, v254 offset:0
    s_add_u32 s47, s47, 1
    s_cmp_ge_u32 s47, 1600000
    s_waitcnt lgkmcnt(0)
    s_cbranch_scc1 L_ld128
    v_cmp_gt_u32 vcc, 21, v90
    s_cbranch_vccnz L_lr129
    s_branch L_ld128
L_ll130:
    s_mov_b32 s47, 0
L_lr132:
    ds_read_b32 v90, v254 offset:0
    s_add_u32 s47, s47, 1
    s_cmp_ge_u32 s47, 1600000
    s_waitcnt lgkmcnt(0)
    s_cbranch_scc1 L_ld131
    v_cmp_gt_u32 vcc, 22, v90
    s_cbranch_vccnz L_lr132
    s_branch L_ld131
L_sf133:
    s_nop 4
    buffer_store_dword v4, v2, s[20:23], s34 offen sc1
    s_nop 1
    s_branch L_se134
L_sf135:
    s_nop 4
    buffer_store_dwordx4 v[132:135], v3, s[20:23], s43 offen sc1
    buffer_store_dwordx4 v[136:139], v3, s[20:23], s44 offen sc1
    s_nop 1
    s_branch L_se136
L_sf137:
    s_nop 4
    buffer_store_dword v4, v2, s[20:23], s34 offen sc1
    s_nop 1
    s_branch L_se138
L_sf139:
    s_nop 4
    buffer_store_dwordx4 v[80:83], v3, s[20:23], s43 offen sc1
    buffer_store_dwordx4 v[84:87], v3, s[20:23], s44 offen sc1
    s_nop 1
    s_branch L_se140
L_sf141:
    s_nop 4
    buffer_store_dword v4, v2, s[20:23], s34 offen sc1
    s_nop 1
    s_branch L_se142
L_pl143:
    s_mov_b32 s47, 0
L_pr145:
    buffer_load_dword v15, v14, s[20:23], s33 offen sc1
    s_add_u32 s47, s47, 1
    s_cmp_ge_u32 s47, 400000
    s_waitcnt vmcnt(0)
    s_cbranch_scc1 L_pd144
    v_cmp_gt_u32 vcc, 7, v15
    s_cbranch_vccnz L_pr145
    s_branch L_pd144
L_sf146:
    s_nop 4
    buffer_store_dwordx4 v[132:135], v3, s[20:23], s43 offen sc1
    buffer_store_dwordx4 v[136:139], v3, s[20:23], s44 offen sc1
    s_nop 1
    s_branch L_se147
L_sf148:
    s_nop 4
    buffer_store_dwordx2 v[80:81], v3, s[20:23], s43 offen sc1
    buffer_store_dwordx2 v[84:85], v3, s[20:23], s44 offen sc1
    s_nop 1
    s_branch L_se149
L_ll150:
    s_mov_b32 s47, 0
L_lr152:
    ds_read_b32 v90, v254 offset:0
    s_add_u32 s47, s47, 1
    s_cmp_ge_u32 s47, 1600000
    s_waitcnt lgkmcnt(0)
    s_cbranch_scc1 L_ld151
    v_cmp_gt_u32 vcc, 23, v90
    s_cbranch_vccnz L_lr152
    s_branch L_ld151
L_sf153:
    s_nop 4
    buffer_store_dword v4, v2, s[20:23], s34 offen sc1
    s_nop 1
    s_branch L_se154
L_ll155:
    s_mov_b32 s47, 0
L_lr157:
    ds_read_b32 v90, v254 offset:0
    s_add_u32 s47, s47, 1
    s_cmp_ge_u32 s47, 1600000
    s_waitcnt lgkmcnt(0)
    s_cbranch_scc1 L_ld156
    v_cmp_gt_u32 vcc, 24, v90
    s_cbranch_vccnz L_lr157
    s_branch L_ld156
L_pl158:
    s_mov_b32 s47, 0
L_pr160:
    buffer_load_dword v15, v14, s[20:23], s33 offen sc1
    s_add_u32 s47, s47, 1
    s_cmp_ge_u32 s47, 400000
    s_waitcnt vmcnt(0)
    s_cbranch_scc1 L_pd159
    v_cmp_gt_u32 vcc, 8, v15
    s_cbranch_vccnz L_pr160
    s_branch L_pd159
L_ll161:
    s_mov_b32 s47, 0
L_lr163:
    ds_read_b32 v90, v254 offset:0
    s_add_u32 s47, s47, 1
    s_cmp_ge_u32 s47, 1600000
    s_waitcnt lgkmcnt(0)
    s_cbranch_scc1 L_ld162
    v_cmp_gt_u32 vcc, 25, v90
    s_cbranch_vccnz L_lr163
    s_branch L_ld162
L_ll164:
    s_mov_b32 s47, 0
L_lr166:
    ds_read_b32 v90, v254 offset:0
    s_add_u32 s47, s47, 1
    s_cmp_ge_u32 s47, 1600000
    s_waitcnt lgkmcnt(0)
    s_cbranch_scc1 L_ld165
    v_cmp_gt_u32 vcc, 26, v90
    s_cbranch_vccnz L_lr166
    s_branch L_ld165
L_pl167:
    s_mov_b32 s47, 0
L_pr169:
    buffer_load_dword v15, v14, s[20:23], s33 offen sc1
    s_add_u32 s47, s47, 1
    s_cmp_ge_u32 s47, 400000
    s_waitcnt vmcnt(0)
    s_cbranch_scc1 L_pd168
    v_cmp_gt_u32 vcc, 9, v15
    s_cbranch_vccnz L_pr169
    s_branch L_pd168
L_ll170:
    s_mov_b32 s47, 0
L_lr172:
    ds_read_b32 v90, v254 offset:0
    s_add_u32 s47, s47, 1
    s_cmp_ge_u32 s47, 1600000
    s_waitcnt lgkmcnt(0)
    s_cbranch_scc1 L_ld171
    v_cmp_gt_u32 vcc, 27, v90
    s_cbranch_vccnz L_lr172
    s_branch L_ld171
L_sf173:
    s_nop 4
    buffer_store_dword v4, v2, s[20:23], s34 offen sc1
    s_nop 1
    s_branch L_se174
L_ll175:
    s_mov_b32 s47, 0
L_lr177:
    ds_read_b32 v90, v254 offset:0
    s_add_u32 s47, s47, 1
    s_cmp_ge_u32 s47, 1600000
    s_waitcnt lgkmcnt(0)
    s_cbranch_scc1 L_ld176
    v_cmp_gt_u32 vcc, 28, v90
    s_cbranch_vccnz L_lr177
    s_branch L_ld176
L_ll178:
    s_mov_b32 s47, 0
L_lr180:
    ds_read_b32 v90, v254 offset:0
    s_add_u32 s47, s47, 1
    s_cmp_ge_u32 s47, 1600000
    s_waitcnt lgkmcnt(0)
    s_cbranch_scc1 L_ld179
    v_cmp_gt_u32 vcc, 29, v90
    s_cbranch_vccnz L_lr180
    s_branch L_ld179
L_pl181:
    s_mov_b32 s47, 0
L_pr183:
    buffer_load_dword v15, v14, s[20:23], s33 offen sc1
    s_add_u32 s47, s47, 1
    s_cmp_ge_u32 s47, 400000
    s_waitcnt vmcnt(0)
    s_cbranch_scc1 L_pd182
    v_cmp_gt_u32 vcc, 10, v15
    s_cbranch_vccnz L_pr183
    s_branch L_pd182
L_sf184:
    s_nop 4
    buffer_store_dwordx4 v[16:19], v3, s[20:23], s4 offen sc1
    buffer_store_dwordx4 v[20:23], v3, s[20:23], s43 offen sc1
    buffer_store_dwordx4 v[24:27], v3, s[20:23], s44 offen sc1
    buffer_store_dwordx4 v[28:31], v3, s[20:23], s38 offen sc1
    buffer_store_dwordx4 v[32:35], v3, s[20:23], s5 offen sc1
    s_nop 1
    s_branch L_se185
L_sf186:
    s_nop 4
    buffer_store_dword v4, v2, s[20:23], s34 offen sc1
    s_nop 1
    s_branch L_se187
L_pl188:
    s_mov_b32 s47, 0
L_pr190:
    buffer_load_dword v15, v2, s[20:23], s8 offen sc1
    s_add_u32 s47, s47, 1
    s_cmp_ge_u32 s47, 400000
    s_waitcnt vmcnt(0)
    s_cbranch_scc1 L_pd189
    v_cmp_gt_u32 vcc, 11, v15
    s_cbranch_vccnz L_pr190
    s_branch L_pd189
L_zr197:
    s_mov_b32 s47, 0
    v_mul_u32_u24 v6, 128, v1
    v_add_u32 v6, 0, v6
    s_mov_b64 exec, 255
L_zs198:
    buffer_load_dword v7, v6, s[20:23], s41 offen sc1
    s_add_u32 s47, s47, 1
    s_waitcnt vmcnt(0)
    v_cmp_gt_u32 vcc, 1, v7
    s_cbranch_vccz L_zs198x
    s_sleep 6
    s_cmp_lt_u32 s47, 400000
    s_cbranch_scc1 L_zs198
L_zs198x:
    s_mov_b64 exec, -1
    s_branch L_zq196
L_zr203:
    s_mov_b32 s47, 0
    v_mul_u32_u24 v6, 128, v1
    v_add_u32 v6, 0, v6
    s_mov_b64 exec, 32767
L_zs204:
    buffer_load_dword v7, v6, s[20:23], s40 offen sc1
    s_add_u32 s47, s47, 1
    s_waitcnt vmcnt(0)
    v_cmp_gt_u32 vcc, 1, v7
    s_cbranch_vccz L_zs204x
    s_sleep 6
    s_cmp_lt_u32 s47, 400000
    s_cbranch_scc1 L_zs204
L_zs204x:
    s_mov_b64 exec, -1
    s_branch L_zq202
L_zr209:
    s_mov_b32 s47, 0
    v_mul_u32_u24 v6, 128, v1
    v_add_u32 v6, 5120, v6
    s_mov_b64 exec, 255
L_zs210:
    buffer_load_dword v7, v6, s[20:23], s41 offen sc1
    s_add_u32 s47, s47, 1
    s_waitcnt vmcnt(0)
    v_cmp_gt_u32 vcc, 1, v7
    s_cbranch_vccz L_zs210x
    s_sleep 6
    s_cmp_lt_u32 s47, 400000
    s_cbranch_scc1 L_zs210
L_zs210x:
    s_mov_b64 exec, -1
    s_branch L_zq208
L_zr215:
    s_mov_b32 s47, 0
    v_mul_u32_u24 v6, 128, v1
    v_add_u32 v6, 0, v6
    s_mov_b64 exec, 65535
L_zs216:
    buffer_load_dword v7, v6, s[20:23], s42 offen sc1
    s_add_u32 s47, s47, 1
    s_waitcnt vmcnt(0)
    v_cmp_gt_u32 vcc, 1, v7
    s_cbranch_vccz L_zs216x
    s_sleep 6
    s_cmp_lt_u32 s47, 400000
    s_cbranch_scc1 L_zs216
L_zs216x:
    s_mov_b64 exec, -1
    s_branch L_zq214
L_ll220:
    s_mov_b32 s47, 0
L_lr222:
    s_sleep 1
    ds_read_b32 v11, v4 offset:16
    s_add_u32 s47, s47, 1
    s_cmp_ge_u32 s47, 1600000
    s_waitcnt lgkmcnt(0)
    s_cbranch_scc1 L_ld221
    v_cmp_gt_u32 vcc, 1, v11
    s_cbranch_vccnz L_lr222
    s_branch L_ld221
L_zr224:
    s_mov_b32 s47, 0
    v_mul_u32_u24 v6, 128, v1
    v_add_u32 v6, 0, v6
    s_mov_b64 exec, 4095
L_zs225:
    buffer_load_dword v7, v6, s[20:23], s31 offen sc1
    s_add_u32 s47, s47, 1
    s_waitcnt vmcnt(0)
    v_cmp_gt_u32 vcc, 1, v7
    s_cbranch_vccz L_zs225x
    s_sleep 6
    s_cmp_lt_u32 s47, 400000
    s_cbranch_scc1 L_zs225
L_zs225x:
    s_mov_b64 exec, -1
    s_branch L_zq223
L_ll226:
    s_mov_b32 s47, 0
L_lr228:
    s_sleep 1
    ds_read_b32 v11, v4 offset:16
    s_add_u32 s47, s47, 1
    s_cmp_ge_u32 s47, 1600000
    s_waitcnt lgkmcnt(0)
    s_cbranch_scc1 L_ld227
    v_cmp_gt_u32 vcc, 3, v11
    s_cbranch_vccnz L_lr228
    s_branch L_ld227
L_ll231:
    s_mov_b32 s47, 0
L_lr233:
    s_sleep 1
    ds_read_b32 v11, v4 offset:16
    s_add_u32 s47, s47, 1
    s_cmp_ge_u32 s47, 1600000
    s_waitcnt lgkmcnt(0)
    s_cbranch_scc1 L_ld232
    v_cmp_gt_u32 vcc, 5, v11
    s_cbranch_vccnz L_lr233
    s_branch L_ld232
L_ll234:
    s_mov_b32 s47, 0
L_lr236:
    s_sleep 1
    ds_read_b32 v11, v4 offset:16
    s_add_u32 s47, s47, 1
    s_cmp_ge_u32 s47, 1600000
    s_waitcnt lgkmcnt(0)
    s_cbranch_scc1 L_ld235
    v_cmp_gt_u32 vcc, 8, v11
    s_cbranch_vccnz L_lr236
    s_branch L_ld235
L_ll237:
    s_mov_b32 s47, 0
L_lr239:
    s_sleep 1
    ds_read_b32 v11, v4 offset:16
    s_add_u32 s47, s47, 1
    s_cmp_ge_u32 s47, 1600000
    s_waitcnt lgkmcnt(0)
    s_cbranch_scc1 L_ld238
    v_cmp_gt_u32 vcc, 10, v11
    s_cbranch_vccnz L_lr239
    s_branch L_ld238
L_ll240:
    s_mov_b32 s47, 0
L_lr242:
    s_sleep 1
    ds_read_b32 v11, v4 offset:16
    s_add_u32 s47, s47, 1
    s_cmp_ge_u32 s47, 1600000
    s_waitcnt lgkmcnt(0)
    s_cbranch_scc1 L_ld241
    v_cmp_gt_u32 vcc, 13, v11
    s_cbranch_vccnz L_lr242
    s_branch L_ld241
L_ll245:
    s_mov_b32 s47, 0
L_lr247:
    s_sleep 1
    ds_read_b32 v11, v4 offset:16
    s_add_u32 s47, s47, 1
    s_cmp_ge_u32 s47, 1600000
    s_waitcnt lgkmcnt(0)
    s_cbranch_scc1 L_ld246
    v_cmp_gt_u32 vcc, 15, v11
    s_cbranch_vccnz L_lr247
    s_branch L_ld246
L_ll248:
    s_mov_b32 s47, 0
L_lr250:
    s_sleep 1
    ds_read_b32 v11, v4 offset:16
    s_add_u32 s47, s47, 1
    s_cmp_ge_u32 s47, 1600000
    s_waitcnt lgkmcnt(0)
    s_cbranch_scc1 L_ld249
    v_cmp_gt_u32 vcc, 16, v11
    s_cbranch_vccnz L_lr250
    s_branch L_ld249
L_ll253:
    s_mov_b32 s47, 0
L_lr255:
    s_sleep 1
    ds_read_b32 v11, v4 offset:16
    s_add_u32 s47, s47, 1
    s_cmp_ge_u32 s47, 1600000
    s_waitcnt lgkmcnt(0)
    s_cbranch_scc1 L_ld254
    v_cmp_gt_u32 vcc, 16, v11
    s_cbranch_vccnz L_lr255
    s_branch L_ld254
L_ll256:
    s_mov_b32 s47, 0
L_lr258:
    s_sleep 1
    ds_read_b32 v11, v4 offset:16
    s_add_u32 s47, s47, 1
    s_cmp_ge_u32 s47, 1600000
    s_waitcnt lgkmcnt(0)
    s_cbranch_scc1 L_ld257
    v_cmp_gt_u32 vcc, 16, v11
    s_cbranch_vccnz L_lr258
    s_branch L_ld257
L_ll259:
    s_mov_b32 s47, 0
L_lr261:
    s_sleep 1
    ds_read_b32 v11, v4 offset:16
    s_add_u32 s47, s47, 1
    s_cmp_ge_u32 s47, 1600000
    s_waitcnt lgkmcnt(0)
    s_cbranch_scc1 L_ld260
    v_cmp_gt_u32 vcc, 17, v11
    s_cbranch_vccnz L_lr261
    s_branch L_ld260
L_ll262:
    s_mov_b32 s47, 0
L_lr264:
    s_sleep 1
    ds_read_b32 v11, v4 offset:16
    s_add_u32 s47, s47, 1
    s_cmp_ge_u32 s47, 1600000
    s_waitcnt lgkmcnt(0)
    s_cbranch_scc1 L_ld263
    v_cmp_gt_u32 vcc, 18, v11
    s_cbranch_vccnz L_lr264
    s_branch L_ld263
L_ll265:
    s_mov_b32 s47, 0
L_lr267:
    s_sleep 1
    ds_read_b32 v11, v4 offset:16
    s_add_u32 s47, s47, 1
    s_cmp_ge_u32 s47, 1600000
    s_waitcnt lgkmcnt(0)
    s_cbranch_scc1 L_ld266
    v_cmp_gt_u32 vcc, 19, v11
    s_cbranch_vccnz L_lr267
    s_branch L_ld266
L_ll268:
    s_mov_b32 s47, 0
L_lr270:
    s_sleep 1
    ds_read_b32 v11, v4 offset:16
    s_add_u32 s47, s47, 1
    s_cmp_ge_u32 s47, 1600000
    s_waitcnt lgkmcnt(0)
    s_cbranch_scc1 L_ld269
    v_cmp_gt_u32 vcc, 20, v11
    s_cbranch_vccnz L_lr270
    s_branch L_ld269
L_ll271:
    s_mov_b32 s47, 0
L_lr273:
    s_sleep 1
    ds_read_b32 v11, v4 offset:16
    s_add_u32 s47, s47, 1
    s_cmp_ge_u32 s47, 1600000
    s_waitcnt lgkmcnt(0)
    s_cbranch_scc1 L_ld272
    v_cmp_gt_u32 vcc, 23, v11
    s_cbranch_vccnz L_lr273
    s_branch L_ld272
L_ll274:
    s_mov_b32 s47, 0
L_lr276:
    s_sleep 1
    ds_read_b32 v11, v4 offset:16
    s_add_u32 s47, s47, 1
    s_cmp_ge_u32 s47, 1600000
    s_waitcnt lgkmcnt(0)
    s_cbranch_scc1 L_ld275
    v_cmp_gt_u32 vcc, 21, v11
    s_cbranch_vccnz L_lr276
    s_branch L_ld275
L_ll277:
    s_mov_b32 s47, 0
L_lr279:
    s_sleep 1
    ds_read_b32 v11, v4 offset:16
    s_add_u32 s47, s47, 1
    s_cmp_ge_u32 s47, 1600000
    s_waitcnt lgkmcnt(0)
    s_cbranch_scc1 L_ld278
    v_cmp_gt_u32 vcc, 22, v11
    s_cbranch_vccnz L_lr279
    s_branch L_ld278
L_code_end:
.section .rodata,"a"
.p2align 6
.amdhsa_kernel sequential_preLN__sliding_block__mixer_s_mlp__prompt_kernel
  .amdhsa_next_free_vgpr 256
  .amdhsa_next_free_sgpr 102
  .amdhsa_accum_offset 256
  .amdhsa_group_segment_fixed_size 0
  .amdhsa_kernarg_size 88
  .amdhsa_user_sgpr_count 2
  .amdhsa_user_sgpr_kernarg_segment_ptr 1
  .amdhsa_system_sgpr_workgroup_id_x 1
.end_amdhsa_kernel
```
